```python
import torch

def _softmax(x, axis=-1):
    return torch.softmax(x, dim=axis)
def _gelu(x):
    return torch.nn.functional.gelu(x, approximate="tanh")
def _silu(x):
    return torch.nn.functional.silu(x)
def _sigmoid(x):
    return torch.sigmoid(x)
def _layernorm(x, axis=-1, eps=1e-5):
    m = x.mean(dim=axis, keepdim=True)
    v = x.var(dim=axis, keepdim=True, unbiased=False)
    return (x - m) / torch.sqrt(v + eps)
def _scatter_add(tgt, idx, src, axis=0):
    return tgt.clone().index_add_(axis, idx, src)
def _segment_sum(src, seg, n):
    out = torch.zeros((n,) + src.shape[1:], dtype=src.dtype)
    return out.index_add_(0, seg, src)
def _pad(x, pw):
    flat = tuple(v for pair in reversed(pw) for v in pair)
    return torch.nn.functional.pad(x, flat)

kernel_name = 'gated_mix__ssm_conv_s4__glu_gated_swiglu__prompt'

def setup_inputs():

    _w = (lambda a: (lambda t: t.to(torch.bfloat16) if t.is_floating_point() else t)(torch.as_tensor(a)))
    def _A_setup():
        B, L, D, N = 1, 2048, 576, 128
        A_re = -(lambda _x: torch.exp(torch.as_tensor(_x)))((lambda *s: torch.randn(*s, dtype=torch.bfloat16) * 3.2)(D, N))
        A_im = torch.pi * (lambda *s: torch.randn(*s, dtype=torch.bfloat16) * 0.05)(D, N)
        B_re = (lambda *s: torch.randn(*s, dtype=torch.bfloat16) * 0.1)(D, N)
        B_im = (lambda *s: torch.randn(*s, dtype=torch.bfloat16) * 0.1)(D, N)
        C_re = (lambda *s: torch.randn(*s, dtype=torch.bfloat16) * 0.1)(D, N)
        C_im = (lambda *s: torch.randn(*s, dtype=torch.bfloat16) * 0.1)(D, N)
        log_dt = (lambda *s: torch.randn(*s, dtype=torch.bfloat16) * 0.05)(D) * 0.5 - 4.0
        Dskip = (lambda *s: torch.randn(*s, dtype=torch.bfloat16) * 0.05)(D)
        return {
            "u": _w((lambda *s: torch.randn(*s, dtype=torch.bfloat16) * 0.05)(B, L, D)),
            "A_re": _w(A_re),
            "A_im": _w(A_im),
            "B_re": _w(B_re),
            "B_im": _w(B_im),
            "C_re": _w(C_re),
            "C_im": _w(C_im),
            "log_dt": _w(log_dt),
            "Dskip": _w(Dskip),
        }
    _A_in = _A_setup()

    def _B_setup():
        B, S, D, F = 1, 2048, 576, 4608
        return {
            "x": _w((lambda *s: torch.randn(*s, dtype=torch.bfloat16) * 0.05)(B, S, D)),
            "w1": _w((lambda *s: torch.randn(*s, dtype=torch.bfloat16) * 0.8)(D, F) * (2.0 / D) ** 0.5),
            "w3": _w((lambda *s: torch.randn(*s, dtype=torch.bfloat16) * 0.8)(D, F) * (2.0 / D) ** 0.5),
            "w2": _w((lambda *s: torch.randn(*s, dtype=torch.bfloat16) * 0.8)(F, D) * (2.0 / F) ** 0.5),
        }
    _B_in = _B_setup()

    return {
        "A_u": _A_in["u"],
        "A_A_re": _A_in["A_re"],
        "A_A_im": _A_in["A_im"],
        "A_B_re": _A_in["B_re"],
        "A_B_im": _A_in["B_im"],
        "A_C_re": _A_in["C_re"],
        "A_C_im": _A_in["C_im"],
        "A_log_dt": _A_in["log_dt"],
        "A_Dskip": _A_in["Dskip"],
        "B_x": _B_in["x"],
        "B_w1": _B_in["w1"],
        "B_w3": _B_in["w3"],
        "B_w2": _B_in["w2"],
        "gate_w": _w((lambda *s: torch.randn(*s, dtype=torch.bfloat16) * 0.05)(576) * 16.0),
    }

def reference(A_u, A_A_re, A_A_im, A_B_re, A_B_im, A_C_re, A_C_im, A_log_dt, A_Dskip, B_x, B_w1, B_w3, B_w2, gate_w):
    def _A_ref(u, A_re, A_im, B_re, B_im, C_re, C_im, log_dt, Dskip):
        Bsz, L, D = u.shape
        dt = torch.exp(log_dt)[:, None]
        A = A_re + 1j * A_im
        Bc = B_re + 1j * B_im
        Cc = C_re + 1j * C_im
        logdA = dt * A
        dB = dt * Bc
        l = (lambda x, dt: x.to(dt))(torch.arange(L), A_re.dtype)
        P = torch.exp(logdA[:, :, None] * l[None, None, :])
        K = torch.einsum("dn,dnl,dn->dl", Cc, P, dB).real
        L2 = 2 * L
        Kp = _pad(K, ((0, 0), (0, L)))
        up = (lambda x, *d: x.permute(*d))(u, 0, 2, 1)
        up = _pad(up, ((0, 0), (0, 0), (0, L)))
        Kf = (lambda x, axes=(-2,-1): torch.fft.rfft2(x.float(), dim=axes))(Kp[:, None, :], axes=(-2, -1))
        Uf = (lambda x, axes=(-2,-1): torch.fft.rfft2(x.float(), dim=axes))(up[:, :, None, :], axes=(-2, -1))
        Yf = Uf * Kf[None, :, :, :]
        y = (lambda x, s, axes=(-2,-1): torch.fft.irfft2(x, s=s, dim=axes).to(torch.bfloat16))(Yf, (1, L2), axes=(-2, -1))[:, :, 0, :L]
        y = (lambda x, *d: x.permute(*d))(y, 0, 2, 1) + u * Dskip[None, None, :]
        return y

    def _B_ref(x, w1, w3, w2):
        gate = torch.einsum("bsd,df->bsf", x, w1)
        up = torch.einsum("bsd,df->bsf", x, w3)
        h = _silu(gate) * up
        out = torch.einsum("bsf,fd->bsd", h, w2)
        return out

    x = A_u
    g = _sigmoid((x * gate_w).sum(-1, keepdims=True))
    a = _A_ref(x, A_A_re, A_A_im, A_B_re, A_B_im, A_C_re, A_C_im, A_log_dt, A_Dskip)
    b = _B_ref(x, B_w1, B_w3, B_w2)
    return g * a + (1 - g) * b
```

```asm
; @launch kernel=mk_kernel grid=(256,1,1) block=(256,1,1) lds=163840
.amdgcn_target "amdgcn-amd-amdhsa--gfx950"
.text
.globl mk_kernel
.p2align 12
.type mk_kernel,@function
mk_kernel:
    s_cmp_ge_u32 s2, 256
    s_cbranch_scc1 mk_END
    s_load_dwordx16 s[64:79], s[0:1], 0
    s_load_dwordx16 s[80:95], s[0:1], 64
    s_load_dwordx2 s[96:97], s[0:1], 128
    s_getpc_b64 s[60:61]
mk_PC:
    s_sub_u32 s60, s60, mk_PC-mk_kernel
    s_subb_u32 s61, s61, 0
    v_bfe_u32 v50, v0, 6, 2
    v_and_b32 v51, 15, v0
    s_lshr_b32 s3, s2, 3
    s_and_b32 s3, s3, 7
    s_lshl_b32 s3, s3, 13
    v_lshl_add_u32 v50, v50, 4, v51
    v_lshl_add_u32 v50, v50, 7, s3
    v_min_u32 v51, mk_CE-mk_kernel-4, v50
    v_mov_b32 v53, s61
    v_add_co_u32 v52, vcc, s60, v51
    s_nop 1
    v_addc_co_u32 v53, vcc, 0, v53, vcc
    global_load_dword v54, v[52:53], off
mk_CPE:
    v_lshrrev_b32 v1, 6, v0
    v_and_b32 v0, 63, v0
    s_and_b32 s3, s2, 7
    v_readfirstlane_b32 s40, v1
    s_nop 0
    s_lshr_b32 s14, s2, 3
    s_and_b32 s41, s3, 1
    s_lshl_b32 s41, s41, 2
    s_and_b32 s15, s14, 3
    s_add_u32 s41, s41, s15
    s_lshr_b32 s3, s3, 1
    s_lshl_b32 s42, s3, 3
    s_lshr_b32 s14, s14, 2
    s_add_u32 s42, s42, s14
    s_lshr_b32 s59, s2, 2
    s_add_u32 s59, s59, 512
    s_lshl_b32 s60, s2, 1
    s_add_u32 s60, s60, s40
    s_cmp_lt_u32 s40, 2
    s_cselect_b32 s57, s60, s59
    s_lshl_b32 s60, s57, 8
    v_lshlrev_b32 v7, 2, v0
    v_add_u32 v7, s60, v7
    s_lshr_b32 s43, s42, 2
    s_and_b32 s44, s42, 3
    s_mul_i32 s46, s43, 9
    s_lshl_b32 s14, s44, 1
    s_add_u32 s14, s14, s46
    s_lshl_b32 s45, s14, 7
    s_mul_i32 s62, s41, 294912
    v_lshrrev_b32 v1, 3, v0
    v_and_b32 v2, 7, v0
    v_lshrrev_b32 v3, 1, v1
    v_xor_b32 v4, v2, v3
    v_lshlrev_b32 v4, 4, v4
    v_mul_u32_u24 v5, 1152, v1
    v_xor_b32 v6, 64, v4
    v_add3_u32 v100, v5, v4, s62
    v_add3_u32 v101, v5, v6, s62
    v_add_u32 v102, 16384, v100
    v_add_u32 v101, 8192, v101
    v_add_u32 v103, 16384, v101
    s_add_u32 s60, s45, 4096
    v_and_b32 v3, 1, v3
    v_lshlrev_b32 v3, 5, v3
    v_lshlrev_b32 v4, 4, v2
    v_xor_b32 v4, v4, v3
    v_xor_b32 v6, 64, v4
    v_mul_u32_u24 v5, 9216, v1
    v_add3_u32 v96, v5, v4, s60
    v_add3_u32 v98, v5, v6, s60
    v_add_u32 v97, 72704, v96
    v_add_u32 v99, 70656, v98
    v_subrev_u32 v98, 2048, v98
    s_and_b32 s60, s42, 7
    s_mul_i32 s60, s60, 1
    s_and_b32 s63, s41, 3
    s_mul_i32 s63, s63, 2
    s_add_u32 s60, s60, s63
    s_mul_i32 s63, s60, 114
    s_lshr_b32 s63, s63, 10
    s_mul_i32 s63, s63, 9
    s_sub_u32 s60, s60, s63
    s_mul_i32 s4, s60, 128
    s_and_b32 s58, s57, 0xfffffffe
    s_lshl_b32 s58, s58, 1
    s_and_b32 s59, s59, 0xfffffffe
    s_lshl_b32 s59, s59, 1
    s_lshl_b32 s60, s2, 2
    s_waitcnt lgkmcnt(0)
    s_cmp_eq_u32 s40, 3
    s_cbranch_scc1 mk_G1
    global_load_dword v1, v7, s[66:67]
    global_load_dword v2, v7, s[68:69]
    global_load_dword v3, v7, s[70:71]
    global_load_dword v4, v7, s[72:73]
    global_load_dword v5, v7, s[74:75]
    global_load_dword v6, v7, s[76:77]
    s_load_dword s62, s[78:79], s58
    s_load_dword s82, s[80:81], s60
    s_load_dword s83, s[80:81], s59
    s_sub_u32 s20, s84, 4096
    s_subb_u32 s21, s85, 0
    s_mov_b32 s22, 5312512
    s_mov_b32 s23, 0x00020000
    s_sub_u32 s24, s86, 4096
    s_subb_u32 s25, s87, 0
    s_mov_b32 s26, 5312512
    s_mov_b32 s27, 0x00020000
    s_mov_b32 s16, s64
    s_mov_b32 s17, s65
    s_mov_b32 s18, 2359296
    s_mov_b32 s19, 0x00020000
    s_branch mk_PB
mk_G1:
    s_load_dword s82, s[80:81], s60
    s_load_dword s83, s[80:81], s59
    s_sub_u32 s20, s84, 4096
    s_subb_u32 s21, s85, 0
    s_mov_b32 s22, 5312512
    s_mov_b32 s23, 0x00020000
    s_sub_u32 s24, s86, 4096
    s_subb_u32 s25, s87, 0
    s_mov_b32 s26, 5312512
    s_mov_b32 s27, 0x00020000
    s_mov_b32 s16, s64
    s_mov_b32 s17, s65
    s_mov_b32 s18, 2359296
    s_mov_b32 s19, 0x00020000
    s_mul_i32 s60, s4, 4608
    s_mov_b32 s3, 65536
    s_mov_b32 s63, s4
    s_mov_b32 s1, 0
mk_SLP0wx0:
    s_mov_b32 m0, s3
    s_add_u32 s54, s63, 36864
    buffer_load_dwordx4 v96, s[20:23], s60 offen offset:0 lds
    buffer_load_dwordx4 v97, s[20:23], s60 offen offset:1024 lds
    buffer_load_dwordx4 v98, s[24:27], s60 offen offset:2048 lds
    buffer_load_dwordx4 v99, s[24:27], s60 offen offset:3072 lds
    s_mov_b32 m0, s1
    s_add_u32 s60, s60, 147456
    buffer_load_dwordx4 v100, s[16:19], s63 offen offset:0 lds
    buffer_load_dwordx4 v101, s[16:19], s63 offen offset:1024 lds
    buffer_load_dwordx4 v102, s[16:19], s63 offen offset:2048 lds
    buffer_load_dwordx4 v103, s[16:19], s63 offen offset:3072 lds
    s_add_u32 m0, s1, 4096
    s_add_u32 s63, s63, 73728
    buffer_load_dwordx4 v100, s[16:19], s54 offen offset:0 lds
    buffer_load_dwordx4 v101, s[16:19], s54 offen offset:1024 lds
    buffer_load_dwordx4 v102, s[16:19], s54 offen offset:2048 lds
    buffer_load_dwordx4 v103, s[16:19], s54 offen offset:3072 lds
    s_add_u32 s3, s3, 4096
    s_add_u32 s1, s1, 16384
    s_cmp_lt_u32 s1, 32768
    s_cbranch_scc1 mk_SLP0wx0
mk_PB:
    s_add_u32 s15, s46, 8
    s_lshl_b32 s46, s15, 7
    s_lshl_b32 s60, s44, 5
    s_add_u32 s46, s46, s60
    s_lshl_b32 s48, s14, 18
    s_lshl_b32 s52, s15, 18
    s_lshl_b32 s55, s40, 14
    s_lshl_b32 s56, s40, 12
    s_add_u32 s56, s56, 65536
    s_lshl_b32 s61, s41, 2
    s_add_u32 s61, s61, s40
    s_mul_i32 s60, s40, 73728
    s_mul_i32 s63, s40, 147456
    s_bitcmp1_b32 s57, 0
    s_cselect_b32 s0, 0, 16
    v_add_u32 v208, s60, v100
    v_add_u32 v212, s63, v96
    v_add_u32 v209, s60, v101
    v_add_u32 v213, s63, v97
    v_add_u32 v210, s60, v102
    v_add_u32 v214, s63, v98
    v_add_u32 v211, s60, v103
    v_add_u32 v215, s63, v99
    s_add_u32 s5, s4, 128
    s_cmp_eq_u32 s5, 1152
    s_cselect_b32 s5, 0, s5
    s_add_u32 s6, s5, 128
    s_cmp_eq_u32 s6, 1152
    s_cselect_b32 s6, 0, s6
    s_add_u32 s7, s6, 128
    s_cmp_eq_u32 s7, 1152
    s_cselect_b32 s7, 0, s7
    s_add_u32 s12, s7, 128
    s_cmp_eq_u32 s12, 1152
    s_cselect_b32 s12, 0, s12
    s_add_u32 s13, s12, 128
    s_cmp_eq_u32 s13, 1152
    s_cselect_b32 s13, 0, s13
    s_add_u32 s14, s13, 128
    s_cmp_eq_u32 s14, 1152
    s_cselect_b32 s14, 0, s14
    s_add_u32 s15, s14, 128
    s_cmp_eq_u32 s15, 1152
    s_cselect_b32 s15, 0, s15
    s_add_u32 s47, s15, 128
    s_cmp_eq_u32 s47, 1152
    s_cselect_b32 s47, 0, s47
    s_and_b32 s3, s42, 1
    s_lshl_b32 s3, s3, 2
    v_lshrrev_b32 v86, 4, v0
    v_and_b32 v89, 7, v0
    v_xor_b32 v86, v86, v89
    v_xor_b32 v86, s3, v86
    v_lshlrev_b32 v252, 4, v86
    s_mul_i32 s3, s40, 36
    s_mul_i32 s63, s2, 18
    v_cmp_gt_u32 vcc, 36, v0
    v_add_u32 v86, s3, v0
    v_lshrrev_b32 v87, 3, v86
    v_add_u32 v87, s63, v87
    v_and_b32 v86, 7, v86
    v_mul_u32_u24 v89, 1152, v87
    v_lshl_add_u32 v89, v86, 4, v89
    v_add_u32 v89, 5120, v89
    v_lshrrev_b32 v90, 1, v86
    v_mul_u32_u24 v90, 147456, v90
    v_lshl_add_u32 v90, v87, 5, v90
    v_and_b32 v86, 1, v86
    v_lshl_add_u32 v90, v86, 4, v90
    v_add_u32 v90, 24707072, v90
    v_mov_b32 v88, 2130706432
    v_cndmask_b32 v169, v88, v89, vcc
    v_cndmask_b32 v168, v88, v90, vcc
    s_movk_i32 s10, 1152
    s_mov_b32 s11, 0x00020000
    s_mov_b32 s8, s90
    s_mov_b32 s9, s91
    s_sub_u32 s36, s88, 4096
    s_subb_u32 s37, s89, 0
    s_mov_b32 s38, 5312512
    s_mov_b32 s39, 0x00020000
    s_mov_b32 s32, s96
    s_mov_b32 s33, s97
    s_mov_b32 s34, 38273024
    s_mov_b32 s35, 0x00020000
    s_add_u32 s49, s48, 0x20000
    s_add_u32 s50, s48, 0x40000
    s_add_u32 s51, s48, 0x60000
    s_lshr_b32 s60, s44, 1
    s_lshl_b32 s60, s60, 17
    s_add_u32 s52, s52, s60
    s_and_b32 s60, s44, 1
    s_lshl_b32 s60, s60, 9
    s_add_u32 s52, s52, s60
    s_mov_b32 s53, 0xbfb8aa3b
    s_lshl_b32 s59, s40, 10
    s_add_u32 s59, s59, 98304
    s_and_b32 s60, s40, 1
    s_cmp_eq_u32 s60, 0
    s_cselect_b32 s28, s20, s24
    s_cselect_b32 s29, s21, s25
    s_mov_b32 s30, 5312512
    s_mov_b32 s31, 0x00020000
    s_lshl_b32 s60, s60, 2
    v_lshrrev_b32 v81, 1, v0
    v_xor_b32 v81, s60, v81
    v_mul_u32_u24 v81, 9216, v81
    v_and_b32 v82, 1, v0
    v_lshlrev_b32 v82, 4, v82
    s_lshr_b32 s60, s40, 1
    s_mul_i32 s60, s60, 294912
    s_add_u32 s60, s60, s46
    s_add_u32 s60, s60, 4096
    v_add3_u32 v216, v81, v82, s60
    v_and_b32 v81, 31, v0
    v_lshrrev_b32 v82, 5, v0
    v_lshrrev_b32 v83, 1, v81
    v_and_b32 v83, 7, v83
    v_xor_b32 v83, v83, v82
    v_lshlrev_b32 v83, 4, v83
    v_lshlrev_b32 v84, 7, v81
    v_add_u32 v84, s55, v84
    v_add_u32 v217, v84, v83
    v_xor_b32 v85, 32, v83
    v_add_u32 v218, v84, v85
    v_xor_b32 v85, 64, v83
    v_add_u32 v219, v84, v85
    v_xor_b32 v85, 0x60, v83
    v_add_u32 v220, v84, v85
    v_lshrrev_b32 v83, 4, v81
    v_lshlrev_b32 v83, 10, v83
    v_lshlrev_b32 v84, 8, v82
    v_and_b32 v85, 15, v81
    v_lshlrev_b32 v85, 4, v85
    s_lshl_b32 s60, s61, 12
    v_add3_u32 v83, v83, v84, v85
    v_add_u32 v225, s60, v83
    v_lshrrev_b32 v81, 4, v0
    v_and_b32 v82, 1, v81
    v_lshrrev_b32 v83, 1, v81
    v_and_b32 v84, 15, v0
    v_lshrrev_b32 v85, 2, v84
    v_and_b32 v86, 3, v84
    v_lshlrev_b32 v87, 11, v82
    v_lshl_add_u32 v87, v83, 10, v87
    v_lshl_add_u32 v87, v85, 7, v87
    v_lshl_add_u32 v87, v86, 3, v87
    v_lshrrev_b32 v88, 1, v85
    v_lshl_add_u32 v88, v82, 1, v88
    v_lshlrev_b32 v88, 5, v88
    v_add_u32 v87, 0x10000, v87
    v_add_u32 v221, v87, v88
    v_xor_b32 v222, 32, v221
    v_xor_b32 v223, 64, v221
    v_xor_b32 v224, 0x60, v221
    v_lshl_add_u32 v87, v83, 3, v85
    v_lshlrev_b32 v88, 2, v82
    v_xor_b32 v87, v87, v88
    v_lshlrev_b32 v87, 5, v87
    v_lshl_add_u32 v87, v86, 3, v87
    v_xor_b32 v88, 0x80, v87
    v_lshlrev_b32 v89, 10, v82
    v_add_u32 v89, 98304, v89
    v_add_u32 v226, v87, v89
    v_add_u32 v227, v88, v89
    v_lshl_add_u32 v87, v81, 4, v85
    v_lshlrev_b32 v87, 7, v87
    v_add_u32 v87, s55, v87
    v_and_b32 v88, 1, v84
    v_lshl_add_u32 v87, v88, 3, v87
    v_lshrrev_b32 v88, 1, v86
    s_lshl_b32 s60, s44, 1
    v_add_u32 v88, s60, v88
    v_lshrrev_b32 v89, 3, v84
    v_xor_b32 v88, v88, v89
    v_lshlrev_b32 v88, 4, v88
    v_xor_b32 v89, 0, v88
    v_add_u32 v89, 0, v89
    v_add_u32 v244, v87, v89
    v_xor_b32 v89, 32, v88
    v_add_u32 v89, 512, v89
    v_add_u32 v245, v87, v89
    v_xor_b32 v89, 64, v88
    v_add_u32 v89, 1024, v89
    v_add_u32 v246, v87, v89
    v_xor_b32 v89, 96, v88
    v_add_u32 v89, 1536, v89
    v_add_u32 v247, v87, v89
    v_mul_u32_u24 v87, 4224, v84
    v_lshl_add_u32 v87, v81, 5, v87
    s_lshl_b32 s60, s61, 7
    v_add_u32 v230, s60, v87
    s_lshr_b32 s60, s4, 7
    s_add_u32 s63, s43, 9
    s_sub_u32 s63, s63, s60
    s_cmp_ge_u32 s63, 9
    s_cselect_b32 s58, 9, 0
    s_sub_u32 s63, s63, s58
    s_lshl_b32 s58, 1, s63
    s_sub_u32 s63, 8, s60
    s_lshl_b32 s63, 1, s63
    s_cmp_lt_u32 s42, 4
    s_cselect_b32 s63, s63, 0
    s_or_b32 s58, s58, s63
    s_mul_i32 s60, s57, 4224
    s_add_u32 s60, s60, 18874368
    s_lshl_b32 s63, s2, 7
    s_add_u32 s63, s63, 25329664
    s_cmp_lt_u32 s2, 16
    s_cselect_b32 s63, s63, 2130706432
    s_cmp_eq_u32 s40, 3
    s_cselect_b32 s60, s63, s60
    v_lshlrev_b32 v87, 4, v0
    v_add_u32 v86, s60, v87
    v_mov_b32 v88, 2130706432
    v_cmp_gt_u32 vcc, 8, v0
    v_mov_b32 v164, 0
    v_mov_b32 v165, 0
    v_mov_b32 v166, 0
    v_mov_b32 v167, 0
    v_cndmask_b32 v163, v88, v86, vcc
    s_lshl_b32 s60, s61, 2
    s_lshr_b32 s63, s42, 3
    s_add_u32 s60, s60, s63
    s_lshl_b32 s60, s60, 7
    s_and_b32 s63, s42, 7
    s_lshl_b32 s3, s63, 2
    s_add_u32 s60, s60, s3
    s_add_u32 s60, s60, 25296896
    v_mov_b32 v89, s60
    v_cmp_eq_u32 vcc, 0, v0
    s_nop 0
    s_mul_i32 s57, s42, 67584
    s_add_u32 s57, s57, 18874496
    v_cndmask_b32 v228, v88, v89, vcc
    s_lshl_b32 s60, s63, 10
    s_add_u32 s60, s60, s55
    v_add_u32 v251, s60, v87
    s_lshl_b32 s60, s61, 3
    s_add_u32 s60, s60, s63
    s_lshl_b32 s60, s60, 5
    s_add_u32 s60, s60, 24641536
    s_lshr_b32 s63, s42, 3
    s_cmp_eq_u32 s63, s40
    s_cselect_b32 s60, s60, 2130706432
    v_lshrrev_b32 v86, 3, v0
    v_lshl_add_u32 v254, v86, 2, s60
    v_mov_b32 v249, 0
    v_mov_b32 v250, 0
    s_cmp_eq_u32 s40, 3
    s_cbranch_scc0 mk_KG
    s_mul_i32 s60, s4, 4608
    s_mov_b32 s3, 73728
    s_add_u32 s60, s60, 294912
    s_add_u32 s63, s4, 147456
    s_mov_b32 s1, 32768
mk_SLP0wx2:
    s_mov_b32 m0, s3
    s_add_u32 s54, s63, 36864
    buffer_load_dwordx4 v96, s[20:23], s60 offen offset:0 lds
    buffer_load_dwordx4 v97, s[20:23], s60 offen offset:1024 lds
    buffer_load_dwordx4 v98, s[24:27], s60 offen offset:2048 lds
    buffer_load_dwordx4 v99, s[24:27], s60 offen offset:3072 lds
    s_mov_b32 m0, s1
    s_add_u32 s60, s60, 147456
    buffer_load_dwordx4 v100, s[16:19], s63 offen offset:0 lds
    buffer_load_dwordx4 v101, s[16:19], s63 offen offset:1024 lds
    buffer_load_dwordx4 v102, s[16:19], s63 offen offset:2048 lds
    buffer_load_dwordx4 v103, s[16:19], s63 offen offset:3072 lds
    s_add_u32 m0, s1, 4096
    s_add_u32 s63, s63, 73728
    buffer_load_dwordx4 v100, s[16:19], s54 offen offset:0 lds
    buffer_load_dwordx4 v101, s[16:19], s54 offen offset:1024 lds
    buffer_load_dwordx4 v102, s[16:19], s54 offen offset:2048 lds
    buffer_load_dwordx4 v103, s[16:19], s54 offen offset:3072 lds
    s_add_u32 s3, s3, 4096
    s_add_u32 s1, s1, 16384
    s_cmp_lt_u32 s1, 65536
    s_cbranch_scc1 mk_SLP0wx2
    s_mul_i32 s60, s5, 4608
    s_mov_b32 s3, 81920
mk_SLP1w0:
    s_mov_b32 m0, s3
    s_add_u32 s3, s3, 4096
    buffer_load_dwordx4 v96, s[20:23], s60 offen offset:0 lds
    buffer_load_dwordx4 v97, s[20:23], s60 offen offset:1024 lds
    buffer_load_dwordx4 v98, s[24:27], s60 offen offset:2048 lds
    buffer_load_dwordx4 v99, s[24:27], s60 offen offset:3072 lds
    s_add_u32 s60, s60, 147456
    s_cmp_lt_u32 s3, 98304
    s_cbranch_scc1 mk_SLP1w0
    v_mul_u32_u24 v81, 1152, v0
    v_mul_u32_u24 v82, 9216, v0
    v_lshlrev_b32 v83, 7, v0
    s_and_b32 s60, s41, 3
    s_and_b32 s63, s42, 7
    s_lshl_b32 s1, s60, 1
    s_sub_u32 s1, s1, 1
    s_cselect_b32 s1, 8, s1
    s_lshl_b32 s1, s1, 7
    s_lshl_b32 s3, s41, 3
    s_add_u32 s3, s3, s63
    s_mul_i32 s3, s3, 36864
    s_add_u32 s1, s1, s3
    s_sub_u32 s63, s63, 1
    s_cselect_b32 s63, 8, s63
    s_lshl_b32 s63, s63, 2
    s_add_u32 s63, s63, s60
    s_mul_i32 s63, s63, 147456
    s_add_u32 s63, s63, s45
    s_add_u32 s63, s63, 4096
    s_mul_i32 s3, s2, 20736
    s_add_u32 s3, s3, 5120
    s_mov_b32 exec_hi, 0
    buffer_load_dword v253, v81, s[16:19], s1 offen
    s_mov_b32 exec_lo, 0x3ffff
    buffer_load_dword v253, v81, s[36:39], s3 offen
    s_mov_b32 exec_lo, 0xffff
    buffer_load_dword v253, v82, s[20:23], s63 offen
    buffer_load_dword v253, v82, s[24:27], s63 offen
    buffer_load_dword v253, v83, s[8:11], 0 offen
    s_mov_b64 exec, -1
    s_mov_b32 s63, s5
    s_mov_b32 s1, 8192
mk_SLP1x0:
    s_mov_b32 m0, s1
    s_add_u32 s54, s63, 36864
    buffer_load_dwordx4 v100, s[16:19], s63 offen offset:0 lds
    buffer_load_dwordx4 v101, s[16:19], s63 offen offset:1024 lds
    buffer_load_dwordx4 v102, s[16:19], s63 offen offset:2048 lds
    buffer_load_dwordx4 v103, s[16:19], s63 offen offset:3072 lds
    s_add_u32 s63, s63, 73728
    s_add_u32 s1, s1, 16384
    s_cmp_lt_u32 s1, 65536
    s_cbranch_scc1 mk_SLP1x0
    v_mov_b32 v160, 2130706432
    v_mov_b32 v161, 2130706432
    v_mov_b32 v162, 2130706432
    s_waitcnt lgkmcnt(0)
    s_lshl_b32 s66, s82, 16
    s_and_b32 s67, s82, 0xffff0000
    s_bitcmp1_b32 s2, 2
    s_cselect_b32 s3, 0, 16
    s_lshl_b32 s68, s83, s3
    s_and_b32 s68, s68, 0xffff0000
    s_branch mk_JOIN
mk_KG:
    s_mul_i32 s60, s40, 16896
    s_add_u32 s60, s60, 98304
    v_lshlrev_b32 v202, 3, v0
    v_add_u32 v202, s60, v202
    v_and_b32 v60, 31, v0
    v_lshrrev_b32 v61, 5, v0
    v_mul_u32_u24 v62, 528, v60
    v_lshl_add_u32 v62, v61, 4, v62
    v_add_u32 v203, s60, v62
    s_mul_i32 s60, s2, 3
    s_add_u32 s60, s60, s40
    s_lshl_b32 s60, s60, 12
    s_add_u32 s60, s60, 21495808
    v_lshlrev_b32 v60, 4, v60
    v_sub_u32 v60, s60, v60
    v_lshlrev_b32 v63, 3, v61
    v_sub_u32 v160, v60, v63
    v_lshlrev_b32 v63, 9, v61
    v_sub_u32 v161, v60, v63
    v_lshlrev_b32 v63, 10, v61
    v_sub_u32 v162, v60, v63
    s_waitcnt lgkmcnt(0)
    s_lshl_b32 s62, s62, s0
    s_and_b32 s62, s62, 0xffff0000
    s_lshl_b32 s66, s82, 16
    s_and_b32 s67, s82, 0xffff0000
    s_bitcmp1_b32 s2, 2
    s_cselect_b32 s3, 0, 16
    s_lshl_b32 s68, s83, s3
    s_and_b32 s68, s68, 0xffff0000
    v_mov_b32 v32, s62
    s_mov_b32 s69, 1069066811
    v_mul_f32 v33, s69, v32
    v_fma_f32 v34, v32, s69, -v33
    s_mov_b32 s70, 0x32a5705f
    v_fma_f32 v34, v32, s70, v34
    v_exp_f32 v33, v33
    v_mul_f32 v34, 0x3f317218, v34
    v_fma_f32 v33, v33, v34, v33
    v_cvt_pk_bf16_f32 v33, v33, v33
    v_lshlrev_b32 v32, 16, v33
    s_waitcnt vmcnt(0)
    v_lshlrev_b32 v34, 16, v1
    v_lshlrev_b32 v36, 16, v2
    v_and_b32 v35, 0xffff0000, v1
    v_and_b32 v37, 0xffff0000, v2
    v_mul_f32 v34, v32, v34
    v_mul_f32 v36, v32, v36
    v_mul_f32 v35, v32, v35
    v_mul_f32 v37, v32, v37
    v_mul_f32 v34, s69, v34
    v_mul_f32 v36, 0.15915494, v36
    v_mul_f32 v35, s69, v35
    v_mul_f32 v37, 0.15915494, v37
    s_mov_b32 s71, 0x41000000
    s_mov_b32 s72, 0x43800000
    v_mul_f32 v38, s71, v34
    v_mul_f32 v39, s71, v36
    v_exp_f32 v38, v38
    v_fract_f32 v39, v39
    v_mul_f32 v40, s71, v35
    v_mul_f32 v41, s71, v37
    v_exp_f32 v40, v40
    v_fract_f32 v41, v41
    v_exp_f32 v42, v34
    v_fract_f32 v43, v36
    v_exp_f32 v44, v35
    v_fract_f32 v45, v37
    v_mul_f32 v46, s72, v34
    v_mul_f32 v47, s72, v36
    v_exp_f32 v46, v46
    v_fract_f32 v47, v47
    v_mul_f32 v48, s72, v35
    v_mul_f32 v49, s72, v37
    v_exp_f32 v48, v48
    v_fract_f32 v49, v49
    v_cos_f32 v60, v39
    v_sin_f32 v61, v39
    v_cos_f32 v62, v41
    v_sin_f32 v63, v41
    v_cos_f32 v64, v43
    v_sin_f32 v65, v43
    v_cos_f32 v66, v45
    v_sin_f32 v67, v45
    v_cos_f32 v68, v47
    v_sin_f32 v69, v47
    v_cos_f32 v70, v49
    v_sin_f32 v71, v49
    v_mul_f32 v60, v38, v60
    v_mul_f32 v61, v38, v61
    v_mul_f32 v62, v40, v62
    v_mul_f32 v63, v40, v63
    v_mul_f32 v64, v42, v64
    v_mul_f32 v65, v42, v65
    v_mul_f32 v66, v44, v66
    v_mul_f32 v67, v44, v67
    v_mul_f32 v68, v46, v68
    v_mul_f32 v69, v46, v69
    v_mul_f32 v70, v48, v70
    v_mul_f32 v71, v48, v71
    v_lshlrev_b32 v72, 16, v3
    v_lshlrev_b32 v73, 16, v4
    v_lshlrev_b32 v76, 16, v5
    v_lshlrev_b32 v77, 16, v6
    v_and_b32 v74, 0xffff0000, v3
    v_and_b32 v75, 0xffff0000, v4
    v_and_b32 v78, 0xffff0000, v5
    v_and_b32 v79, 0xffff0000, v6
    v_mul_f32 v72, v32, v72
    v_mul_f32 v73, v32, v73
    v_mul_f32 v74, v32, v74
    v_mul_f32 v75, v32, v75
    v_pk_mul_f32 v[80:81], v[60:61], v[60:61] op_sel_hi:[0,1]
    v_pk_mul_f32 v[82:83], v[62:63], v[62:63] op_sel_hi:[0,1]
    v_pk_mul_f32 v[84:85], v[76:77], v[72:73] op_sel_hi:[0,1]
    v_pk_mul_f32 v[86:87], v[78:79], v[74:75] op_sel_hi:[0,1]
    v_pk_mul_f32 v[88:89], v[64:65], v[64:65] op_sel_hi:[0,1]
    v_pk_mul_f32 v[90:91], v[66:67], v[66:67] op_sel_hi:[0,1]
    v_pk_fma_f32 v[80:81], v[60:61], v[60:61], v[80:81] op_sel:[1,1,0] op_sel_hi:[1,0,1] neg_lo:[1,0,0]
    v_pk_fma_f32 v[82:83], v[62:63], v[62:63], v[82:83] op_sel:[1,1,0] op_sel_hi:[1,0,1] neg_lo:[1,0,0]
    v_pk_fma_f32 v[84:85], v[76:77], v[72:73], v[84:85] op_sel:[1,1,0] op_sel_hi:[1,0,1] neg_lo:[1,0,0]
    v_pk_fma_f32 v[86:87], v[78:79], v[74:75], v[86:87] op_sel:[1,1,0] op_sel_hi:[1,0,1] neg_lo:[1,0,0]
    v_pk_fma_f32 v[88:89], v[64:65], v[64:65], v[88:89] op_sel:[1,1,0] op_sel_hi:[1,0,1] neg_lo:[1,0,0]
    v_pk_fma_f32 v[90:91], v[66:67], v[66:67], v[90:91] op_sel:[1,1,0] op_sel_hi:[1,0,1] neg_lo:[1,0,0]
    v_mov_b32 v200, 0x3f80
    v_mov_b32 v201, 0x3f80
    ds_write_b64 v202, v[200:201]
    v_cvt_pk_bf16_f32 v192, v60, v61
    v_cvt_pk_bf16_f32 v193, v62, v63
    ds_write_b64 v202, v[192:193] offset:528
    v_cvt_pk_bf16_f32 v194, v80, v81
    v_cvt_pk_bf16_f32 v195, v82, v83
    ds_write_b64 v202, v[194:195] offset:1056
    v_pk_mul_f32 v[92:93], v[60:61], v[80:81] op_sel_hi:[0,1]
    v_pk_mul_f32 v[94:95], v[62:63], v[82:83] op_sel_hi:[0,1]
    v_pk_mul_f32 v[96:97], v[80:81], v[80:81] op_sel_hi:[0,1]
    v_pk_mul_f32 v[98:99], v[82:83], v[82:83] op_sel_hi:[0,1]
    v_pk_mul_f32 v[100:101], v[88:89], v[88:89] op_sel_hi:[0,1]
    v_pk_mul_f32 v[102:103], v[90:91], v[90:91] op_sel_hi:[0,1]
    v_pk_fma_f32 v[92:93], v[60:61], v[80:81], v[92:93] op_sel:[1,1,0] op_sel_hi:[1,0,1] neg_lo:[1,0,0]
    v_pk_fma_f32 v[94:95], v[62:63], v[82:83], v[94:95] op_sel:[1,1,0] op_sel_hi:[1,0,1] neg_lo:[1,0,0]
    v_pk_fma_f32 v[96:97], v[80:81], v[80:81], v[96:97] op_sel:[1,1,0] op_sel_hi:[1,0,1] neg_lo:[1,0,0]
    v_pk_fma_f32 v[98:99], v[82:83], v[82:83], v[98:99] op_sel:[1,1,0] op_sel_hi:[1,0,1] neg_lo:[1,0,0]
    v_pk_fma_f32 v[100:101], v[88:89], v[88:89], v[100:101] op_sel:[1,1,0] op_sel_hi:[1,0,1] neg_lo:[1,0,0]
    v_pk_fma_f32 v[102:103], v[90:91], v[90:91], v[102:103] op_sel:[1,1,0] op_sel_hi:[1,0,1] neg_lo:[1,0,0]
    v_pk_mul_f32 v[104:105], v[92:93], v[80:81] op_sel_hi:[0,1]
    v_pk_mul_f32 v[106:107], v[94:95], v[82:83] op_sel_hi:[0,1]
    v_pk_mul_f32 v[108:109], v[96:97], v[80:81] op_sel_hi:[0,1]
    v_pk_mul_f32 v[110:111], v[98:99], v[82:83] op_sel_hi:[0,1]
    v_pk_fma_f32 v[104:105], v[92:93], v[80:81], v[104:105] op_sel:[1,1,0] op_sel_hi:[1,0,1] neg_lo:[1,0,0]
    v_pk_fma_f32 v[106:107], v[94:95], v[82:83], v[106:107] op_sel:[1,1,0] op_sel_hi:[1,0,1] neg_lo:[1,0,0]
    v_pk_fma_f32 v[108:109], v[96:97], v[80:81], v[108:109] op_sel:[1,1,0] op_sel_hi:[1,0,1] neg_lo:[1,0,0]
    v_pk_fma_f32 v[110:111], v[98:99], v[82:83], v[110:111] op_sel:[1,1,0] op_sel_hi:[1,0,1] neg_lo:[1,0,0]
    v_cvt_pk_bf16_f32 v196, v92, v93
    v_cvt_pk_bf16_f32 v197, v94, v95
    ds_write_b64 v202, v[196:197] offset:1584
    v_cvt_pk_bf16_f32 v198, v96, v97
    v_cvt_pk_bf16_f32 v199, v98, v99
    ds_write_b64 v202, v[198:199] offset:2112
    v_pk_mul_f32 v[112:113], v[104:105], v[80:81] op_sel_hi:[0,1]
    v_pk_mul_f32 v[114:115], v[106:107], v[82:83] op_sel_hi:[0,1]
    v_pk_mul_f32 v[116:117], v[108:109], v[80:81] op_sel_hi:[0,1]
    v_pk_mul_f32 v[118:119], v[110:111], v[82:83] op_sel_hi:[0,1]
    v_pk_fma_f32 v[112:113], v[104:105], v[80:81], v[112:113] op_sel:[1,1,0] op_sel_hi:[1,0,1] neg_lo:[1,0,0]
    v_pk_fma_f32 v[114:115], v[106:107], v[82:83], v[114:115] op_sel:[1,1,0] op_sel_hi:[1,0,1] neg_lo:[1,0,0]
    v_pk_fma_f32 v[116:117], v[108:109], v[80:81], v[116:117] op_sel:[1,1,0] op_sel_hi:[1,0,1] neg_lo:[1,0,0]
    v_pk_fma_f32 v[118:119], v[110:111], v[82:83], v[118:119] op_sel:[1,1,0] op_sel_hi:[1,0,1] neg_lo:[1,0,0]
    v_cvt_pk_bf16_f32 v192, v104, v105
    v_cvt_pk_bf16_f32 v193, v106, v107
    ds_write_b64 v202, v[192:193] offset:2640
    v_cvt_pk_bf16_f32 v194, v108, v109
    v_cvt_pk_bf16_f32 v195, v110, v111
    ds_write_b64 v202, v[194:195] offset:3168
    v_pk_mul_f32 v[120:121], v[112:113], v[80:81] op_sel_hi:[0,1]
    v_pk_mul_f32 v[122:123], v[114:115], v[82:83] op_sel_hi:[0,1]
    v_pk_mul_f32 v[124:125], v[116:117], v[80:81] op_sel_hi:[0,1]
    v_pk_mul_f32 v[126:127], v[118:119], v[82:83] op_sel_hi:[0,1]
    v_pk_fma_f32 v[120:121], v[112:113], v[80:81], v[120:121] op_sel:[1,1,0] op_sel_hi:[1,0,1] neg_lo:[1,0,0]
    v_pk_fma_f32 v[122:123], v[114:115], v[82:83], v[122:123] op_sel:[1,1,0] op_sel_hi:[1,0,1] neg_lo:[1,0,0]
    v_pk_fma_f32 v[124:125], v[116:117], v[80:81], v[124:125] op_sel:[1,1,0] op_sel_hi:[1,0,1] neg_lo:[1,0,0]
    v_pk_fma_f32 v[126:127], v[118:119], v[82:83], v[126:127] op_sel:[1,1,0] op_sel_hi:[1,0,1] neg_lo:[1,0,0]
    v_cvt_pk_bf16_f32 v196, v112, v113
    v_cvt_pk_bf16_f32 v197, v114, v115
    ds_write_b64 v202, v[196:197] offset:3696
    v_cvt_pk_bf16_f32 v198, v116, v117
    v_cvt_pk_bf16_f32 v199, v118, v119
    ds_write_b64 v202, v[198:199] offset:4224
    v_pk_mul_f32 v[8:9], v[120:121], v[80:81] op_sel_hi:[0,1]
    v_pk_mul_f32 v[10:11], v[122:123], v[82:83] op_sel_hi:[0,1]
    v_pk_mul_f32 v[12:13], v[124:125], v[80:81] op_sel_hi:[0,1]
    v_pk_mul_f32 v[14:15], v[126:127], v[82:83] op_sel_hi:[0,1]
    v_pk_fma_f32 v[8:9], v[120:121], v[80:81], v[8:9] op_sel:[1,1,0] op_sel_hi:[1,0,1] neg_lo:[1,0,0]
    v_pk_fma_f32 v[10:11], v[122:123], v[82:83], v[10:11] op_sel:[1,1,0] op_sel_hi:[1,0,1] neg_lo:[1,0,0]
    v_pk_fma_f32 v[12:13], v[124:125], v[80:81], v[12:13] op_sel:[1,1,0] op_sel_hi:[1,0,1] neg_lo:[1,0,0]
    v_pk_fma_f32 v[14:15], v[126:127], v[82:83], v[14:15] op_sel:[1,1,0] op_sel_hi:[1,0,1] neg_lo:[1,0,0]
    v_cvt_pk_bf16_f32 v192, v120, v121
    v_cvt_pk_bf16_f32 v193, v122, v123
    ds_write_b64 v202, v[192:193] offset:4752
    v_cvt_pk_bf16_f32 v194, v124, v125
    v_cvt_pk_bf16_f32 v195, v126, v127
    ds_write_b64 v202, v[194:195] offset:5280
    v_pk_mul_f32 v[16:17], v[8:9], v[80:81] op_sel_hi:[0,1]
    v_pk_mul_f32 v[18:19], v[10:11], v[82:83] op_sel_hi:[0,1]
    v_pk_mul_f32 v[20:21], v[12:13], v[80:81] op_sel_hi:[0,1]
    v_pk_mul_f32 v[22:23], v[14:15], v[82:83] op_sel_hi:[0,1]
    v_pk_fma_f32 v[16:17], v[8:9], v[80:81], v[16:17] op_sel:[1,1,0] op_sel_hi:[1,0,1] neg_lo:[1,0,0]
    v_pk_fma_f32 v[18:19], v[10:11], v[82:83], v[18:19] op_sel:[1,1,0] op_sel_hi:[1,0,1] neg_lo:[1,0,0]
    v_pk_fma_f32 v[20:21], v[12:13], v[80:81], v[20:21] op_sel:[1,1,0] op_sel_hi:[1,0,1] neg_lo:[1,0,0]
    v_pk_fma_f32 v[22:23], v[14:15], v[82:83], v[22:23] op_sel:[1,1,0] op_sel_hi:[1,0,1] neg_lo:[1,0,0]
    v_cvt_pk_bf16_f32 v196, v8, v9
    v_cvt_pk_bf16_f32 v197, v10, v11
    ds_write_b64 v202, v[196:197] offset:5808
    v_cvt_pk_bf16_f32 v198, v12, v13
    v_cvt_pk_bf16_f32 v199, v14, v15
    ds_write_b64 v202, v[198:199] offset:6336
    v_pk_mul_f32 v[24:25], v[16:17], v[80:81] op_sel_hi:[0,1]
    v_pk_mul_f32 v[26:27], v[18:19], v[82:83] op_sel_hi:[0,1]
    v_pk_mul_f32 v[28:29], v[20:21], v[80:81] op_sel_hi:[0,1]
    v_pk_mul_f32 v[30:31], v[22:23], v[82:83] op_sel_hi:[0,1]
    v_pk_fma_f32 v[24:25], v[16:17], v[80:81], v[24:25] op_sel:[1,1,0] op_sel_hi:[1,0,1] neg_lo:[1,0,0]
    v_pk_fma_f32 v[26:27], v[18:19], v[82:83], v[26:27] op_sel:[1,1,0] op_sel_hi:[1,0,1] neg_lo:[1,0,0]
    v_pk_fma_f32 v[28:29], v[20:21], v[80:81], v[28:29] op_sel:[1,1,0] op_sel_hi:[1,0,1] neg_lo:[1,0,0]
    v_pk_fma_f32 v[30:31], v[22:23], v[82:83], v[30:31] op_sel:[1,1,0] op_sel_hi:[1,0,1] neg_lo:[1,0,0]
    v_cvt_pk_bf16_f32 v192, v16, v17
    v_cvt_pk_bf16_f32 v193, v18, v19
    ds_write_b64 v202, v[192:193] offset:6864
    v_cvt_pk_bf16_f32 v194, v20, v21
    v_cvt_pk_bf16_f32 v195, v22, v23
    ds_write_b64 v202, v[194:195] offset:7392
    v_pk_mul_f32 v[144:145], v[24:25], v[80:81] op_sel_hi:[0,1]
    v_pk_mul_f32 v[146:147], v[26:27], v[82:83] op_sel_hi:[0,1]
    v_pk_mul_f32 v[148:149], v[28:29], v[80:81] op_sel_hi:[0,1]
    v_pk_mul_f32 v[150:151], v[30:31], v[82:83] op_sel_hi:[0,1]
    v_pk_fma_f32 v[144:145], v[24:25], v[80:81], v[144:145] op_sel:[1,1,0] op_sel_hi:[1,0,1] neg_lo:[1,0,0]
    v_pk_fma_f32 v[146:147], v[26:27], v[82:83], v[146:147] op_sel:[1,1,0] op_sel_hi:[1,0,1] neg_lo:[1,0,0]
    v_pk_fma_f32 v[148:149], v[28:29], v[80:81], v[148:149] op_sel:[1,1,0] op_sel_hi:[1,0,1] neg_lo:[1,0,0]
    v_pk_fma_f32 v[150:151], v[30:31], v[82:83], v[150:151] op_sel:[1,1,0] op_sel_hi:[1,0,1] neg_lo:[1,0,0]
    v_cvt_pk_bf16_f32 v196, v24, v25
    v_cvt_pk_bf16_f32 v197, v26, v27
    ds_write_b64 v202, v[196:197] offset:7920
    v_cvt_pk_bf16_f32 v198, v28, v29
    v_cvt_pk_bf16_f32 v199, v30, v31
    ds_write_b64 v202, v[198:199] offset:8448
    v_pk_mul_f32 v[152:153], v[144:145], v[80:81] op_sel_hi:[0,1]
    v_pk_mul_f32 v[154:155], v[146:147], v[82:83] op_sel_hi:[0,1]
    v_pk_mul_f32 v[156:157], v[148:149], v[80:81] op_sel_hi:[0,1]
    v_pk_mul_f32 v[158:159], v[150:151], v[82:83] op_sel_hi:[0,1]
    v_pk_fma_f32 v[152:153], v[144:145], v[80:81], v[152:153] op_sel:[1,1,0] op_sel_hi:[1,0,1] neg_lo:[1,0,0]
    v_pk_fma_f32 v[154:155], v[146:147], v[82:83], v[154:155] op_sel:[1,1,0] op_sel_hi:[1,0,1] neg_lo:[1,0,0]
    v_pk_fma_f32 v[156:157], v[148:149], v[80:81], v[156:157] op_sel:[1,1,0] op_sel_hi:[1,0,1] neg_lo:[1,0,0]
    v_pk_fma_f32 v[158:159], v[150:151], v[82:83], v[158:159] op_sel:[1,1,0] op_sel_hi:[1,0,1] neg_lo:[1,0,0]
    v_cvt_pk_bf16_f32 v192, v144, v145
    v_cvt_pk_bf16_f32 v193, v146, v147
    ds_write_b64 v202, v[192:193] offset:8976
    v_cvt_pk_bf16_f32 v194, v148, v149
    v_cvt_pk_bf16_f32 v195, v150, v151
    ds_write_b64 v202, v[194:195] offset:9504
    v_pk_mul_f32 v[72:73], v[152:153], v[80:81] op_sel_hi:[0,1]
    v_pk_mul_f32 v[74:75], v[154:155], v[82:83] op_sel_hi:[0,1]
    v_pk_mul_f32 v[76:77], v[156:157], v[80:81] op_sel_hi:[0,1]
    v_pk_mul_f32 v[78:79], v[158:159], v[82:83] op_sel_hi:[0,1]
    v_pk_fma_f32 v[72:73], v[152:153], v[80:81], v[72:73] op_sel:[1,1,0] op_sel_hi:[1,0,1] neg_lo:[1,0,0]
    v_pk_fma_f32 v[74:75], v[154:155], v[82:83], v[74:75] op_sel:[1,1,0] op_sel_hi:[1,0,1] neg_lo:[1,0,0]
    v_pk_fma_f32 v[76:77], v[156:157], v[80:81], v[76:77] op_sel:[1,1,0] op_sel_hi:[1,0,1] neg_lo:[1,0,0]
    v_pk_fma_f32 v[78:79], v[158:159], v[82:83], v[78:79] op_sel:[1,1,0] op_sel_hi:[1,0,1] neg_lo:[1,0,0]
    v_cvt_pk_bf16_f32 v196, v152, v153
    v_cvt_pk_bf16_f32 v197, v154, v155
    ds_write_b64 v202, v[196:197] offset:10032
    v_cvt_pk_bf16_f32 v198, v156, v157
    v_cvt_pk_bf16_f32 v199, v158, v159
    ds_write_b64 v202, v[198:199] offset:10560
    v_pk_mul_f32 v[92:93], v[72:73], v[80:81] op_sel_hi:[0,1]
    v_pk_mul_f32 v[94:95], v[74:75], v[82:83] op_sel_hi:[0,1]
    v_pk_mul_f32 v[96:97], v[76:77], v[80:81] op_sel_hi:[0,1]
    v_pk_mul_f32 v[98:99], v[78:79], v[82:83] op_sel_hi:[0,1]
    v_pk_fma_f32 v[92:93], v[72:73], v[80:81], v[92:93] op_sel:[1,1,0] op_sel_hi:[1,0,1] neg_lo:[1,0,0]
    v_pk_fma_f32 v[94:95], v[74:75], v[82:83], v[94:95] op_sel:[1,1,0] op_sel_hi:[1,0,1] neg_lo:[1,0,0]
    v_pk_fma_f32 v[96:97], v[76:77], v[80:81], v[96:97] op_sel:[1,1,0] op_sel_hi:[1,0,1] neg_lo:[1,0,0]
    v_pk_fma_f32 v[98:99], v[78:79], v[82:83], v[98:99] op_sel:[1,1,0] op_sel_hi:[1,0,1] neg_lo:[1,0,0]
    v_cvt_pk_bf16_f32 v192, v72, v73
    v_cvt_pk_bf16_f32 v193, v74, v75
    ds_write_b64 v202, v[192:193] offset:11088
    v_cvt_pk_bf16_f32 v194, v76, v77
    v_cvt_pk_bf16_f32 v195, v78, v79
    ds_write_b64 v202, v[194:195] offset:11616
    v_pk_mul_f32 v[104:105], v[92:93], v[80:81] op_sel_hi:[0,1]
    v_pk_mul_f32 v[106:107], v[94:95], v[82:83] op_sel_hi:[0,1]
    v_pk_mul_f32 v[108:109], v[96:97], v[80:81] op_sel_hi:[0,1]
    v_pk_mul_f32 v[110:111], v[98:99], v[82:83] op_sel_hi:[0,1]
    v_pk_fma_f32 v[104:105], v[92:93], v[80:81], v[104:105] op_sel:[1,1,0] op_sel_hi:[1,0,1] neg_lo:[1,0,0]
    v_pk_fma_f32 v[106:107], v[94:95], v[82:83], v[106:107] op_sel:[1,1,0] op_sel_hi:[1,0,1] neg_lo:[1,0,0]
    v_pk_fma_f32 v[108:109], v[96:97], v[80:81], v[108:109] op_sel:[1,1,0] op_sel_hi:[1,0,1] neg_lo:[1,0,0]
    v_pk_fma_f32 v[110:111], v[98:99], v[82:83], v[110:111] op_sel:[1,1,0] op_sel_hi:[1,0,1] neg_lo:[1,0,0]
    v_cvt_pk_bf16_f32 v196, v92, v93
    v_cvt_pk_bf16_f32 v197, v94, v95
    ds_write_b64 v202, v[196:197] offset:12144
    v_cvt_pk_bf16_f32 v198, v96, v97
    v_cvt_pk_bf16_f32 v199, v98, v99
    ds_write_b64 v202, v[198:199] offset:12672
    v_pk_mul_f32 v[112:113], v[104:105], v[80:81] op_sel_hi:[0,1]
    v_pk_mul_f32 v[114:115], v[106:107], v[82:83] op_sel_hi:[0,1]
    v_pk_mul_f32 v[116:117], v[108:109], v[80:81] op_sel_hi:[0,1]
    v_pk_mul_f32 v[118:119], v[110:111], v[82:83] op_sel_hi:[0,1]
    v_pk_fma_f32 v[112:113], v[104:105], v[80:81], v[112:113] op_sel:[1,1,0] op_sel_hi:[1,0,1] neg_lo:[1,0,0]
    v_pk_fma_f32 v[114:115], v[106:107], v[82:83], v[114:115] op_sel:[1,1,0] op_sel_hi:[1,0,1] neg_lo:[1,0,0]
    v_pk_fma_f32 v[116:117], v[108:109], v[80:81], v[116:117] op_sel:[1,1,0] op_sel_hi:[1,0,1] neg_lo:[1,0,0]
    v_pk_fma_f32 v[118:119], v[110:111], v[82:83], v[118:119] op_sel:[1,1,0] op_sel_hi:[1,0,1] neg_lo:[1,0,0]
    v_cvt_pk_bf16_f32 v192, v104, v105
    v_cvt_pk_bf16_f32 v193, v106, v107
    ds_write_b64 v202, v[192:193] offset:13200
    v_cvt_pk_bf16_f32 v194, v108, v109
    v_cvt_pk_bf16_f32 v195, v110, v111
    ds_write_b64 v202, v[194:195] offset:13728
    v_pk_mul_f32 v[120:121], v[112:113], v[80:81] op_sel_hi:[0,1]
    v_pk_mul_f32 v[122:123], v[114:115], v[82:83] op_sel_hi:[0,1]
    v_pk_mul_f32 v[124:125], v[116:117], v[80:81] op_sel_hi:[0,1]
    v_pk_mul_f32 v[126:127], v[118:119], v[82:83] op_sel_hi:[0,1]
    v_pk_fma_f32 v[120:121], v[112:113], v[80:81], v[120:121] op_sel:[1,1,0] op_sel_hi:[1,0,1] neg_lo:[1,0,0]
    v_pk_fma_f32 v[122:123], v[114:115], v[82:83], v[122:123] op_sel:[1,1,0] op_sel_hi:[1,0,1] neg_lo:[1,0,0]
    v_pk_fma_f32 v[124:125], v[116:117], v[80:81], v[124:125] op_sel:[1,1,0] op_sel_hi:[1,0,1] neg_lo:[1,0,0]
    v_pk_fma_f32 v[126:127], v[118:119], v[82:83], v[126:127] op_sel:[1,1,0] op_sel_hi:[1,0,1] neg_lo:[1,0,0]
    v_cvt_pk_bf16_f32 v196, v112, v113
    v_cvt_pk_bf16_f32 v197, v114, v115
    ds_write_b64 v202, v[196:197] offset:14256
    v_cvt_pk_bf16_f32 v198, v116, v117
    v_cvt_pk_bf16_f32 v199, v118, v119
    ds_write_b64 v202, v[198:199] offset:14784
    v_pk_mul_f32 v[8:9], v[120:121], v[80:81] op_sel_hi:[0,1]
    v_pk_mul_f32 v[10:11], v[122:123], v[82:83] op_sel_hi:[0,1]
    v_pk_fma_f32 v[8:9], v[120:121], v[80:81], v[8:9] op_sel:[1,1,0] op_sel_hi:[1,0,1] neg_lo:[1,0,0]
    v_pk_fma_f32 v[10:11], v[122:123], v[82:83], v[10:11] op_sel:[1,1,0] op_sel_hi:[1,0,1] neg_lo:[1,0,0]
    v_cvt_pk_bf16_f32 v192, v120, v121
    v_cvt_pk_bf16_f32 v193, v122, v123
    ds_write_b64 v202, v[192:193] offset:15312
    v_cvt_pk_bf16_f32 v194, v124, v125
    v_cvt_pk_bf16_f32 v195, v126, v127
    ds_write_b64 v202, v[194:195] offset:15840
    v_cvt_pk_bf16_f32 v196, v8, v9
    v_cvt_pk_bf16_f32 v197, v10, v11
    ds_write_b64 v202, v[196:197] offset:16368
    v_pk_mul_f32 v[12:13], v[84:85], v[64:65] op_sel_hi:[0,1]
    v_pk_mul_f32 v[14:15], v[86:87], v[66:67] op_sel_hi:[0,1]
    v_pk_mul_f32 v[16:17], v[84:85], v[68:69] op_sel_hi:[0,1]
    v_pk_mul_f32 v[18:19], v[86:87], v[70:71] op_sel_hi:[0,1]
    v_pk_fma_f32 v[12:13], v[84:85], v[64:65], v[12:13] op_sel:[1,1,0] op_sel_hi:[1,0,1] neg_lo:[1,0,0]
    v_pk_fma_f32 v[14:15], v[86:87], v[66:67], v[14:15] op_sel:[1,1,0] op_sel_hi:[1,0,1] neg_lo:[1,0,0]
    v_pk_fma_f32 v[16:17], v[84:85], v[68:69], v[16:17] op_sel:[1,1,0] op_sel_hi:[1,0,1] neg_lo:[1,0,0]
    v_pk_fma_f32 v[18:19], v[86:87], v[70:71], v[18:19] op_sel:[1,1,0] op_sel_hi:[1,0,1] neg_lo:[1,0,0]
    ds_read_b128 a[0:3], v203 offset:0
    ds_read_b128 a[4:7], v203 offset:32
    ds_read_b128 a[8:11], v203 offset:64
    ds_read_b128 a[12:15], v203 offset:96
    ds_read_b128 a[16:19], v203 offset:128
    ds_read_b128 a[20:23], v203 offset:160
    ds_read_b128 a[24:27], v203 offset:192
    ds_read_b128 a[28:31], v203 offset:224
    ds_read_b128 a[32:35], v203 offset:256
    ds_read_b128 a[36:39], v203 offset:288
    ds_read_b128 a[40:43], v203 offset:320
    ds_read_b128 a[44:47], v203 offset:352
    ds_read_b128 a[48:51], v203 offset:384
    ds_read_b128 a[52:55], v203 offset:416
    ds_read_b128 a[56:59], v203 offset:448
    ds_read_b128 a[60:63], v203 offset:480
    v_pk_mul_f32 v[20:21], v[12:13], v[64:65] op_sel_hi:[0,1]
    v_pk_mul_f32 v[22:23], v[14:15], v[66:67] op_sel_hi:[0,1]
    v_pk_mul_f32 v[24:25], v[16:17], v[68:69] op_sel_hi:[0,1]
    v_pk_mul_f32 v[26:27], v[18:19], v[70:71] op_sel_hi:[0,1]
    v_pk_mul_f32 v[28:29], v[16:17], v[88:89] op_sel_hi:[0,1]
    v_pk_mul_f32 v[30:31], v[18:19], v[90:91] op_sel_hi:[0,1]
    v_pk_fma_f32 v[20:21], v[12:13], v[64:65], v[20:21] op_sel:[1,1,0] op_sel_hi:[1,0,1] neg_lo:[1,0,0]
    v_pk_fma_f32 v[22:23], v[14:15], v[66:67], v[22:23] op_sel:[1,1,0] op_sel_hi:[1,0,1] neg_lo:[1,0,0]
    v_pk_fma_f32 v[24:25], v[16:17], v[68:69], v[24:25] op_sel:[1,1,0] op_sel_hi:[1,0,1] neg_lo:[1,0,0]
    v_pk_fma_f32 v[26:27], v[18:19], v[70:71], v[26:27] op_sel:[1,1,0] op_sel_hi:[1,0,1] neg_lo:[1,0,0]
    v_pk_fma_f32 v[28:29], v[16:17], v[88:89], v[28:29] op_sel:[1,1,0] op_sel_hi:[1,0,1] neg_lo:[1,0,0]
    v_pk_fma_f32 v[30:31], v[18:19], v[90:91], v[30:31] op_sel:[1,1,0] op_sel_hi:[1,0,1] neg_lo:[1,0,0]
    v_cvt_pk_bf16_f32 v198, v84, -v85
    v_cvt_pk_bf16_f32 v199, v86, -v87
    ds_write_b64 v202, v[198:199] offset:0
    v_pk_mul_f32 v[144:145], v[20:21], v[64:65] op_sel_hi:[0,1]
    v_pk_mul_f32 v[146:147], v[22:23], v[66:67] op_sel_hi:[0,1]
    v_pk_mul_f32 v[148:149], v[24:25], v[68:69] op_sel_hi:[0,1]
    v_pk_mul_f32 v[150:151], v[26:27], v[70:71] op_sel_hi:[0,1]
    v_pk_mul_f32 v[152:153], v[28:29], v[88:89] op_sel_hi:[0,1]
    v_pk_mul_f32 v[154:155], v[30:31], v[90:91] op_sel_hi:[0,1]
    v_pk_mul_f32 v[156:157], v[24:25], v[100:101] op_sel_hi:[0,1]
    v_pk_mul_f32 v[158:159], v[26:27], v[102:103] op_sel_hi:[0,1]
    v_pk_fma_f32 v[144:145], v[20:21], v[64:65], v[144:145] op_sel:[1,1,0] op_sel_hi:[1,0,1] neg_lo:[1,0,0]
    v_pk_fma_f32 v[146:147], v[22:23], v[66:67], v[146:147] op_sel:[1,1,0] op_sel_hi:[1,0,1] neg_lo:[1,0,0]
    v_pk_fma_f32 v[148:149], v[24:25], v[68:69], v[148:149] op_sel:[1,1,0] op_sel_hi:[1,0,1] neg_lo:[1,0,0]
    v_pk_fma_f32 v[150:151], v[26:27], v[70:71], v[150:151] op_sel:[1,1,0] op_sel_hi:[1,0,1] neg_lo:[1,0,0]
    v_pk_fma_f32 v[152:153], v[28:29], v[88:89], v[152:153] op_sel:[1,1,0] op_sel_hi:[1,0,1] neg_lo:[1,0,0]
    v_pk_fma_f32 v[154:155], v[30:31], v[90:91], v[154:155] op_sel:[1,1,0] op_sel_hi:[1,0,1] neg_lo:[1,0,0]
    v_pk_fma_f32 v[156:157], v[24:25], v[100:101], v[156:157] op_sel:[1,1,0] op_sel_hi:[1,0,1] neg_lo:[1,0,0]
    v_pk_fma_f32 v[158:159], v[26:27], v[102:103], v[158:159] op_sel:[1,1,0] op_sel_hi:[1,0,1] neg_lo:[1,0,0]
    v_cvt_pk_bf16_f32 v192, v12, -v13
    v_cvt_pk_bf16_f32 v193, v14, -v15
    ds_write_b64 v202, v[192:193] offset:528
    v_cvt_pk_bf16_f32 v194, v16, -v17
    v_cvt_pk_bf16_f32 v195, v18, -v19
    ds_write_b64 v202, v[194:195] offset:4224
    v_pk_mul_f32 v[72:73], v[144:145], v[64:65] op_sel_hi:[0,1]
    v_pk_mul_f32 v[74:75], v[146:147], v[66:67] op_sel_hi:[0,1]
    v_pk_mul_f32 v[76:77], v[148:149], v[68:69] op_sel_hi:[0,1]
    v_pk_mul_f32 v[78:79], v[150:151], v[70:71] op_sel_hi:[0,1]
    v_pk_mul_f32 v[92:93], v[152:153], v[88:89] op_sel_hi:[0,1]
    v_pk_mul_f32 v[94:95], v[154:155], v[90:91] op_sel_hi:[0,1]
    v_pk_mul_f32 v[96:97], v[156:157], v[100:101] op_sel_hi:[0,1]
    v_pk_mul_f32 v[98:99], v[158:159], v[102:103] op_sel_hi:[0,1]
    v_pk_mul_f32 v[104:105], v[148:149], v[100:101] op_sel_hi:[0,1]
    v_pk_mul_f32 v[106:107], v[150:151], v[102:103] op_sel_hi:[0,1]
    v_pk_fma_f32 v[72:73], v[144:145], v[64:65], v[72:73] op_sel:[1,1,0] op_sel_hi:[1,0,1] neg_lo:[1,0,0]
    v_pk_fma_f32 v[74:75], v[146:147], v[66:67], v[74:75] op_sel:[1,1,0] op_sel_hi:[1,0,1] neg_lo:[1,0,0]
    v_pk_fma_f32 v[76:77], v[148:149], v[68:69], v[76:77] op_sel:[1,1,0] op_sel_hi:[1,0,1] neg_lo:[1,0,0]
    v_pk_fma_f32 v[78:79], v[150:151], v[70:71], v[78:79] op_sel:[1,1,0] op_sel_hi:[1,0,1] neg_lo:[1,0,0]
    v_pk_fma_f32 v[92:93], v[152:153], v[88:89], v[92:93] op_sel:[1,1,0] op_sel_hi:[1,0,1] neg_lo:[1,0,0]
    v_pk_fma_f32 v[94:95], v[154:155], v[90:91], v[94:95] op_sel:[1,1,0] op_sel_hi:[1,0,1] neg_lo:[1,0,0]
    v_pk_fma_f32 v[96:97], v[156:157], v[100:101], v[96:97] op_sel:[1,1,0] op_sel_hi:[1,0,1] neg_lo:[1,0,0]
    v_pk_fma_f32 v[98:99], v[158:159], v[102:103], v[98:99] op_sel:[1,1,0] op_sel_hi:[1,0,1] neg_lo:[1,0,0]
    v_pk_fma_f32 v[104:105], v[148:149], v[100:101], v[104:105] op_sel:[1,1,0] op_sel_hi:[1,0,1] neg_lo:[1,0,0]
    v_pk_fma_f32 v[106:107], v[150:151], v[102:103], v[106:107] op_sel:[1,1,0] op_sel_hi:[1,0,1] neg_lo:[1,0,0]
    v_cvt_pk_bf16_f32 v196, v20, -v21
    v_cvt_pk_bf16_f32 v197, v22, -v23
    ds_write_b64 v202, v[196:197] offset:1056
    v_cvt_pk_bf16_f32 v198, v24, -v25
    v_cvt_pk_bf16_f32 v199, v26, -v27
    ds_write_b64 v202, v[198:199] offset:8448
    v_cvt_pk_bf16_f32 v192, v28, -v29
    v_cvt_pk_bf16_f32 v193, v30, -v31
    ds_write_b64 v202, v[192:193] offset:4752
    v_pk_mul_f32 v[108:109], v[72:73], v[64:65] op_sel_hi:[0,1]
    v_pk_mul_f32 v[110:111], v[74:75], v[66:67] op_sel_hi:[0,1]
    v_pk_mul_f32 v[112:113], v[76:77], v[68:69] op_sel_hi:[0,1]
    v_pk_mul_f32 v[114:115], v[78:79], v[70:71] op_sel_hi:[0,1]
    v_pk_mul_f32 v[116:117], v[92:93], v[88:89] op_sel_hi:[0,1]
    v_pk_mul_f32 v[118:119], v[94:95], v[90:91] op_sel_hi:[0,1]
    v_pk_mul_f32 v[120:121], v[104:105], v[100:101] op_sel_hi:[0,1]
    v_pk_mul_f32 v[122:123], v[106:107], v[102:103] op_sel_hi:[0,1]
    v_pk_mul_f32 v[124:125], v[76:77], v[60:61] op_sel_hi:[0,1]
    v_pk_mul_f32 v[126:127], v[78:79], v[62:63] op_sel_hi:[0,1]
    v_pk_fma_f32 v[108:109], v[72:73], v[64:65], v[108:109] op_sel:[1,1,0] op_sel_hi:[1,0,1] neg_lo:[1,0,0]
    v_pk_fma_f32 v[110:111], v[74:75], v[66:67], v[110:111] op_sel:[1,1,0] op_sel_hi:[1,0,1] neg_lo:[1,0,0]
    v_pk_fma_f32 v[112:113], v[76:77], v[68:69], v[112:113] op_sel:[1,1,0] op_sel_hi:[1,0,1] neg_lo:[1,0,0]
    v_pk_fma_f32 v[114:115], v[78:79], v[70:71], v[114:115] op_sel:[1,1,0] op_sel_hi:[1,0,1] neg_lo:[1,0,0]
    v_pk_fma_f32 v[116:117], v[92:93], v[88:89], v[116:117] op_sel:[1,1,0] op_sel_hi:[1,0,1] neg_lo:[1,0,0]
    v_pk_fma_f32 v[118:119], v[94:95], v[90:91], v[118:119] op_sel:[1,1,0] op_sel_hi:[1,0,1] neg_lo:[1,0,0]
    v_pk_fma_f32 v[120:121], v[104:105], v[100:101], v[120:121] op_sel:[1,1,0] op_sel_hi:[1,0,1] neg_lo:[1,0,0]
    v_pk_fma_f32 v[122:123], v[106:107], v[102:103], v[122:123] op_sel:[1,1,0] op_sel_hi:[1,0,1] neg_lo:[1,0,0]
    v_pk_fma_f32 v[124:125], v[76:77], v[60:61], v[124:125] op_sel:[1,1,0] op_sel_hi:[1,0,1] neg_lo:[1,0,0]
    v_pk_fma_f32 v[126:127], v[78:79], v[62:63], v[126:127] op_sel:[1,1,0] op_sel_hi:[1,0,1] neg_lo:[1,0,0]
    v_cvt_pk_bf16_f32 v194, v144, -v145
    v_cvt_pk_bf16_f32 v195, v146, -v147
    ds_write_b64 v202, v[194:195] offset:1584
    v_cvt_pk_bf16_f32 v196, v148, -v149
    v_cvt_pk_bf16_f32 v197, v150, -v151
    ds_write_b64 v202, v[196:197] offset:10560
    v_cvt_pk_bf16_f32 v198, v152, -v153
    v_cvt_pk_bf16_f32 v199, v154, -v155
    ds_write_b64 v202, v[198:199] offset:5280
    ds_write_b64 v202, v[198:199] offset:6336
    v_cvt_pk_bf16_f32 v192, v156, -v157
    v_cvt_pk_bf16_f32 v193, v158, -v159
    ds_write_b64 v202, v[192:193] offset:8976
    v_pk_mul_f32 v[8:9], v[108:109], v[64:65] op_sel_hi:[0,1]
    v_pk_mul_f32 v[10:11], v[110:111], v[66:67] op_sel_hi:[0,1]
    v_pk_mul_f32 v[80:81], v[112:113], v[68:69] op_sel_hi:[0,1]
    v_pk_mul_f32 v[82:83], v[114:115], v[70:71] op_sel_hi:[0,1]
    v_pk_mul_f32 v[84:85], v[112:113], v[60:61] op_sel_hi:[0,1]
    v_pk_mul_f32 v[86:87], v[114:115], v[62:63] op_sel_hi:[0,1]
    v_pk_fma_f32 v[8:9], v[108:109], v[64:65], v[8:9] op_sel:[1,1,0] op_sel_hi:[1,0,1] neg_lo:[1,0,0]
    v_pk_fma_f32 v[10:11], v[110:111], v[66:67], v[10:11] op_sel:[1,1,0] op_sel_hi:[1,0,1] neg_lo:[1,0,0]
    v_pk_fma_f32 v[80:81], v[112:113], v[68:69], v[80:81] op_sel:[1,1,0] op_sel_hi:[1,0,1] neg_lo:[1,0,0]
    v_pk_fma_f32 v[82:83], v[114:115], v[70:71], v[82:83] op_sel:[1,1,0] op_sel_hi:[1,0,1] neg_lo:[1,0,0]
    v_pk_fma_f32 v[84:85], v[112:113], v[60:61], v[84:85] op_sel:[1,1,0] op_sel_hi:[1,0,1] neg_lo:[1,0,0]
    v_pk_fma_f32 v[86:87], v[114:115], v[62:63], v[86:87] op_sel:[1,1,0] op_sel_hi:[1,0,1] neg_lo:[1,0,0]
    v_cvt_pk_bf16_f32 v194, v72, -v73
    v_cvt_pk_bf16_f32 v195, v74, -v75
    ds_write_b64 v202, v[194:195] offset:2112
    v_cvt_pk_bf16_f32 v196, v76, -v77
    v_cvt_pk_bf16_f32 v197, v78, -v79
    ds_write_b64 v202, v[196:197] offset:12672
    v_cvt_pk_bf16_f32 v198, v92, -v93
    v_cvt_pk_bf16_f32 v199, v94, -v95
    ds_write_b64 v202, v[198:199] offset:6864
    v_cvt_pk_bf16_f32 v192, v96, -v97
    v_cvt_pk_bf16_f32 v193, v98, -v99
    ds_write_b64 v202, v[192:193] offset:9504
    v_cvt_pk_bf16_f32 v194, v104, -v105
    v_cvt_pk_bf16_f32 v195, v106, -v107
    ds_write_b64 v202, v[194:195] offset:11088
    v_pk_mul_f32 v[12:13], v[8:9], v[64:65] op_sel_hi:[0,1]
    v_pk_mul_f32 v[14:15], v[10:11], v[66:67] op_sel_hi:[0,1]
    v_pk_mul_f32 v[16:17], v[80:81], v[68:69] op_sel_hi:[0,1]
    v_pk_mul_f32 v[18:19], v[82:83], v[70:71] op_sel_hi:[0,1]
    v_pk_mul_f32 v[20:21], v[80:81], v[60:61] op_sel_hi:[0,1]
    v_pk_mul_f32 v[22:23], v[82:83], v[62:63] op_sel_hi:[0,1]
    v_pk_fma_f32 v[12:13], v[8:9], v[64:65], v[12:13] op_sel:[1,1,0] op_sel_hi:[1,0,1] neg_lo:[1,0,0]
    v_pk_fma_f32 v[14:15], v[10:11], v[66:67], v[14:15] op_sel:[1,1,0] op_sel_hi:[1,0,1] neg_lo:[1,0,0]
    v_pk_fma_f32 v[16:17], v[80:81], v[68:69], v[16:17] op_sel:[1,1,0] op_sel_hi:[1,0,1] neg_lo:[1,0,0]
    v_pk_fma_f32 v[18:19], v[82:83], v[70:71], v[18:19] op_sel:[1,1,0] op_sel_hi:[1,0,1] neg_lo:[1,0,0]
    v_pk_fma_f32 v[20:21], v[80:81], v[60:61], v[20:21] op_sel:[1,1,0] op_sel_hi:[1,0,1] neg_lo:[1,0,0]
    v_pk_fma_f32 v[22:23], v[82:83], v[62:63], v[22:23] op_sel:[1,1,0] op_sel_hi:[1,0,1] neg_lo:[1,0,0]
    v_cvt_pk_bf16_f32 v196, v108, -v109
    v_cvt_pk_bf16_f32 v197, v110, -v111
    ds_write_b64 v202, v[196:197] offset:2640
    v_cvt_pk_bf16_f32 v198, v112, -v113
    v_cvt_pk_bf16_f32 v199, v114, -v115
    ds_write_b64 v202, v[198:199] offset:13728
    v_cvt_pk_bf16_f32 v192, v116, -v117
    v_cvt_pk_bf16_f32 v193, v118, -v119
    ds_write_b64 v202, v[192:193] offset:7392
    v_cvt_pk_bf16_f32 v194, v120, -v121
    v_cvt_pk_bf16_f32 v195, v122, -v123
    ds_write_b64 v202, v[194:195] offset:11616
    v_cvt_pk_bf16_f32 v196, v124, -v125
    v_cvt_pk_bf16_f32 v197, v126, -v127
    ds_write_b64 v202, v[196:197] offset:13200
    v_pk_mul_f32 v[24:25], v[16:17], v[60:61] op_sel_hi:[0,1]
    v_pk_mul_f32 v[26:27], v[18:19], v[62:63] op_sel_hi:[0,1]
    v_pk_fma_f32 v[24:25], v[16:17], v[60:61], v[24:25] op_sel:[1,1,0] op_sel_hi:[1,0,1] neg_lo:[1,0,0]
    v_pk_fma_f32 v[26:27], v[18:19], v[62:63], v[26:27] op_sel:[1,1,0] op_sel_hi:[1,0,1] neg_lo:[1,0,0]
    v_cvt_pk_bf16_f32 v198, v8, -v9
    v_cvt_pk_bf16_f32 v199, v10, -v11
    ds_write_b64 v202, v[198:199] offset:3168
    v_cvt_pk_bf16_f32 v192, v80, -v81
    v_cvt_pk_bf16_f32 v193, v82, -v83
    ds_write_b64 v202, v[192:193] offset:14784
    v_cvt_pk_bf16_f32 v194, v84, -v85
    v_cvt_pk_bf16_f32 v195, v86, -v87
    ds_write_b64 v202, v[194:195] offset:14256
    v_cvt_pk_bf16_f32 v196, v12, -v13
    v_cvt_pk_bf16_f32 v197, v14, -v15
    ds_write_b64 v202, v[196:197] offset:3696
    v_cvt_pk_bf16_f32 v198, v16, -v17
    v_cvt_pk_bf16_f32 v199, v18, -v19
    ds_write_b64 v202, v[198:199] offset:15840
    v_cvt_pk_bf16_f32 v192, v20, -v21
    v_cvt_pk_bf16_f32 v193, v22, -v23
    ds_write_b64 v202, v[192:193] offset:15312
    v_cvt_pk_bf16_f32 v194, v24, -v25
    v_cvt_pk_bf16_f32 v195, v26, -v27
    ds_write_b64 v202, v[194:195] offset:16368
    ds_read_b128 a[64:67], v203 offset:0
    ds_read_b128 a[68:71], v203 offset:32
    ds_read_b128 a[72:75], v203 offset:64
    ds_read_b128 a[76:79], v203 offset:96
    ds_read_b128 a[80:83], v203 offset:128
    ds_read_b128 a[84:87], v203 offset:160
    ds_read_b128 a[88:91], v203 offset:192
    ds_read_b128 a[92:95], v203 offset:224
    ds_read_b128 a[96:99], v203 offset:256
    ds_read_b128 a[100:103], v203 offset:288
    ds_read_b128 a[104:107], v203 offset:320
    ds_read_b128 a[108:111], v203 offset:352
    ds_read_b128 a[112:115], v203 offset:384
    ds_read_b128 a[116:119], v203 offset:416
    ds_read_b128 a[120:123], v203 offset:448
    ds_read_b128 a[124:127], v203 offset:480
    s_waitcnt lgkmcnt(15)
    v_mfma_f32_32x32x16_bf16 v[128:143], a[64:67], a[0:3], 0
    s_waitcnt lgkmcnt(14)
    v_mfma_f32_32x32x16_bf16 v[128:143], a[68:71], a[4:7], v[128:143]
    s_waitcnt lgkmcnt(13)
    v_mfma_f32_32x32x16_bf16 v[128:143], a[72:75], a[8:11], v[128:143]
    s_waitcnt lgkmcnt(12)
    v_mfma_f32_32x32x16_bf16 v[128:143], a[76:79], a[12:15], v[128:143]
    s_waitcnt lgkmcnt(11)
    v_mfma_f32_32x32x16_bf16 v[128:143], a[80:83], a[16:19], v[128:143]
    s_waitcnt lgkmcnt(10)
    v_mfma_f32_32x32x16_bf16 v[128:143], a[84:87], a[20:23], v[128:143]
    s_waitcnt lgkmcnt(9)
    v_mfma_f32_32x32x16_bf16 v[128:143], a[88:91], a[24:27], v[128:143]
    s_waitcnt lgkmcnt(8)
    v_mfma_f32_32x32x16_bf16 v[128:143], a[92:95], a[28:31], v[128:143]
    s_waitcnt lgkmcnt(7)
    v_mfma_f32_32x32x16_bf16 v[128:143], a[96:99], a[32:35], v[128:143]
    s_waitcnt lgkmcnt(6)
    v_mfma_f32_32x32x16_bf16 v[128:143], a[100:103], a[36:39], v[128:143]
    s_waitcnt lgkmcnt(5)
    v_mfma_f32_32x32x16_bf16 v[128:143], a[104:107], a[40:43], v[128:143]
    s_waitcnt lgkmcnt(4)
    v_mfma_f32_32x32x16_bf16 v[128:143], a[108:111], a[44:47], v[128:143]
    s_waitcnt lgkmcnt(3)
    v_mfma_f32_32x32x16_bf16 v[128:143], a[112:115], a[48:51], v[128:143]
    s_waitcnt lgkmcnt(2)
    v_mfma_f32_32x32x16_bf16 v[128:143], a[116:119], a[52:55], v[128:143]
    s_waitcnt lgkmcnt(1)
    v_mfma_f32_32x32x16_bf16 v[128:143], a[120:123], a[56:59], v[128:143]
    s_waitcnt lgkmcnt(0)
    v_mfma_f32_32x32x16_bf16 v[128:143], a[124:127], a[60:63], v[128:143]
    v_and_b32 v60, 1, v0
    v_cmp_eq_u32 vcc, 1, v60
    s_nop 7
    s_nop 1
    v_cvt_pk_bf16_f32 v144, v131, v130
    v_cvt_pk_bf16_f32 v145, v129, v128
    v_cvt_pk_bf16_f32 v146, v134, v133
    v_cvt_pk_bf16_f32 v147, v132, v132
    v_cvt_pk_bf16_f32 v148, v138, v138
    v_cvt_pk_bf16_f32 v149, v137, v137
    v_cvt_pk_bf16_f32 v150, v137, v136
    v_cvt_pk_bf16_f32 v151, v136, v136
    v_cndmask_b32 v80, v140, v141, vcc
    v_cndmask_b32 v81, v142, v143, vcc
    v_cvt_pk_bf16_f32 v152, v141, v141
    v_cvt_pk_bf16_f32 v153, v141, v80
    v_cvt_pk_bf16_f32 v154, v140, v140
    v_cvt_pk_bf16_f32 v156, v143, v143
    v_cvt_pk_bf16_f32 v157, v143, v81
    v_cvt_pk_bf16_f32 v158, v142, v142
    v_mov_b32 v155, v154
    v_mov_b32 v159, v158
mk_JOIN:
    s_waitcnt vmcnt(37)
    s_barrier
    ds_read_b128 a[0:3], v217 offset:0
    ds_read_b128 a[4:7], v217 offset:4096
    ds_read_b64_tr_b16 v[192:193], v221 offset:0
    ds_read_b64_tr_b16 v[194:195], v221 offset:512
    ds_read_b64_tr_b16 v[196:197], v222 offset:0
    ds_read_b64_tr_b16 v[198:199], v222 offset:512
    ds_read_b64_tr_b16 v[200:201], v223 offset:0
    ds_read_b64_tr_b16 v[202:203], v223 offset:512
    s_waitcnt lgkmcnt(4)
    v_mfma_f32_32x32x16_bf16 v[0:15], v[192:195], a[0:3], 0
    ds_read_b64_tr_b16 v[204:205], v224 offset:0
    ds_read_b128 a[8:11], v218 offset:0
    s_add_u32 m0, s55, 12288
    s_add_u32 s54, s5, 36864
    buffer_load_dwordx4 v208, s[16:19], s54 offen offset:0 lds
    v_mfma_f32_32x32x16_bf16 v[16:31], v[192:195], a[4:7], 0
    ds_read_b64_tr_b16 v[206:207], v224 offset:512
    ds_read_b128 a[12:15], v218 offset:4096
    s_waitcnt lgkmcnt(6)
    v_mfma_f32_32x32x16_bf16 v[32:47], v[196:199], a[0:3], 0
    ds_read_b64_tr_b16 v[192:193], v221 offset:4096
    ds_read_b128 a[16:19], v219 offset:0
    buffer_load_dwordx4 v209, s[16:19], s54 offen offset:1024 lds
    v_mfma_f32_32x32x16_bf16 v[48:63], v[196:199], a[4:7], 0
    ds_read_b64_tr_b16 v[194:195], v221 offset:4608
    ds_read_b128 a[20:23], v219 offset:4096
    s_waitcnt lgkmcnt(5)
    v_mfma_f32_32x32x16_bf16 v[64:79], v[200:203], a[0:3], 0
    ds_read_b64_tr_b16 v[196:197], v222 offset:4096
    ds_read_b128 v[140:143], v251 offset:0
    buffer_load_dwordx4 v210, s[16:19], s54 offen offset:2048 lds
    v_mfma_f32_32x32x16_bf16 v[80:95], v[200:203], a[4:7], 0
    ds_read_b64_tr_b16 v[198:199], v222 offset:4608
    ds_read_b128 a[24:27], v220 offset:0
    v_mfma_f32_32x32x16_bf16 v[96:111], v[204:207], a[0:3], 0
    ds_read_b64_tr_b16 v[200:201], v223 offset:4096
    ds_read_b128 a[28:31], v220 offset:4096
    buffer_load_dwordx4 v211, s[16:19], s54 offen offset:3072 lds
    v_mfma_f32_32x32x16_bf16 v[112:127], v[204:207], a[4:7], 0
    ds_read_b64_tr_b16 v[202:203], v223 offset:4608
    s_bitcmp1_b32 s58, 0
    s_cbranch_scc0 mk_ut1
    ds_read_b64_tr_b16 v[232:233], v244 offset:0
    ds_read_b64_tr_b16 v[234:235], v245 offset:0
    ds_read_b64_tr_b16 v[236:237], v246 offset:0
    ds_read_b64_tr_b16 v[238:239], v247 offset:0
    s_cmp_eq_u32 s4, 1024
    s_cselect_b32 s60, 2162688, 0
    s_add_u32 s60, s60, s57
    s_waitcnt lgkmcnt(0)
    buffer_store_dwordx4 v[232:235], v230, s[32:35], s60 offen offset:0 sc1
    buffer_store_dwordx4 v[236:239], v230, s[32:35], s60 offen offset:16 sc1
mk_ut1:
    s_waitcnt lgkmcnt(4)
    v_mfma_f32_32x32x16_bf16 v[0:15], v[192:195], a[8:11], v[0:15]
    ds_read_b64_tr_b16 v[204:205], v224 offset:4096
    s_waitcnt lgkmcnt(2)
    buffer_load_dwordx4 v[172:175], v252, s[8:11], s4 offen
    v_mfma_f32_32x32x16_bf16 v[16:31], v[192:195], a[12:15], v[16:31]
    ds_read_b64_tr_b16 v[206:207], v224 offset:4608
    s_add_u32 m0, s56, 32768
    s_mul_i32 s54, s6, 4608
    buffer_load_dwordx4 v212, s[20:23], s54 offen offset:0 lds
    v_mfma_f32_32x32x16_bf16 v[32:47], v[196:199], a[8:11], v[32:47]
    ds_read_b64_tr_b16 v[192:193], v221 offset:8192
    v_mfma_f32_32x32x16_bf16 v[48:63], v[196:199], a[12:15], v[48:63]
    ds_read_b64_tr_b16 v[194:195], v221 offset:8704
    buffer_load_dwordx4 v213, s[20:23], s54 offen offset:1024 lds
    s_waitcnt lgkmcnt(2)
    v_mfma_f32_32x32x16_bf16 v[64:79], v[200:203], a[8:11], v[64:79]
    ds_read_b64_tr_b16 v[196:197], v222 offset:8192
    v_mfma_f32_32x32x16_bf16 v[80:95], v[200:203], a[12:15], v[80:95]
    ds_read_b64_tr_b16 v[198:199], v222 offset:8704
    buffer_load_dwordx4 v214, s[24:27], s54 offen offset:2048 lds
    v_mfma_f32_32x32x16_bf16 v[96:111], v[204:207], a[8:11], v[96:111]
    ds_read_b64_tr_b16 v[200:201], v223 offset:8192
    v_mfma_f32_32x32x16_bf16 v[112:127], v[204:207], a[12:15], v[112:127]
    ds_read_b64_tr_b16 v[202:203], v223 offset:8704
    buffer_load_dwordx4 v215, s[24:27], s54 offen offset:3072 lds
    s_waitcnt lgkmcnt(2)
    v_mfma_f32_32x32x16_bf16 v[0:15], v[192:195], a[16:19], v[0:15]
    ds_read_b64_tr_b16 v[204:205], v224 offset:8192
    v_mfma_f32_32x32x16_bf16 v[16:31], v[192:195], a[20:23], v[16:31]
    ds_read_b64_tr_b16 v[206:207], v224 offset:8704
    buffer_load_dwordx4 v[176:179], v252, s[8:11], s5 offen
    v_mfma_f32_32x32x16_bf16 v[32:47], v[196:199], a[16:19], v[32:47]
    ds_read_b64_tr_b16 v[192:193], v221 offset:12288
    buffer_load_dwordx4 v[180:183], v252, s[8:11], s6 offen
    v_mfma_f32_32x32x16_bf16 v[48:63], v[196:199], a[20:23], v[48:63]
    ds_read_b64_tr_b16 v[194:195], v221 offset:12800
    buffer_load_dwordx4 v[184:187], v252, s[8:11], s7 offen
    s_waitcnt lgkmcnt(2)
    v_mfma_f32_32x32x16_bf16 v[64:79], v[200:203], a[16:19], v[64:79]
    ds_read_b64_tr_b16 v[196:197], v222 offset:12288
    buffer_load_dwordx4 v[188:191], v252, s[8:11], s12 offen
    v_mfma_f32_32x32x16_bf16 v[80:95], v[200:203], a[20:23], v[80:95]
    ds_read_b64_tr_b16 v[198:199], v222 offset:12800
    buffer_load_dwordx4 v[240:243], v169, s[36:39], 0 offen
    v_mfma_f32_32x32x16_bf16 v[96:111], v[204:207], a[16:19], v[96:111]
    ds_read_b64_tr_b16 v[200:201], v223 offset:12288
    s_add_u32 m0, s55, 0
    s_nop 0
    buffer_load_dwordx4 v208, s[16:19], s6 offen offset:0 lds
    v_mfma_f32_32x32x16_bf16 v[112:127], v[204:207], a[20:23], v[112:127]
    ds_read_b64_tr_b16 v[202:203], v223 offset:12800
    s_waitcnt lgkmcnt(2)
    v_mfma_f32_32x32x16_bf16 v[0:15], v[192:195], a[24:27], v[0:15]
    ds_read_b64_tr_b16 v[204:205], v224 offset:12288
    buffer_load_dwordx4 v209, s[16:19], s6 offen offset:1024 lds
    v_mfma_f32_32x32x16_bf16 v[16:31], v[192:195], a[28:31], v[16:31]
    ds_read_b64_tr_b16 v[206:207], v224 offset:12800
    v_mfma_f32_32x32x16_bf16 v[32:47], v[196:199], a[24:27], v[32:47]
    buffer_load_dwordx4 v210, s[16:19], s6 offen offset:2048 lds
    v_mfma_f32_32x32x16_bf16 v[48:63], v[196:199], a[28:31], v[48:63]
    s_waitcnt vmcnt(13)
    s_barrier
    ds_read_b128 a[32:35], v217 offset:8192
    ds_read_b128 a[36:39], v217 offset:12288
    ds_read_b64_tr_b16 v[192:193], v221 offset:16384
    ds_read_b64_tr_b16 v[194:195], v221 offset:16896
    s_waitcnt lgkmcnt(4)
    v_mfma_f32_32x32x16_bf16 v[64:79], v[200:203], a[24:27], v[64:79]
    ds_read_b64_tr_b16 v[196:197], v222 offset:16384
    ds_read_b128 a[40:43], v218 offset:8192
    s_waitcnt vmcnt(12)
    v_dot2_f32_bf16 v249, v140, v172, v249
    v_dot2_f32_bf16 v250, v141, v173, v250
    buffer_load_dwordx4 v211, s[16:19], s6 offen offset:3072 lds
    v_mfma_f32_32x32x16_bf16 v[80:95], v[200:203], a[28:31], v[80:95]
    ds_read_b64_tr_b16 v[198:199], v222 offset:16896
    ds_read_b128 a[44:47], v218 offset:12288
    v_dot2_f32_bf16 v249, v142, v174, v249
    v_dot2_f32_bf16 v250, v143, v175, v250
    v_mfma_f32_32x32x16_bf16 v[96:111], v[204:207], a[24:27], v[96:111]
    ds_read_b64_tr_b16 v[200:201], v223 offset:16384
    ds_read_b128 a[48:51], v219 offset:8192
    s_add_u32 m0, s55, 4096
    s_add_u32 s54, s6, 36864
    buffer_load_dwordx4 v208, s[16:19], s54 offen offset:0 lds
    v_mfma_f32_32x32x16_bf16 v[112:127], v[204:207], a[28:31], v[112:127]
    ds_read_b64_tr_b16 v[202:203], v223 offset:16896
    ds_read_b128 a[52:55], v219 offset:12288
    s_waitcnt lgkmcnt(5)
    v_mfma_f32_32x32x16_bf16 v[0:15], v[192:195], a[32:35], v[0:15]
    ds_read_b64_tr_b16 v[204:205], v224 offset:16384
    ds_read_b128 v[140:143], v251 offset:8192
    buffer_load_dwordx4 v209, s[16:19], s54 offen offset:1024 lds
    v_mfma_f32_32x32x16_bf16 v[16:31], v[192:195], a[36:39], v[16:31]
    ds_read_b64_tr_b16 v[206:207], v224 offset:16896
    ds_read_b128 a[56:59], v220 offset:8192
    v_mfma_f32_32x32x16_bf16 v[32:47], v[196:199], a[32:35], v[32:47]
    ds_read_b64_tr_b16 v[192:193], v221 offset:20480
    ds_read_b128 a[60:63], v220 offset:12288
    buffer_load_dwordx4 v210, s[16:19], s54 offen offset:2048 lds
    v_mfma_f32_32x32x16_bf16 v[48:63], v[196:199], a[36:39], v[48:63]
    ds_read_b64_tr_b16 v[194:195], v221 offset:20992
    s_bitcmp1_b32 s58, 1
    s_cbranch_scc0 mk_ut2
    ds_read_b64_tr_b16 v[232:233], v244 offset:8192
    ds_read_b64_tr_b16 v[234:235], v245 offset:8192
    ds_read_b64_tr_b16 v[236:237], v246 offset:8192
    ds_read_b64_tr_b16 v[238:239], v247 offset:8192
    s_cmp_eq_u32 s5, 1024
    s_cselect_b32 s60, 2162688, 0
    s_add_u32 s60, s60, s57
    s_waitcnt lgkmcnt(0)
    buffer_store_dwordx4 v[232:235], v230, s[32:35], s60 offen offset:0 sc1
    buffer_store_dwordx4 v[236:239], v230, s[32:35], s60 offen offset:16 sc1
mk_ut2:
    s_waitcnt lgkmcnt(4)
    v_mfma_f32_32x32x16_bf16 v[64:79], v[200:203], a[32:35], v[64:79]
    ds_read_b64_tr_b16 v[196:197], v222 offset:20480
    s_waitcnt lgkmcnt(2)
    s_waitcnt vmcnt(11)
    v_dot2_f32_bf16 v249, v140, v176, v249
    v_dot2_f32_bf16 v250, v141, v177, v250
    buffer_load_dwordx4 v211, s[16:19], s54 offen offset:3072 lds
    v_mfma_f32_32x32x16_bf16 v[80:95], v[200:203], a[36:39], v[80:95]
    ds_read_b64_tr_b16 v[198:199], v222 offset:20992
    v_dot2_f32_bf16 v249, v142, v178, v249
    v_dot2_f32_bf16 v250, v143, v179, v250
    v_mfma_f32_32x32x16_bf16 v[96:111], v[204:207], a[32:35], v[96:111]
    ds_read_b64_tr_b16 v[200:201], v223 offset:20480
    s_lshl_b32 s87, s40, 13
    s_sub_u32 s86, 131072, s87
    s_add_u32 s87, s87, 131072
    s_add_u32 m0, s56, 0
    s_mul_i32 s54, s7, 4608
    buffer_load_dwordx4 v212, s[20:23], s54 offen offset:0 lds
    v_mfma_f32_32x32x16_bf16 v[112:127], v[204:207], a[36:39], v[112:127]
    ds_read_b64_tr_b16 v[202:203], v223 offset:20992
    s_waitcnt lgkmcnt(2)
    v_mfma_f32_32x32x16_bf16 v[0:15], v[192:195], a[40:43], v[0:15]
    ds_read_b64_tr_b16 v[204:205], v224 offset:20480
    buffer_load_dwordx4 v213, s[20:23], s54 offen offset:1024 lds
    v_mfma_f32_32x32x16_bf16 v[16:31], v[192:195], a[44:47], v[16:31]
    ds_read_b64_tr_b16 v[206:207], v224 offset:20992
    v_mfma_f32_32x32x16_bf16 v[32:47], v[196:199], a[40:43], v[32:47]
    ds_read_b64_tr_b16 v[192:193], v221 offset:24576
    buffer_load_dwordx4 v214, s[24:27], s54 offen offset:2048 lds
    v_mfma_f32_32x32x16_bf16 v[48:63], v[196:199], a[44:47], v[48:63]
    ds_read_b64_tr_b16 v[194:195], v221 offset:25088
    s_waitcnt lgkmcnt(2)
    v_mfma_f32_32x32x16_bf16 v[64:79], v[200:203], a[40:43], v[64:79]
    ds_read_b64_tr_b16 v[196:197], v222 offset:24576
    buffer_load_dwordx4 v215, s[24:27], s54 offen offset:3072 lds
    v_mfma_f32_32x32x16_bf16 v[80:95], v[200:203], a[44:47], v[80:95]
    ds_read_b64_tr_b16 v[198:199], v222 offset:25088
    v_mfma_f32_32x32x16_bf16 v[96:111], v[204:207], a[40:43], v[96:111]
    ds_read_b64_tr_b16 v[200:201], v223 offset:24576
    s_add_u32 m0, s55, 8192
    s_nop 0
    buffer_load_dwordx4 v208, s[16:19], s7 offen offset:0 lds
    v_mfma_f32_32x32x16_bf16 v[112:127], v[204:207], a[44:47], v[112:127]
    ds_read_b64_tr_b16 v[202:203], v223 offset:25088
    s_waitcnt lgkmcnt(2)
    v_mfma_f32_32x32x16_bf16 v[0:15], v[192:195], a[48:51], v[0:15]
    ds_read_b64_tr_b16 v[204:205], v224 offset:24576
    buffer_load_dwordx4 v209, s[16:19], s7 offen offset:1024 lds
    v_mfma_f32_32x32x16_bf16 v[16:31], v[192:195], a[52:55], v[16:31]
    ds_read_b64_tr_b16 v[206:207], v224 offset:25088
    v_mfma_f32_32x32x16_bf16 v[32:47], v[196:199], a[48:51], v[32:47]
    ds_read_b64_tr_b16 v[192:193], v221 offset:28672
    buffer_load_dwordx4 v210, s[16:19], s7 offen offset:2048 lds
    v_mfma_f32_32x32x16_bf16 v[48:63], v[196:199], a[52:55], v[48:63]
    ds_read_b64_tr_b16 v[194:195], v221 offset:29184
    s_waitcnt lgkmcnt(2)
    v_mfma_f32_32x32x16_bf16 v[64:79], v[200:203], a[48:51], v[64:79]
    ds_read_b64_tr_b16 v[196:197], v222 offset:28672
    buffer_load_dwordx4 v211, s[16:19], s7 offen offset:3072 lds
    v_mfma_f32_32x32x16_bf16 v[80:95], v[200:203], a[52:55], v[80:95]
    ds_read_b64_tr_b16 v[198:199], v222 offset:29184
    v_mfma_f32_32x32x16_bf16 v[96:111], v[204:207], a[48:51], v[96:111]
    ds_read_b64_tr_b16 v[200:201], v223 offset:28672
    s_add_u32 m0, s55, 12288
    s_add_u32 s54, s7, 36864
    buffer_load_dwordx4 v208, s[16:19], s54 offen offset:0 lds
    v_mfma_f32_32x32x16_bf16 v[112:127], v[204:207], a[52:55], v[112:127]
    ds_read_b64_tr_b16 v[202:203], v223 offset:29184
    s_waitcnt lgkmcnt(2)
    v_mfma_f32_32x32x16_bf16 v[0:15], v[192:195], a[56:59], v[0:15]
    ds_read_b64_tr_b16 v[204:205], v224 offset:28672
    buffer_load_dwordx4 v209, s[16:19], s54 offen offset:1024 lds
    v_mfma_f32_32x32x16_bf16 v[16:31], v[192:195], a[60:63], v[16:31]
    ds_read_b64_tr_b16 v[206:207], v224 offset:29184
    v_mfma_f32_32x32x16_bf16 v[32:47], v[196:199], a[56:59], v[32:47]
    buffer_load_dwordx4 v210, s[16:19], s54 offen offset:2048 lds
    v_mfma_f32_32x32x16_bf16 v[48:63], v[196:199], a[60:63], v[48:63]
    s_waitcnt vmcnt(11)
    s_barrier
    ds_read_b128 a[64:67], v217 offset:0
    ds_read_b128 a[68:71], v217 offset:4096
    ds_read_b64_tr_b16 v[192:193], v221 offset:32768
    ds_read_b64_tr_b16 v[194:195], v221 offset:33280
    s_waitcnt lgkmcnt(4)
    v_mfma_f32_32x32x16_bf16 v[64:79], v[200:203], a[56:59], v[64:79]
    ds_read_b64_tr_b16 v[196:197], v222 offset:32768
    ds_read_b128 a[72:75], v218 offset:0
    buffer_load_dwordx4 v211, s[16:19], s54 offen offset:3072 lds
    v_mfma_f32_32x32x16_bf16 v[80:95], v[200:203], a[60:63], v[80:95]
    ds_read_b64_tr_b16 v[198:199], v222 offset:33280
    ds_read_b128 a[76:79], v218 offset:4096
    v_mfma_f32_32x32x16_bf16 v[96:111], v[204:207], a[56:59], v[96:111]
    ds_read_b64_tr_b16 v[200:201], v223 offset:32768
    ds_read_b128 a[80:83], v219 offset:0
    buffer_store_dwordx2 v[144:145], v160, s[32:35], 0 offen offset:4088
    v_mfma_f32_32x32x16_bf16 v[112:127], v[204:207], a[60:63], v[112:127]
    ds_read_b64_tr_b16 v[202:203], v223 offset:33280
    ds_read_b128 a[84:87], v219 offset:4096
    s_waitcnt lgkmcnt(5)
    v_mfma_f32_32x32x16_bf16 v[0:15], v[192:195], a[64:67], v[0:15]
    ds_read_b64_tr_b16 v[204:205], v224 offset:32768
    ds_read_b128 v[140:143], v251 offset:0
    buffer_store_dwordx2 v[146:147], v160, s[32:35], 0 offen offset:3576
    v_mfma_f32_32x32x16_bf16 v[16:31], v[192:195], a[68:71], v[16:31]
    ds_read_b64_tr_b16 v[206:207], v224 offset:33280
    ds_read_b128 a[88:91], v220 offset:0
    v_mfma_f32_32x32x16_bf16 v[32:47], v[196:199], a[64:67], v[32:47]
    ds_read_b64_tr_b16 v[192:193], v221 offset:36864
    ds_read_b128 a[92:95], v220 offset:4096
    buffer_store_dwordx4 v[148:151], v161, s[32:35], 0 offen offset:3056
    v_mfma_f32_32x32x16_bf16 v[48:63], v[196:199], a[68:71], v[48:63]
    ds_read_b64_tr_b16 v[194:195], v221 offset:37376
    s_bitcmp1_b32 s58, 2
    s_cbranch_scc0 mk_ut3
    ds_read_b64_tr_b16 v[232:233], v244 offset:0
    ds_read_b64_tr_b16 v[234:235], v245 offset:0
    ds_read_b64_tr_b16 v[236:237], v246 offset:0
    ds_read_b64_tr_b16 v[238:239], v247 offset:0
    s_cmp_eq_u32 s6, 1024
    s_cselect_b32 s60, 2162688, 0
    s_add_u32 s60, s60, s57
    s_waitcnt lgkmcnt(0)
    buffer_store_dwordx4 v[232:235], v230, s[32:35], s60 offen offset:0 sc1
    buffer_store_dwordx4 v[236:239], v230, s[32:35], s60 offen offset:16 sc1
mk_ut3:
    s_waitcnt lgkmcnt(4)
    v_mfma_f32_32x32x16_bf16 v[64:79], v[200:203], a[64:67], v[64:79]
    ds_read_b64_tr_b16 v[196:197], v222 offset:36864
    s_waitcnt lgkmcnt(2)
    v_dot2_f32_bf16 v249, v140, v180, v249
    v_dot2_f32_bf16 v250, v141, v181, v250
    buffer_store_dwordx4 v[152:155], v162, s[32:35], 0 offen offset:2032
    v_mfma_f32_32x32x16_bf16 v[80:95], v[200:203], a[68:71], v[80:95]
    ds_read_b64_tr_b16 v[198:199], v222 offset:37376
    v_dot2_f32_bf16 v249, v142, v182, v249
    v_dot2_f32_bf16 v250, v143, v183, v250
    v_mfma_f32_32x32x16_bf16 v[96:111], v[204:207], a[64:67], v[96:111]
    ds_read_b64_tr_b16 v[200:201], v223 offset:36864
    buffer_store_dwordx4 v[156:159], v162, s[32:35], 0 offen offset:1520
    v_mfma_f32_32x32x16_bf16 v[112:127], v[204:207], a[68:71], v[112:127]
    ds_read_b64_tr_b16 v[202:203], v223 offset:37376
    s_waitcnt lgkmcnt(2)
    v_mfma_f32_32x32x16_bf16 v[0:15], v[192:195], a[72:75], v[0:15]
    ds_read_b64_tr_b16 v[204:205], v224 offset:36864
    buffer_store_dwordx4 v[164:167], v163, s[32:35], 0 offen sc1
    v_mfma_f32_32x32x16_bf16 v[16:31], v[192:195], a[76:79], v[16:31]
    ds_read_b64_tr_b16 v[206:207], v224 offset:37376
    v_mfma_f32_32x32x16_bf16 v[32:47], v[196:199], a[72:75], v[32:47]
    ds_read_b64_tr_b16 v[192:193], v221 offset:40960
    buffer_store_dword v164, v228, s[32:35], 0 offen sc1
    v_mfma_f32_32x32x16_bf16 v[48:63], v[196:199], a[76:79], v[48:63]
    ds_read_b64_tr_b16 v[194:195], v221 offset:41472
    s_waitcnt lgkmcnt(2)
    v_mfma_f32_32x32x16_bf16 v[64:79], v[200:203], a[72:75], v[64:79]
    ds_read_b64_tr_b16 v[196:197], v222 offset:40960
    buffer_load_dwordx4 v[128:131], v252, s[8:11], s13 offen
    v_mfma_f32_32x32x16_bf16 v[80:95], v[200:203], a[76:79], v[80:95]
    ds_read_b64_tr_b16 v[198:199], v222 offset:41472
    buffer_load_dwordx4 v[132:135], v252, s[8:11], s14 offen
    v_mfma_f32_32x32x16_bf16 v[96:111], v[204:207], a[72:75], v[96:111]
    ds_read_b64_tr_b16 v[200:201], v223 offset:40960
    buffer_load_dwordx4 v[136:139], v252, s[8:11], s15 offen
    v_mfma_f32_32x32x16_bf16 v[112:127], v[204:207], a[76:79], v[112:127]
    ds_read_b64_tr_b16 v[202:203], v223 offset:41472
    s_add_u32 m0, s56, 16384
    s_mul_i32 s54, s12, 4608
    buffer_load_dwordx4 v212, s[20:23], s54 offen offset:0 lds
    s_waitcnt lgkmcnt(2)
    v_mfma_f32_32x32x16_bf16 v[0:15], v[192:195], a[80:83], v[0:15]
    ds_read_b64_tr_b16 v[204:205], v224 offset:40960
    v_mfma_f32_32x32x16_bf16 v[16:31], v[192:195], a[84:87], v[16:31]
    ds_read_b64_tr_b16 v[206:207], v224 offset:41472
    buffer_load_dwordx4 v213, s[20:23], s54 offen offset:1024 lds
    v_mfma_f32_32x32x16_bf16 v[32:47], v[196:199], a[80:83], v[32:47]
    ds_read_b64_tr_b16 v[192:193], v221 offset:45056
    v_mfma_f32_32x32x16_bf16 v[48:63], v[196:199], a[84:87], v[48:63]
    ds_read_b64_tr_b16 v[194:195], v221 offset:45568
    buffer_load_dwordx4 v214, s[24:27], s54 offen offset:2048 lds
    s_waitcnt lgkmcnt(2)
    v_mfma_f32_32x32x16_bf16 v[64:79], v[200:203], a[80:83], v[64:79]
    ds_read_b64_tr_b16 v[196:197], v222 offset:45056
    v_mfma_f32_32x32x16_bf16 v[80:95], v[200:203], a[84:87], v[80:95]
    ds_read_b64_tr_b16 v[198:199], v222 offset:45568
    buffer_load_dwordx4 v215, s[24:27], s54 offen offset:3072 lds
    v_mfma_f32_32x32x16_bf16 v[96:111], v[204:207], a[80:83], v[96:111]
    ds_read_b64_tr_b16 v[200:201], v223 offset:45056
    v_mfma_f32_32x32x16_bf16 v[112:127], v[204:207], a[84:87], v[112:127]
    ds_read_b64_tr_b16 v[202:203], v223 offset:45568
    s_add_u32 m0, s55, 0
    s_nop 0
    buffer_load_dwordx4 v208, s[16:19], s12 offen offset:0 lds
    s_waitcnt lgkmcnt(2)
    v_mfma_f32_32x32x16_bf16 v[0:15], v[192:195], a[88:91], v[0:15]
    ds_read_b64_tr_b16 v[204:205], v224 offset:45056
    v_mfma_f32_32x32x16_bf16 v[16:31], v[192:195], a[92:95], v[16:31]
    ds_read_b64_tr_b16 v[206:207], v224 offset:45568
    buffer_load_dwordx4 v209, s[16:19], s12 offen offset:1024 lds
    v_mfma_f32_32x32x16_bf16 v[32:47], v[196:199], a[88:91], v[32:47]
    v_mfma_f32_32x32x16_bf16 v[48:63], v[196:199], a[92:95], v[48:63]
    buffer_load_dwordx4 v210, s[16:19], s12 offen offset:2048 lds
    s_waitcnt vmcnt(17)
    s_barrier
    ds_read_b128 a[96:99], v217 offset:8192
    ds_read_b128 a[100:103], v217 offset:12288
    ds_read_b64_tr_b16 v[192:193], v221 offset:0
    ds_read_b64_tr_b16 v[194:195], v221 offset:512
    s_waitcnt lgkmcnt(4)
    v_mfma_f32_32x32x16_bf16 v[64:79], v[200:203], a[88:91], v[64:79]
    ds_read_b64_tr_b16 v[196:197], v222 offset:0
    ds_read_b128 a[104:107], v218 offset:8192
    v_mfma_f32_32x32x16_bf16 v[80:95], v[200:203], a[92:95], v[80:95]
    ds_read_b64_tr_b16 v[198:199], v222 offset:512
    ds_read_b128 a[108:111], v218 offset:12288
    buffer_load_dwordx4 v211, s[16:19], s12 offen offset:3072 lds
    v_mfma_f32_32x32x16_bf16 v[96:111], v[204:207], a[88:91], v[96:111]
    ds_read_b64_tr_b16 v[200:201], v223 offset:0
    ds_read_b128 a[112:115], v219 offset:8192
    v_mfma_f32_32x32x16_bf16 v[112:127], v[204:207], a[92:95], v[112:127]
    ds_read_b64_tr_b16 v[202:203], v223 offset:512
    ds_read_b128 a[116:119], v219 offset:12288
    s_add_u32 m0, s55, 4096
    s_add_u32 s54, s12, 36864
    buffer_load_dwordx4 v208, s[16:19], s54 offen offset:0 lds
    s_waitcnt lgkmcnt(5)
    v_mfma_f32_32x32x16_bf16 v[0:15], v[192:195], a[96:99], v[0:15]
    ds_read_b64_tr_b16 v[204:205], v224 offset:0
    ds_read_b128 v[140:143], v251 offset:8192
    v_mfma_f32_32x32x16_bf16 v[16:31], v[192:195], a[100:103], v[16:31]
    ds_read_b64_tr_b16 v[206:207], v224 offset:512
    ds_read_b128 a[120:123], v220 offset:8192
    buffer_load_dwordx4 v209, s[16:19], s54 offen offset:1024 lds
    v_mfma_f32_32x32x16_bf16 v[32:47], v[196:199], a[96:99], v[32:47]
    ds_read_b64_tr_b16 v[192:193], v221 offset:4096
    ds_read_b128 a[124:127], v220 offset:12288
    v_mfma_f32_32x32x16_bf16 v[48:63], v[196:199], a[100:103], v[48:63]
    ds_read_b64_tr_b16 v[194:195], v221 offset:4608
    s_bitcmp1_b32 s58, 3
    s_cbranch_scc0 mk_ut4
    ds_read_b64_tr_b16 v[232:233], v244 offset:8192
    ds_read_b64_tr_b16 v[234:235], v245 offset:8192
    ds_read_b64_tr_b16 v[236:237], v246 offset:8192
    ds_read_b64_tr_b16 v[238:239], v247 offset:8192
    s_cmp_eq_u32 s7, 1024
    s_cselect_b32 s60, 2162688, 0
    s_add_u32 s60, s60, s57
    s_waitcnt lgkmcnt(0)
    buffer_store_dwordx4 v[232:235], v230, s[32:35], s60 offen offset:0 sc1
    buffer_store_dwordx4 v[236:239], v230, s[32:35], s60 offen offset:16 sc1
mk_ut4:
    buffer_load_dwordx4 v210, s[16:19], s54 offen offset:2048 lds
    s_waitcnt lgkmcnt(4)
    v_mfma_f32_32x32x16_bf16 v[64:79], v[200:203], a[96:99], v[64:79]
    ds_read_b64_tr_b16 v[196:197], v222 offset:4096
    s_waitcnt lgkmcnt(2)
    v_dot2_f32_bf16 v249, v140, v184, v249
    v_dot2_f32_bf16 v250, v141, v185, v250
    v_mfma_f32_32x32x16_bf16 v[80:95], v[200:203], a[100:103], v[80:95]
    ds_read_b64_tr_b16 v[198:199], v222 offset:4608
    v_dot2_f32_bf16 v249, v142, v186, v249
    v_dot2_f32_bf16 v250, v143, v187, v250
    buffer_load_dwordx4 v211, s[16:19], s54 offen offset:3072 lds
    v_mfma_f32_32x32x16_bf16 v[96:111], v[204:207], a[96:99], v[96:111]
    ds_read_b64_tr_b16 v[200:201], v223 offset:4096
    v_mfma_f32_32x32x16_bf16 v[112:127], v[204:207], a[100:103], v[112:127]
    ds_read_b64_tr_b16 v[202:203], v223 offset:4608
    s_add_u32 m0, s56, 49152
    s_mul_i32 s54, s47, 4608
    buffer_load_dwordx4 v212, s[20:23], s54 offen offset:0 lds
    s_waitcnt lgkmcnt(2)
    v_mfma_f32_32x32x16_bf16 v[0:15], v[192:195], a[104:107], v[0:15]
    ds_read_b64_tr_b16 v[204:205], v224 offset:4096
    v_mfma_f32_32x32x16_bf16 v[16:31], v[192:195], a[108:111], v[16:31]
    ds_read_b64_tr_b16 v[206:207], v224 offset:4608
    buffer_load_dwordx4 v213, s[20:23], s54 offen offset:1024 lds
    v_mfma_f32_32x32x16_bf16 v[32:47], v[196:199], a[104:107], v[32:47]
    ds_read_b64_tr_b16 v[192:193], v221 offset:8192
    v_mfma_f32_32x32x16_bf16 v[48:63], v[196:199], a[108:111], v[48:63]
    ds_read_b64_tr_b16 v[194:195], v221 offset:8704
    buffer_load_dwordx4 v214, s[24:27], s54 offen offset:2048 lds
    s_waitcnt lgkmcnt(2)
    v_mfma_f32_32x32x16_bf16 v[64:79], v[200:203], a[104:107], v[64:79]
    ds_read_b64_tr_b16 v[196:197], v222 offset:8192
    v_mfma_f32_32x32x16_bf16 v[80:95], v[200:203], a[108:111], v[80:95]
    ds_read_b64_tr_b16 v[198:199], v222 offset:8704
    buffer_load_dwordx4 v215, s[24:27], s54 offen offset:3072 lds
    v_mfma_f32_32x32x16_bf16 v[96:111], v[204:207], a[104:107], v[96:111]
    ds_read_b64_tr_b16 v[200:201], v223 offset:8192
    v_mfma_f32_32x32x16_bf16 v[112:127], v[204:207], a[108:111], v[112:127]
    ds_read_b64_tr_b16 v[202:203], v223 offset:8704
    buffer_store_dwordx4 v[240:243], v168, s[32:35], 0 offen sc1
    s_waitcnt lgkmcnt(2)
    v_mfma_f32_32x32x16_bf16 v[0:15], v[192:195], a[112:115], v[0:15]
    ds_read_b64_tr_b16 v[204:205], v224 offset:8192
    v_mfma_f32_32x32x16_bf16 v[16:31], v[192:195], a[116:119], v[16:31]
    ds_read_b64_tr_b16 v[206:207], v224 offset:8704
    buffer_load_dwordx4 v[240:243], v252, s[8:11], s47 offen
    v_mfma_f32_32x32x16_bf16 v[32:47], v[196:199], a[112:115], v[32:47]
    ds_read_b64_tr_b16 v[192:193], v221 offset:12288
    s_add_u32 m0, s56, 32768
    s_mul_i32 s54, s13, 4608
    buffer_load_dwordx4 v212, s[20:23], s54 offen offset:0 lds
    v_mfma_f32_32x32x16_bf16 v[48:63], v[196:199], a[116:119], v[48:63]
    ds_read_b64_tr_b16 v[194:195], v221 offset:12800
    s_waitcnt lgkmcnt(2)
    v_mfma_f32_32x32x16_bf16 v[64:79], v[200:203], a[112:115], v[64:79]
    ds_read_b64_tr_b16 v[196:197], v222 offset:12288
    buffer_load_dwordx4 v213, s[20:23], s54 offen offset:1024 lds
    v_mfma_f32_32x32x16_bf16 v[80:95], v[200:203], a[116:119], v[80:95]
    ds_read_b64_tr_b16 v[198:199], v222 offset:12800
    v_mfma_f32_32x32x16_bf16 v[96:111], v[204:207], a[112:115], v[96:111]
    ds_read_b64_tr_b16 v[200:201], v223 offset:12288
    buffer_load_dwordx4 v214, s[24:27], s54 offen offset:2048 lds
    v_mfma_f32_32x32x16_bf16 v[112:127], v[204:207], a[116:119], v[112:127]
    ds_read_b64_tr_b16 v[202:203], v223 offset:12800
    s_waitcnt lgkmcnt(2)
    v_mfma_f32_32x32x16_bf16 v[0:15], v[192:195], a[120:123], v[0:15]
    ds_read_b64_tr_b16 v[204:205], v224 offset:12288
    buffer_load_dwordx4 v215, s[24:27], s54 offen offset:3072 lds
    v_mfma_f32_32x32x16_bf16 v[16:31], v[192:195], a[124:127], v[16:31]
    ds_read_b64_tr_b16 v[206:207], v224 offset:12800
    v_mfma_f32_32x32x16_bf16 v[32:47], v[196:199], a[120:123], v[32:47]
    s_add_u32 m0, s55, 8192
    s_nop 0
    buffer_load_dwordx4 v208, s[16:19], s13 offen offset:0 lds
    v_mfma_f32_32x32x16_bf16 v[48:63], v[196:199], a[124:127], v[48:63]
    s_waitcnt vmcnt(11)
    s_barrier
    ds_read_b128 a[128:131], v217 offset:0
    ds_read_b128 a[132:135], v217 offset:4096
    ds_read_b64_tr_b16 v[192:193], v221 offset:16384
    ds_read_b64_tr_b16 v[194:195], v221 offset:16896
    s_waitcnt lgkmcnt(4)
    v_mfma_f32_32x32x16_bf16 v[64:79], v[200:203], a[120:123], v[64:79]
    ds_read_b64_tr_b16 v[196:197], v222 offset:16384
    ds_read_b128 a[136:139], v218 offset:0
    buffer_load_dwordx4 v209, s[16:19], s13 offen offset:1024 lds
    v_mfma_f32_32x32x16_bf16 v[80:95], v[200:203], a[124:127], v[80:95]
    ds_read_b64_tr_b16 v[198:199], v222 offset:16896
    ds_read_b128 a[140:143], v218 offset:4096
    v_mfma_f32_32x32x16_bf16 v[96:111], v[204:207], a[120:123], v[96:111]
    ds_read_b64_tr_b16 v[200:201], v223 offset:16384
    ds_read_b128 a[144:147], v219 offset:0
    buffer_load_dwordx4 v210, s[16:19], s13 offen offset:2048 lds
    v_mfma_f32_32x32x16_bf16 v[112:127], v[204:207], a[124:127], v[112:127]
    ds_read_b64_tr_b16 v[202:203], v223 offset:16896
    ds_read_b128 a[148:151], v219 offset:4096
    s_waitcnt lgkmcnt(5)
    v_mfma_f32_32x32x16_bf16 v[0:15], v[192:195], a[128:131], v[0:15]
    ds_read_b64_tr_b16 v[204:205], v224 offset:16384
    ds_read_b128 v[140:143], v251 offset:0
    buffer_load_dwordx4 v211, s[16:19], s13 offen offset:3072 lds
    v_mfma_f32_32x32x16_bf16 v[16:31], v[192:195], a[132:135], v[16:31]
    ds_read_b64_tr_b16 v[206:207], v224 offset:16896
    ds_read_b128 a[152:155], v220 offset:0
    v_mfma_f32_32x32x16_bf16 v[32:47], v[196:199], a[128:131], v[32:47]
    ds_read_b64_tr_b16 v[192:193], v221 offset:20480
    ds_read_b128 a[156:159], v220 offset:4096
    s_add_u32 m0, s55, 12288
    s_add_u32 s54, s13, 36864
    buffer_load_dwordx4 v208, s[16:19], s54 offen offset:0 lds
    v_mfma_f32_32x32x16_bf16 v[48:63], v[196:199], a[132:135], v[48:63]
    ds_read_b64_tr_b16 v[194:195], v221 offset:20992
    s_bitcmp1_b32 s58, 4
    s_cbranch_scc0 mk_ut5
    ds_read_b64_tr_b16 v[232:233], v244 offset:0
    ds_read_b64_tr_b16 v[234:235], v245 offset:0
    ds_read_b64_tr_b16 v[236:237], v246 offset:0
    ds_read_b64_tr_b16 v[238:239], v247 offset:0
    s_cmp_eq_u32 s12, 1024
    s_cselect_b32 s60, 2162688, 0
    s_add_u32 s60, s60, s57
    s_waitcnt lgkmcnt(0)
    buffer_store_dwordx4 v[232:235], v230, s[32:35], s60 offen offset:0 sc1
    buffer_store_dwordx4 v[236:239], v230, s[32:35], s60 offen offset:16 sc1
mk_ut5:
    s_waitcnt lgkmcnt(4)
    v_mfma_f32_32x32x16_bf16 v[64:79], v[200:203], a[128:131], v[64:79]
    ds_read_b64_tr_b16 v[196:197], v222 offset:20480
    s_waitcnt lgkmcnt(2)
    v_dot2_f32_bf16 v249, v140, v188, v249
    v_dot2_f32_bf16 v250, v141, v189, v250
    buffer_load_dwordx4 v209, s[16:19], s54 offen offset:1024 lds
    v_mfma_f32_32x32x16_bf16 v[80:95], v[200:203], a[132:135], v[80:95]
    ds_read_b64_tr_b16 v[198:199], v222 offset:20992
    v_dot2_f32_bf16 v249, v142, v190, v249
    v_dot2_f32_bf16 v250, v143, v191, v250
    v_mfma_f32_32x32x16_bf16 v[96:111], v[204:207], a[128:131], v[96:111]
    ds_read_b64_tr_b16 v[200:201], v223 offset:20480
    buffer_load_dwordx4 v210, s[16:19], s54 offen offset:2048 lds
    v_mfma_f32_32x32x16_bf16 v[112:127], v[204:207], a[132:135], v[112:127]
    ds_read_b64_tr_b16 v[202:203], v223 offset:20992
    s_waitcnt lgkmcnt(2)
    v_mfma_f32_32x32x16_bf16 v[0:15], v[192:195], a[136:139], v[0:15]
    ds_read_b64_tr_b16 v[204:205], v224 offset:20480
    buffer_load_dwordx4 v211, s[16:19], s54 offen offset:3072 lds
    v_mfma_f32_32x32x16_bf16 v[16:31], v[192:195], a[140:143], v[16:31]
    ds_read_b64_tr_b16 v[206:207], v224 offset:20992
    v_mfma_f32_32x32x16_bf16 v[32:47], v[196:199], a[136:139], v[32:47]
    ds_read_b64_tr_b16 v[192:193], v221 offset:24576
    s_add_u32 m0, s87, 0
    s_nop 0
    buffer_load_dwordx4 v208, s[16:19], s47 offen offset:0 lds
    v_mfma_f32_32x32x16_bf16 v[48:63], v[196:199], a[140:143], v[48:63]
    ds_read_b64_tr_b16 v[194:195], v221 offset:25088
    s_waitcnt lgkmcnt(2)
    v_mfma_f32_32x32x16_bf16 v[64:79], v[200:203], a[136:139], v[64:79]
    ds_read_b64_tr_b16 v[196:197], v222 offset:24576
    buffer_load_dwordx4 v209, s[16:19], s47 offen offset:1024 lds
    v_mfma_f32_32x32x16_bf16 v[80:95], v[200:203], a[140:143], v[80:95]
    ds_read_b64_tr_b16 v[198:199], v222 offset:25088
    v_mfma_f32_32x32x16_bf16 v[96:111], v[204:207], a[136:139], v[96:111]
    ds_read_b64_tr_b16 v[200:201], v223 offset:24576
    buffer_load_dwordx4 v210, s[16:19], s47 offen offset:2048 lds
    v_mfma_f32_32x32x16_bf16 v[112:127], v[204:207], a[140:143], v[112:127]
    ds_read_b64_tr_b16 v[202:203], v223 offset:25088
    s_waitcnt lgkmcnt(2)
    v_mfma_f32_32x32x16_bf16 v[0:15], v[192:195], a[144:147], v[0:15]
    ds_read_b64_tr_b16 v[204:205], v224 offset:24576
    buffer_load_dwordx4 v211, s[16:19], s47 offen offset:3072 lds
    v_mfma_f32_32x32x16_bf16 v[16:31], v[192:195], a[148:151], v[16:31]
    ds_read_b64_tr_b16 v[206:207], v224 offset:25088
    v_mfma_f32_32x32x16_bf16 v[32:47], v[196:199], a[144:147], v[32:47]
    ds_read_b64_tr_b16 v[192:193], v221 offset:28672
    s_add_u32 m0, s56, 0
    s_mul_i32 s54, s14, 4608
    buffer_load_dwordx4 v212, s[20:23], s54 offen offset:0 lds
    v_mfma_f32_32x32x16_bf16 v[48:63], v[196:199], a[148:151], v[48:63]
    ds_read_b64_tr_b16 v[194:195], v221 offset:29184
    s_waitcnt lgkmcnt(2)
    v_mfma_f32_32x32x16_bf16 v[64:79], v[200:203], a[144:147], v[64:79]
    ds_read_b64_tr_b16 v[196:197], v222 offset:28672
    buffer_load_dwordx4 v213, s[20:23], s54 offen offset:1024 lds
    v_mfma_f32_32x32x16_bf16 v[80:95], v[200:203], a[148:151], v[80:95]
    ds_read_b64_tr_b16 v[198:199], v222 offset:29184
    v_mfma_f32_32x32x16_bf16 v[96:111], v[204:207], a[144:147], v[96:111]
    ds_read_b64_tr_b16 v[200:201], v223 offset:28672
    buffer_load_dwordx4 v214, s[24:27], s54 offen offset:2048 lds
    v_mfma_f32_32x32x16_bf16 v[112:127], v[204:207], a[148:151], v[112:127]
    ds_read_b64_tr_b16 v[202:203], v223 offset:29184
    s_waitcnt lgkmcnt(2)
    v_mfma_f32_32x32x16_bf16 v[0:15], v[192:195], a[152:155], v[0:15]
    ds_read_b64_tr_b16 v[204:205], v224 offset:28672
    buffer_load_dwordx4 v215, s[24:27], s54 offen offset:3072 lds
    v_mfma_f32_32x32x16_bf16 v[16:31], v[192:195], a[156:159], v[16:31]
    ds_read_b64_tr_b16 v[206:207], v224 offset:29184
    v_mfma_f32_32x32x16_bf16 v[32:47], v[196:199], a[152:155], v[32:47]
    s_add_u32 m0, s55, 0
    s_nop 0
    buffer_load_dwordx4 v208, s[16:19], s14 offen offset:0 lds
    v_mfma_f32_32x32x16_bf16 v[48:63], v[196:199], a[156:159], v[48:63]
    s_waitcnt vmcnt(9)
    s_barrier
    ds_read_b128 a[160:163], v217 offset:8192
    ds_read_b128 a[164:167], v217 offset:12288
    ds_read_b64_tr_b16 v[192:193], v221 offset:32768
    ds_read_b64_tr_b16 v[194:195], v221 offset:33280
    s_waitcnt lgkmcnt(4)
    v_mfma_f32_32x32x16_bf16 v[64:79], v[200:203], a[152:155], v[64:79]
    ds_read_b64_tr_b16 v[196:197], v222 offset:32768
    ds_read_b128 a[168:171], v218 offset:8192
    buffer_load_dwordx4 v209, s[16:19], s14 offen offset:1024 lds
    v_mfma_f32_32x32x16_bf16 v[80:95], v[200:203], a[156:159], v[80:95]
    ds_read_b64_tr_b16 v[198:199], v222 offset:33280
    ds_read_b128 a[172:175], v218 offset:12288
    v_mfma_f32_32x32x16_bf16 v[96:111], v[204:207], a[152:155], v[96:111]
    ds_read_b64_tr_b16 v[200:201], v223 offset:32768
    ds_read_b128 a[176:179], v219 offset:8192
    buffer_load_dwordx4 v210, s[16:19], s14 offen offset:2048 lds
    v_mfma_f32_32x32x16_bf16 v[112:127], v[204:207], a[156:159], v[112:127]
    ds_read_b64_tr_b16 v[202:203], v223 offset:33280
    ds_read_b128 a[180:183], v219 offset:12288
    s_waitcnt lgkmcnt(5)
    v_mfma_f32_32x32x16_bf16 v[0:15], v[192:195], a[160:163], v[0:15]
    ds_read_b64_tr_b16 v[204:205], v224 offset:32768
    ds_read_b128 v[140:143], v251 offset:8192
    buffer_load_dwordx4 v211, s[16:19], s14 offen offset:3072 lds
    v_mfma_f32_32x32x16_bf16 v[16:31], v[192:195], a[164:167], v[16:31]
    ds_read_b64_tr_b16 v[206:207], v224 offset:33280
    ds_read_b128 a[184:187], v220 offset:8192
    v_mfma_f32_32x32x16_bf16 v[32:47], v[196:199], a[160:163], v[32:47]
    ds_read_b64_tr_b16 v[192:193], v221 offset:36864
    ds_read_b128 a[188:191], v220 offset:12288
    s_add_u32 m0, s55, 4096
    s_add_u32 s54, s14, 36864
    buffer_load_dwordx4 v208, s[16:19], s54 offen offset:0 lds
    v_mfma_f32_32x32x16_bf16 v[48:63], v[196:199], a[164:167], v[48:63]
    ds_read_b64_tr_b16 v[194:195], v221 offset:37376
    s_bitcmp1_b32 s58, 5
    s_cbranch_scc0 mk_ut6
    ds_read_b64_tr_b16 v[232:233], v244 offset:8192
    ds_read_b64_tr_b16 v[234:235], v245 offset:8192
    ds_read_b64_tr_b16 v[236:237], v246 offset:8192
    ds_read_b64_tr_b16 v[238:239], v247 offset:8192
    s_cmp_eq_u32 s13, 1024
    s_cselect_b32 s60, 2162688, 0
    s_add_u32 s60, s60, s57
    s_waitcnt lgkmcnt(0)
    buffer_store_dwordx4 v[232:235], v230, s[32:35], s60 offen offset:0 sc1
    buffer_store_dwordx4 v[236:239], v230, s[32:35], s60 offen offset:16 sc1
mk_ut6:
    s_waitcnt lgkmcnt(4)
    v_mfma_f32_32x32x16_bf16 v[64:79], v[200:203], a[160:163], v[64:79]
    ds_read_b64_tr_b16 v[196:197], v222 offset:36864
    s_waitcnt lgkmcnt(2)
    v_dot2_f32_bf16 v249, v140, v128, v249
    v_dot2_f32_bf16 v250, v141, v129, v250
    buffer_load_dwordx4 v209, s[16:19], s54 offen offset:1024 lds
    v_mfma_f32_32x32x16_bf16 v[80:95], v[200:203], a[164:167], v[80:95]
    ds_read_b64_tr_b16 v[198:199], v222 offset:37376
    v_dot2_f32_bf16 v249, v142, v130, v249
    v_dot2_f32_bf16 v250, v143, v131, v250
    v_mfma_f32_32x32x16_bf16 v[96:111], v[204:207], a[160:163], v[96:111]
    ds_read_b64_tr_b16 v[200:201], v223 offset:36864
    buffer_load_dwordx4 v210, s[16:19], s54 offen offset:2048 lds
    v_mfma_f32_32x32x16_bf16 v[112:127], v[204:207], a[164:167], v[112:127]
    ds_read_b64_tr_b16 v[202:203], v223 offset:37376
    s_waitcnt lgkmcnt(2)
    v_mfma_f32_32x32x16_bf16 v[0:15], v[192:195], a[168:171], v[0:15]
    ds_read_b64_tr_b16 v[204:205], v224 offset:36864
    buffer_load_dwordx4 v211, s[16:19], s54 offen offset:3072 lds
    v_mfma_f32_32x32x16_bf16 v[16:31], v[192:195], a[172:175], v[16:31]
    ds_read_b64_tr_b16 v[206:207], v224 offset:37376
    v_mfma_f32_32x32x16_bf16 v[32:47], v[196:199], a[168:171], v[32:47]
    ds_read_b64_tr_b16 v[192:193], v221 offset:40960
    s_add_u32 m0, s87, 4096
    s_add_u32 s54, s47, 36864
    buffer_load_dwordx4 v208, s[16:19], s54 offen offset:0 lds
    v_mfma_f32_32x32x16_bf16 v[48:63], v[196:199], a[172:175], v[48:63]
    ds_read_b64_tr_b16 v[194:195], v221 offset:41472
    s_waitcnt lgkmcnt(2)
    v_mfma_f32_32x32x16_bf16 v[64:79], v[200:203], a[168:171], v[64:79]
    ds_read_b64_tr_b16 v[196:197], v222 offset:40960
    buffer_load_dwordx4 v209, s[16:19], s54 offen offset:1024 lds
    v_mfma_f32_32x32x16_bf16 v[80:95], v[200:203], a[172:175], v[80:95]
    ds_read_b64_tr_b16 v[198:199], v222 offset:41472
    v_mfma_f32_32x32x16_bf16 v[96:111], v[204:207], a[168:171], v[96:111]
    ds_read_b64_tr_b16 v[200:201], v223 offset:40960
    buffer_load_dwordx4 v210, s[16:19], s54 offen offset:2048 lds
    v_mfma_f32_32x32x16_bf16 v[112:127], v[204:207], a[172:175], v[112:127]
    ds_read_b64_tr_b16 v[202:203], v223 offset:41472
    s_waitcnt lgkmcnt(2)
    v_mfma_f32_32x32x16_bf16 v[0:15], v[192:195], a[176:179], v[0:15]
    ds_read_b64_tr_b16 v[204:205], v224 offset:40960
    buffer_load_dwordx4 v211, s[16:19], s54 offen offset:3072 lds
    v_mfma_f32_32x32x16_bf16 v[16:31], v[192:195], a[180:183], v[16:31]
    ds_read_b64_tr_b16 v[206:207], v224 offset:41472
    v_mfma_f32_32x32x16_bf16 v[32:47], v[196:199], a[176:179], v[32:47]
    ds_read_b64_tr_b16 v[192:193], v221 offset:45056
    s_add_u32 m0, s56, 16384
    s_mul_i32 s54, s15, 4608
    buffer_load_dwordx4 v212, s[20:23], s54 offen offset:0 lds
    v_mfma_f32_32x32x16_bf16 v[48:63], v[196:199], a[180:183], v[48:63]
    ds_read_b64_tr_b16 v[194:195], v221 offset:45568
    s_waitcnt lgkmcnt(2)
    v_mfma_f32_32x32x16_bf16 v[64:79], v[200:203], a[176:179], v[64:79]
    ds_read_b64_tr_b16 v[196:197], v222 offset:45056
    buffer_load_dwordx4 v213, s[20:23], s54 offen offset:1024 lds
    v_mfma_f32_32x32x16_bf16 v[80:95], v[200:203], a[180:183], v[80:95]
    ds_read_b64_tr_b16 v[198:199], v222 offset:45568
    v_mfma_f32_32x32x16_bf16 v[96:111], v[204:207], a[176:179], v[96:111]
    ds_read_b64_tr_b16 v[200:201], v223 offset:45056
    buffer_load_dwordx4 v214, s[24:27], s54 offen offset:2048 lds
    v_mfma_f32_32x32x16_bf16 v[112:127], v[204:207], a[180:183], v[112:127]
    ds_read_b64_tr_b16 v[202:203], v223 offset:45568
    s_waitcnt lgkmcnt(2)
    v_mfma_f32_32x32x16_bf16 v[0:15], v[192:195], a[184:187], v[0:15]
    ds_read_b64_tr_b16 v[204:205], v224 offset:45056
    buffer_load_dwordx4 v215, s[24:27], s54 offen offset:3072 lds
    v_mfma_f32_32x32x16_bf16 v[16:31], v[192:195], a[188:191], v[16:31]
    ds_read_b64_tr_b16 v[206:207], v224 offset:45568
    v_mfma_f32_32x32x16_bf16 v[32:47], v[196:199], a[184:187], v[32:47]
    s_add_u32 m0, s55, 8192
    s_nop 0
    buffer_load_dwordx4 v208, s[16:19], s15 offen offset:0 lds
    v_mfma_f32_32x32x16_bf16 v[48:63], v[196:199], a[188:191], v[48:63]
    s_waitcnt vmcnt(9)
    s_barrier
    ds_read_b128 a[192:195], v217 offset:0
    ds_read_b128 a[196:199], v217 offset:4096
    ds_read_b64_tr_b16 v[192:193], v221 offset:0
    ds_read_b64_tr_b16 v[194:195], v221 offset:512
    s_waitcnt lgkmcnt(4)
    v_mfma_f32_32x32x16_bf16 v[64:79], v[200:203], a[184:187], v[64:79]
    ds_read_b64_tr_b16 v[196:197], v222 offset:0
    ds_read_b128 a[200:203], v218 offset:0
    buffer_load_dwordx4 v209, s[16:19], s15 offen offset:1024 lds
    v_mfma_f32_32x32x16_bf16 v[80:95], v[200:203], a[188:191], v[80:95]
    ds_read_b64_tr_b16 v[198:199], v222 offset:512
    ds_read_b128 a[204:207], v218 offset:4096
    v_mfma_f32_32x32x16_bf16 v[96:111], v[204:207], a[184:187], v[96:111]
    ds_read_b64_tr_b16 v[200:201], v223 offset:0
    ds_read_b128 a[208:211], v219 offset:0
    buffer_load_dwordx4 v210, s[16:19], s15 offen offset:2048 lds
    v_mfma_f32_32x32x16_bf16 v[112:127], v[204:207], a[188:191], v[112:127]
    ds_read_b64_tr_b16 v[202:203], v223 offset:512
    ds_read_b128 a[212:215], v219 offset:4096
    s_waitcnt lgkmcnt(5)
    v_mfma_f32_32x32x16_bf16 v[0:15], v[192:195], a[192:195], v[0:15]
    ds_read_b64_tr_b16 v[204:205], v224 offset:0
    ds_read_b128 v[140:143], v251 offset:0
    buffer_load_dwordx4 v211, s[16:19], s15 offen offset:3072 lds
    v_mfma_f32_32x32x16_bf16 v[16:31], v[192:195], a[196:199], v[16:31]
    ds_read_b64_tr_b16 v[206:207], v224 offset:512
    ds_read_b128 a[216:219], v220 offset:0
    v_mfma_f32_32x32x16_bf16 v[32:47], v[196:199], a[192:195], v[32:47]
    ds_read_b64_tr_b16 v[192:193], v221 offset:4096
    ds_read_b128 a[220:223], v220 offset:4096
    s_add_u32 m0, s55, 12288
    s_add_u32 s54, s15, 36864
    buffer_load_dwordx4 v208, s[16:19], s54 offen offset:0 lds
    v_mfma_f32_32x32x16_bf16 v[48:63], v[196:199], a[196:199], v[48:63]
    ds_read_b64_tr_b16 v[194:195], v221 offset:4608
    s_bitcmp1_b32 s58, 6
    s_cbranch_scc0 mk_ut7
    ds_read_b64_tr_b16 v[232:233], v244 offset:0
    ds_read_b64_tr_b16 v[234:235], v245 offset:0
    ds_read_b64_tr_b16 v[236:237], v246 offset:0
    ds_read_b64_tr_b16 v[238:239], v247 offset:0
    s_cmp_eq_u32 s14, 1024
    s_cselect_b32 s60, 2162688, 0
    s_add_u32 s60, s60, s57
    s_waitcnt lgkmcnt(0)
    buffer_store_dwordx4 v[232:235], v230, s[32:35], s60 offen offset:0 sc1
    buffer_store_dwordx4 v[236:239], v230, s[32:35], s60 offen offset:16 sc1
mk_ut7:
    s_waitcnt lgkmcnt(4)
    v_mfma_f32_32x32x16_bf16 v[64:79], v[200:203], a[192:195], v[64:79]
    ds_read_b64_tr_b16 v[196:197], v222 offset:4096
    s_waitcnt lgkmcnt(2)
    v_dot2_f32_bf16 v249, v140, v132, v249
    v_dot2_f32_bf16 v250, v141, v133, v250
    buffer_load_dwordx4 v209, s[16:19], s54 offen offset:1024 lds
    v_mfma_f32_32x32x16_bf16 v[80:95], v[200:203], a[196:199], v[80:95]
    ds_read_b64_tr_b16 v[198:199], v222 offset:4608
    v_dot2_f32_bf16 v249, v142, v134, v249
    v_dot2_f32_bf16 v250, v143, v135, v250
    v_mfma_f32_32x32x16_bf16 v[96:111], v[204:207], a[192:195], v[96:111]
    ds_read_b64_tr_b16 v[200:201], v223 offset:4096
    buffer_load_dwordx4 v210, s[16:19], s54 offen offset:2048 lds
    v_mfma_f32_32x32x16_bf16 v[112:127], v[204:207], a[196:199], v[112:127]
    ds_read_b64_tr_b16 v[202:203], v223 offset:4608
    s_waitcnt lgkmcnt(2)
    v_mfma_f32_32x32x16_bf16 v[0:15], v[192:195], a[200:203], v[0:15]
    ds_read_b64_tr_b16 v[204:205], v224 offset:4096
    buffer_load_dwordx4 v211, s[16:19], s54 offen offset:3072 lds
    v_mfma_f32_32x32x16_bf16 v[16:31], v[192:195], a[204:207], v[16:31]
    ds_read_b64_tr_b16 v[206:207], v224 offset:4608
    v_mfma_f32_32x32x16_bf16 v[32:47], v[196:199], a[200:203], v[32:47]
    ds_read_b64_tr_b16 v[192:193], v221 offset:8192
    s_add_u32 m0, s56, 32768
    s_mul_i32 s54, s4, 4608
    s_add_u32 s54, s54, 128
    buffer_load_dwordx4 v212, s[20:23], s54 offen offset:0 lds
    v_mfma_f32_32x32x16_bf16 v[48:63], v[196:199], a[204:207], v[48:63]
    ds_read_b64_tr_b16 v[194:195], v221 offset:8704
    s_waitcnt lgkmcnt(2)
    v_mfma_f32_32x32x16_bf16 v[64:79], v[200:203], a[200:203], v[64:79]
    ds_read_b64_tr_b16 v[196:197], v222 offset:8192
    buffer_load_dwordx4 v213, s[20:23], s54 offen offset:1024 lds
    v_mfma_f32_32x32x16_bf16 v[80:95], v[200:203], a[204:207], v[80:95]
    ds_read_b64_tr_b16 v[198:199], v222 offset:8704
    v_mfma_f32_32x32x16_bf16 v[96:111], v[204:207], a[200:203], v[96:111]
    ds_read_b64_tr_b16 v[200:201], v223 offset:8192
    buffer_load_dwordx4 v214, s[24:27], s54 offen offset:2048 lds
    v_mfma_f32_32x32x16_bf16 v[112:127], v[204:207], a[204:207], v[112:127]
    ds_read_b64_tr_b16 v[202:203], v223 offset:8704
    s_waitcnt lgkmcnt(2)
    v_mfma_f32_32x32x16_bf16 v[0:15], v[192:195], a[208:211], v[0:15]
    ds_read_b64_tr_b16 v[204:205], v224 offset:8192
    buffer_load_dwordx4 v215, s[24:27], s54 offen offset:3072 lds
    v_mfma_f32_32x32x16_bf16 v[16:31], v[192:195], a[212:215], v[16:31]
    ds_read_b64_tr_b16 v[206:207], v224 offset:8704
    v_mfma_f32_32x32x16_bf16 v[32:47], v[196:199], a[208:211], v[32:47]
    ds_read_b64_tr_b16 v[192:193], v221 offset:12288
    s_add_u32 m0, s55, 0
    s_mul_i32 s54, s5, 4608
    s_add_u32 s54, s54, 128
    buffer_load_dwordx4 v212, s[20:23], s54 offen offset:0 lds
    v_mfma_f32_32x32x16_bf16 v[48:63], v[196:199], a[212:215], v[48:63]
    ds_read_b64_tr_b16 v[194:195], v221 offset:12800
    s_waitcnt lgkmcnt(2)
    v_mfma_f32_32x32x16_bf16 v[64:79], v[200:203], a[208:211], v[64:79]
    ds_read_b64_tr_b16 v[196:197], v222 offset:12288
    buffer_load_dwordx4 v213, s[20:23], s54 offen offset:1024 lds
    v_mfma_f32_32x32x16_bf16 v[80:95], v[200:203], a[212:215], v[80:95]
    ds_read_b64_tr_b16 v[198:199], v222 offset:12800
    v_mfma_f32_32x32x16_bf16 v[96:111], v[204:207], a[208:211], v[96:111]
    ds_read_b64_tr_b16 v[200:201], v223 offset:12288
    buffer_load_dwordx4 v214, s[24:27], s54 offen offset:2048 lds
    v_mfma_f32_32x32x16_bf16 v[112:127], v[204:207], a[212:215], v[112:127]
    ds_read_b64_tr_b16 v[202:203], v223 offset:12800
    s_waitcnt lgkmcnt(2)
    v_mfma_f32_32x32x16_bf16 v[0:15], v[192:195], a[216:219], v[0:15]
    ds_read_b64_tr_b16 v[204:205], v224 offset:12288
    buffer_load_dwordx4 v215, s[24:27], s54 offen offset:3072 lds
    v_mfma_f32_32x32x16_bf16 v[16:31], v[192:195], a[220:223], v[16:31]
    ds_read_b64_tr_b16 v[206:207], v224 offset:12800
    v_mfma_f32_32x32x16_bf16 v[32:47], v[196:199], a[216:219], v[32:47]
    s_add_u32 m0, s55, 4096
    s_mul_i32 s54, s6, 4608
    s_add_u32 s54, s54, 128
    buffer_load_dwordx4 v212, s[20:23], s54 offen offset:0 lds
    v_mfma_f32_32x32x16_bf16 v[48:63], v[196:199], a[220:223], v[48:63]
    s_waitcnt vmcnt(9)
    s_barrier
    ds_read_b128 a[224:227], v217 offset:8192
    ds_read_b128 a[228:231], v217 offset:12288
    ds_read_b64_tr_b16 v[192:193], v221 offset:16384
    ds_read_b64_tr_b16 v[194:195], v221 offset:16896
    s_waitcnt lgkmcnt(4)
    v_mfma_f32_32x32x16_bf16 v[64:79], v[200:203], a[216:219], v[64:79]
    ds_read_b64_tr_b16 v[196:197], v222 offset:16384
    ds_read_b128 a[232:235], v218 offset:8192
    buffer_load_dwordx4 v213, s[20:23], s54 offen offset:1024 lds
    v_mfma_f32_32x32x16_bf16 v[80:95], v[200:203], a[220:223], v[80:95]
    ds_read_b64_tr_b16 v[198:199], v222 offset:16896
    ds_read_b128 a[236:239], v218 offset:12288
    v_mfma_f32_32x32x16_bf16 v[96:111], v[204:207], a[216:219], v[96:111]
    ds_read_b64_tr_b16 v[200:201], v223 offset:16384
    ds_read_b128 a[240:243], v219 offset:8192
    v_mfma_f32_32x32x16_bf16 v[112:127], v[204:207], a[220:223], v[112:127]
    ds_read_b64_tr_b16 v[202:203], v223 offset:16896
    ds_read_b128 a[244:247], v219 offset:12288
    s_waitcnt lgkmcnt(5)
    v_mfma_f32_32x32x16_bf16 v[0:15], v[192:195], a[224:227], v[0:15]
    ds_read_b64_tr_b16 v[204:205], v224 offset:16384
    ds_read_b128 v[140:143], v251 offset:8192
    v_mfma_f32_32x32x16_bf16 v[16:31], v[192:195], a[228:231], v[16:31]
    ds_read_b64_tr_b16 v[206:207], v224 offset:16896
    ds_read_b128 a[248:251], v220 offset:8192
    v_mfma_f32_32x32x16_bf16 v[32:47], v[196:199], a[224:227], v[32:47]
    ds_read_b64_tr_b16 v[192:193], v221 offset:20480
    ds_read_b128 a[252:255], v220 offset:12288
    v_mfma_f32_32x32x16_bf16 v[48:63], v[196:199], a[228:231], v[48:63]
    ds_read_b64_tr_b16 v[194:195], v221 offset:20992
    s_bitcmp1_b32 s58, 7
    s_cbranch_scc0 mk_ut8
    ds_read_b64_tr_b16 v[232:233], v244 offset:8192
    ds_read_b64_tr_b16 v[234:235], v245 offset:8192
    ds_read_b64_tr_b16 v[236:237], v246 offset:8192
    ds_read_b64_tr_b16 v[238:239], v247 offset:8192
    s_cmp_eq_u32 s15, 1024
    s_cselect_b32 s60, 2162688, 0
    s_add_u32 s60, s60, s57
    s_waitcnt lgkmcnt(0)
    buffer_store_dwordx4 v[232:235], v230, s[32:35], s60 offen offset:0 sc1
    buffer_store_dwordx4 v[236:239], v230, s[32:35], s60 offen offset:16 sc1
mk_ut8:
    s_waitcnt lgkmcnt(4)
    v_mfma_f32_32x32x16_bf16 v[64:79], v[200:203], a[224:227], v[64:79]
    ds_read_b64_tr_b16 v[196:197], v222 offset:20480
    s_waitcnt lgkmcnt(2)
    v_dot2_f32_bf16 v249, v140, v136, v249
    v_dot2_f32_bf16 v250, v141, v137, v250
    v_mfma_f32_32x32x16_bf16 v[80:95], v[200:203], a[228:231], v[80:95]
    ds_read_b64_tr_b16 v[198:199], v222 offset:20992
    v_dot2_f32_bf16 v249, v142, v138, v249
    v_dot2_f32_bf16 v250, v143, v139, v250
    v_mfma_f32_32x32x16_bf16 v[96:111], v[204:207], a[224:227], v[96:111]
    ds_read_b64_tr_b16 v[200:201], v223 offset:20480
    v_add_u32 v217, s86, v217
    v_add_u32 v218, s86, v218
    v_add_u32 v219, s86, v219
    v_mfma_f32_32x32x16_bf16 v[112:127], v[204:207], a[228:231], v[112:127]
    ds_read_b64_tr_b16 v[202:203], v223 offset:20992
    v_add_u32 v220, s86, v220
    v_add_u32 v251, s86, v251
    v_add_u32 v244, s86, v244
    s_waitcnt lgkmcnt(2)
    v_mfma_f32_32x32x16_bf16 v[0:15], v[192:195], a[232:235], v[0:15]
    ds_read_b64_tr_b16 v[204:205], v224 offset:20480
    v_add_u32 v245, s86, v245
    v_add_u32 v246, s86, v246
    v_add_u32 v247, s86, v247
    v_mfma_f32_32x32x16_bf16 v[16:31], v[192:195], a[236:239], v[16:31]
    ds_read_b64_tr_b16 v[206:207], v224 offset:20992
    v_mfma_f32_32x32x16_bf16 v[32:47], v[196:199], a[232:235], v[32:47]
    ds_read_b64_tr_b16 v[192:193], v221 offset:24576
    v_mfma_f32_32x32x16_bf16 v[48:63], v[196:199], a[236:239], v[48:63]
    ds_read_b64_tr_b16 v[194:195], v221 offset:25088
    s_waitcnt lgkmcnt(2)
    v_mfma_f32_32x32x16_bf16 v[64:79], v[200:203], a[232:235], v[64:79]
    ds_read_b64_tr_b16 v[196:197], v222 offset:24576
    v_mfma_f32_32x32x16_bf16 v[80:95], v[200:203], a[236:239], v[80:95]
    ds_read_b64_tr_b16 v[198:199], v222 offset:25088
    v_mfma_f32_32x32x16_bf16 v[96:111], v[204:207], a[232:235], v[96:111]
    ds_read_b64_tr_b16 v[200:201], v223 offset:24576
    v_mfma_f32_32x32x16_bf16 v[112:127], v[204:207], a[236:239], v[112:127]
    ds_read_b64_tr_b16 v[202:203], v223 offset:25088
    s_waitcnt lgkmcnt(2)
    v_mfma_f32_32x32x16_bf16 v[0:15], v[192:195], a[240:243], v[0:15]
    ds_read_b64_tr_b16 v[204:205], v224 offset:24576
    v_mfma_f32_32x32x16_bf16 v[16:31], v[192:195], a[244:247], v[16:31]
    ds_read_b64_tr_b16 v[206:207], v224 offset:25088
    v_mfma_f32_32x32x16_bf16 v[32:47], v[196:199], a[240:243], v[32:47]
    ds_read_b64_tr_b16 v[192:193], v221 offset:28672
    v_mfma_f32_32x32x16_bf16 v[48:63], v[196:199], a[244:247], v[48:63]
    ds_read_b64_tr_b16 v[194:195], v221 offset:29184
    s_waitcnt lgkmcnt(2)
    v_mfma_f32_32x32x16_bf16 v[64:79], v[200:203], a[240:243], v[64:79]
    ds_read_b64_tr_b16 v[196:197], v222 offset:28672
    v_mfma_f32_32x32x16_bf16 v[80:95], v[200:203], a[244:247], v[80:95]
    ds_read_b64_tr_b16 v[198:199], v222 offset:29184
    v_mfma_f32_32x32x16_bf16 v[96:111], v[204:207], a[240:243], v[96:111]
    ds_read_b64_tr_b16 v[200:201], v223 offset:28672
    v_mfma_f32_32x32x16_bf16 v[112:127], v[204:207], a[244:247], v[112:127]
    ds_read_b64_tr_b16 v[202:203], v223 offset:29184
    s_waitcnt lgkmcnt(2)
    v_mfma_f32_32x32x16_bf16 v[0:15], v[192:195], a[248:251], v[0:15]
    ds_read_b64_tr_b16 v[204:205], v224 offset:28672
    v_mfma_f32_32x32x16_bf16 v[16:31], v[192:195], a[252:255], v[16:31]
    ds_read_b64_tr_b16 v[206:207], v224 offset:29184
    v_mfma_f32_32x32x16_bf16 v[32:47], v[196:199], a[248:251], v[32:47]
    v_mfma_f32_32x32x16_bf16 v[48:63], v[196:199], a[252:255], v[48:63]
    s_barrier
    ds_read_b128 v[160:163], v217 offset:0
    ds_read_b128 v[164:167], v217 offset:4096
    ds_read_b64_tr_b16 v[192:193], v221 offset:49152
    ds_read_b64_tr_b16 v[194:195], v221 offset:49664
    s_waitcnt lgkmcnt(4)
    v_mfma_f32_32x32x16_bf16 v[64:79], v[200:203], a[248:251], v[64:79]
    ds_read_b64_tr_b16 v[196:197], v222 offset:49152
    ds_read_b128 v[168:171], v218 offset:0
    buffer_load_dwordx4 v214, s[24:27], s54 offen offset:2048 lds
    v_mfma_f32_32x32x16_bf16 v[80:95], v[200:203], a[252:255], v[80:95]
    ds_read_b64_tr_b16 v[198:199], v222 offset:49664
    ds_read_b128 v[172:175], v218 offset:4096
    v_mfma_f32_32x32x16_bf16 v[96:111], v[204:207], a[248:251], v[96:111]
    ds_read_b64_tr_b16 v[200:201], v223 offset:49152
    ds_read_b128 v[176:179], v219 offset:0
    buffer_load_dwordx4 v215, s[24:27], s54 offen offset:3072 lds
    v_mfma_f32_32x32x16_bf16 v[112:127], v[204:207], a[252:255], v[112:127]
    ds_read_b64_tr_b16 v[202:203], v223 offset:49664
    ds_read_b128 v[180:183], v219 offset:4096
    s_waitcnt lgkmcnt(5)
    v_mfma_f32_32x32x16_bf16 v[0:15], v[192:195], v[160:163], v[0:15]
    ds_read_b64_tr_b16 v[204:205], v224 offset:49152
    ds_read_b128 v[140:143], v251 offset:0
    s_add_u32 m0, s56, 0
    s_mul_i32 s54, s7, 4608
    s_add_u32 s54, s54, 128
    buffer_load_dwordx4 v212, s[20:23], s54 offen offset:0 lds
    v_mfma_f32_32x32x16_bf16 v[16:31], v[192:195], v[164:167], v[16:31]
    ds_read_b64_tr_b16 v[206:207], v224 offset:49664
    ds_read_b128 v[184:187], v220 offset:0
    v_mfma_f32_32x32x16_bf16 v[32:47], v[196:199], v[160:163], v[32:47]
    ds_read_b64_tr_b16 v[192:193], v221 offset:53248
    ds_read_b128 v[188:191], v220 offset:4096
    buffer_load_dwordx4 v213, s[20:23], s54 offen offset:1024 lds
    v_mfma_f32_32x32x16_bf16 v[48:63], v[196:199], v[164:167], v[48:63]
    ds_read_b64_tr_b16 v[194:195], v221 offset:53760
    s_bitcmp1_b32 s58, 8
    s_cbranch_scc0 mk_ut9
    ds_read_b64_tr_b16 v[232:233], v244 offset:0
    ds_read_b64_tr_b16 v[234:235], v245 offset:0
    ds_read_b64_tr_b16 v[236:237], v246 offset:0
    ds_read_b64_tr_b16 v[238:239], v247 offset:0
    s_cmp_eq_u32 s47, 1024
    s_cselect_b32 s60, 2162688, 0
    s_add_u32 s60, s60, s57
    s_waitcnt lgkmcnt(0)
    buffer_store_dwordx4 v[232:235], v230, s[32:35], s60 offen offset:0 sc1
    buffer_store_dwordx4 v[236:239], v230, s[32:35], s60 offen offset:16 sc1
mk_ut9:
    s_waitcnt lgkmcnt(4)
    v_mfma_f32_32x32x16_bf16 v[64:79], v[200:203], v[160:163], v[64:79]
    ds_read_b64_tr_b16 v[196:197], v222 offset:53248
    s_waitcnt lgkmcnt(2)
    v_dot2_f32_bf16 v249, v140, v240, v249
    v_dot2_f32_bf16 v250, v141, v241, v250
    buffer_load_dwordx4 v214, s[24:27], s54 offen offset:2048 lds
    v_mfma_f32_32x32x16_bf16 v[80:95], v[200:203], v[164:167], v[80:95]
    ds_read_b64_tr_b16 v[198:199], v222 offset:53760
    v_dot2_f32_bf16 v249, v142, v242, v249
    v_dot2_f32_bf16 v250, v143, v243, v250
    v_mfma_f32_32x32x16_bf16 v[96:111], v[204:207], v[160:163], v[96:111]
    ds_read_b64_tr_b16 v[200:201], v223 offset:53248
    buffer_load_dwordx4 v215, s[24:27], s54 offen offset:3072 lds
    v_mfma_f32_32x32x16_bf16 v[112:127], v[204:207], v[164:167], v[112:127]
    ds_read_b64_tr_b16 v[202:203], v223 offset:53760
    v_add_f32 v249, v249, v250
    s_waitcnt lgkmcnt(2)
    v_mfma_f32_32x32x16_bf16 v[0:15], v[192:195], v[168:171], v[0:15]
    ds_read_b64_tr_b16 v[204:205], v224 offset:53248
    v_add_f32_dpp v249, v249, v249 quad_perm:[1,0,3,2] row_mask:0xf bank_mask:0xf
    s_add_u32 m0, s55, 8192
    s_mul_i32 s54, s12, 4608
    s_add_u32 s54, s54, 128
    buffer_load_dwordx4 v212, s[20:23], s54 offen offset:0 lds
    v_mfma_f32_32x32x16_bf16 v[16:31], v[192:195], v[172:175], v[16:31]
    ds_read_b64_tr_b16 v[206:207], v224 offset:53760
    v_add_f32_dpp v249, v249, v249 quad_perm:[2,3,0,1] row_mask:0xf bank_mask:0xf
    v_mfma_f32_32x32x16_bf16 v[32:47], v[196:199], v[168:171], v[32:47]
    ds_read_b64_tr_b16 v[192:193], v221 offset:57344
    v_add_f32_dpp v249, v249, v249 row_half_mirror row_mask:0xf bank_mask:0xf
    buffer_load_dwordx4 v213, s[20:23], s54 offen offset:1024 lds
    v_mfma_f32_32x32x16_bf16 v[48:63], v[196:199], v[172:175], v[48:63]
    ds_read_b64_tr_b16 v[194:195], v221 offset:57856
    v_mul_f32 v249, s53, v249
    v_exp_f32 v249, v249
    s_waitcnt lgkmcnt(2)
    v_mfma_f32_32x32x16_bf16 v[64:79], v[200:203], v[168:171], v[64:79]
    ds_read_b64_tr_b16 v[196:197], v222 offset:57344
    v_add_f32 v249, 1.0, v249
    v_rcp_f32 v249, v249
    buffer_load_dwordx4 v214, s[24:27], s54 offen offset:2048 lds
    v_mfma_f32_32x32x16_bf16 v[80:95], v[200:203], v[172:175], v[80:95]
    ds_read_b64_tr_b16 v[198:199], v222 offset:57856
    buffer_store_dword v249, v254, s[32:35], 0 offen sc1
    v_mfma_f32_32x32x16_bf16 v[96:111], v[204:207], v[168:171], v[96:111]
    ds_read_b64_tr_b16 v[200:201], v223 offset:57344
    s_bfe_u32 s60, s2, 0x20001
    s_mul_i32 s60, s60, 1152
    s_lshr_b32 s63, s2, 3
    s_mul_i32 s63, s63, 36
    s_add_u32 s60, s60, s63
    v_mbcnt_lo_u32_b32 v249, -1, 0
    v_mbcnt_hi_u32_b32 v249, -1, v249
    v_mfma_f32_32x32x16_bf16 v[112:127], v[204:207], v[172:175], v[112:127]
    ds_read_b64_tr_b16 v[202:203], v223 offset:57856
    v_cmp_gt_u32 vcc, 36, v249
    v_add_u32 v250, s60, v249
    s_lshl_b32 s60, s40, 8
    s_add_u32 s60, s60, 4096
    v_mul_u32_u24 v250, 1152, v250
    buffer_load_dwordx4 v215, s[24:27], s54 offen offset:3072 lds
    s_waitcnt lgkmcnt(2)
    v_mfma_f32_32x32x16_bf16 v[0:15], v[192:195], v[176:179], v[0:15]
    ds_read_b64_tr_b16 v[204:205], v224 offset:57344
    v_add_u32 v250, s60, v250
    v_mov_b32 v249, 2130706432
    v_cndmask_b32 v250, v249, v250, vcc
    v_mfma_f32_32x32x16_bf16 v[16:31], v[192:195], v[180:183], v[16:31]
    ds_read_b64_tr_b16 v[206:207], v224 offset:57856
    s_add_u32 m0, s55, 12288
    s_mul_i32 s54, s13, 4608
    s_add_u32 s54, s54, 128
    buffer_load_dwordx4 v212, s[20:23], s54 offen offset:0 lds
    v_mfma_f32_32x32x16_bf16 v[32:47], v[196:199], v[176:179], v[32:47]
    ds_read_b64_tr_b16 v[192:193], v221 offset:61440
    v_mfma_f32_32x32x16_bf16 v[48:63], v[196:199], v[180:183], v[48:63]
    ds_read_b64_tr_b16 v[194:195], v221 offset:61952
    buffer_load_dwordx4 v213, s[20:23], s54 offen offset:1024 lds
    s_waitcnt lgkmcnt(2)
    v_mfma_f32_32x32x16_bf16 v[64:79], v[200:203], v[176:179], v[64:79]
    ds_read_b64_tr_b16 v[196:197], v222 offset:61440
    v_mbcnt_lo_u32_b32 v232, -1, 0
    s_and_b32 s60, s2, 1
    s_lshl_b32 s60, s60, 7
    s_cmp_eq_u32 s40, 0
    s_cselect_b32 s60, s60, 2130706432
    v_mbcnt_hi_u32_b32 v232, -1, v232
    v_mov_b32 v219, s60
    v_mfma_f32_32x32x16_bf16 v[80:95], v[200:203], v[180:183], v[80:95]
    ds_read_b64_tr_b16 v[198:199], v222 offset:61952
    v_and_b32 v218, 1, v232
    v_mov_b32 v217, 2130706432
    v_cmp_eq_u32 vcc, 0, v232
    v_lshlrev_b32 v218, 7, v218
    s_cmp_eq_u32 s40, 0
    s_cselect_b32 s82, 0x80, 0
    s_cselect_b32 s60, 0, 2130706432
    v_add_u32 v218, s60, v218
    buffer_load_dwordx4 v214, s[24:27], s54 offen offset:2048 lds
    v_mfma_f32_32x32x16_bf16 v[96:111], v[204:207], v[176:179], v[96:111]
    ds_read_b64_tr_b16 v[200:201], v223 offset:61440
    v_cndmask_b32 v217, v217, v219, vcc
    v_lshlrev_b32 v232, 4, v232
    v_mov_b32 v219, 1
    s_mov_b32 s72, s94
    s_mov_b32 s73, s95
    s_movk_i32 s74, 256
    s_mov_b32 s75, 0x00020000
    v_mfma_f32_32x32x16_bf16 v[112:127], v[204:207], v[180:183], v[112:127]
    ds_read_b64_tr_b16 v[202:203], v223 offset:61952
    s_mul_i32 s80, s2, 28672
    s_add_u32 s80, s80, 25427968
    s_lshl_b32 s60, s40, 10
    s_add_u32 s60, s60, s80
    s_add_u32 s60, s60, 24576
    s_cmp_lt_u32 s40, 3
    s_cselect_b32 s60, s60, 2130706432
    v_add_u32 v220, s60, v232
    v_mov_b32 v208, -1
    buffer_load_dwordx4 v215, s[24:27], s54 offen offset:3072 lds
    s_waitcnt lgkmcnt(2)
    v_mfma_f32_32x32x16_bf16 v[0:15], v[192:195], v[184:187], v[0:15]
    ds_read_b64_tr_b16 v[204:205], v224 offset:61440
    s_mul_i32 s60, s40, 6144
    s_add_u32 s80, s80, s60
    s_add_u32 s81, s80, 4096
    v_mov_b32 v209, -1
    v_mov_b32 v210, -1
    v_mov_b32 v211, -1
    v_mfma_f32_32x32x16_bf16 v[16:31], v[192:195], v[188:191], v[16:31]
    ds_read_b64_tr_b16 v[206:207], v224 offset:61952
    s_add_u32 m0, s56, 16384
    s_mul_i32 s54, s14, 4608
    s_add_u32 s54, s54, 128
    buffer_load_dwordx4 v212, s[20:23], s54 offen offset:0 lds
    v_mfma_f32_32x32x16_bf16 v[32:47], v[196:199], v[184:187], v[32:47]
    v_mfma_f32_32x32x16_bf16 v[48:63], v[196:199], v[188:191], v[48:63]
    buffer_load_dwordx4 v213, s[20:23], s54 offen offset:1024 lds
    s_waitcnt vmcnt(19)
    s_barrier
    v_subrev_u32 v231, 0x10000, v221
    v_add_u32 v248, 0x10000, v221
    ds_read_b64_tr_b16 v[192:193], v221 offset:32768
    ds_read_b64_tr_b16 v[194:195], v221 offset:33280
    s_waitcnt lgkmcnt(2)
    v_mfma_f32_32x32x16_bf16 v[64:79], v[200:203], v[184:187], v[64:79]
    ds_read_b64_tr_b16 v[196:197], v221 offset:36864
    v_mfma_f32_32x32x16_bf16 v[80:95], v[200:203], v[188:191], v[80:95]
    ds_read_b64_tr_b16 v[198:199], v221 offset:37376
    buffer_load_dwordx4 v214, s[24:27], s54 offen offset:2048 lds
    v_mfma_f32_32x32x16_bf16 v[96:111], v[204:207], v[184:187], v[96:111]
    ds_read_b64_tr_b16 v[200:201], v221 offset:40960
    v_mfma_f32_32x32x16_bf16 v[112:127], v[204:207], v[188:191], v[112:127]
    ds_read_b64_tr_b16 v[202:203], v221 offset:41472
    buffer_load_dwordx4 v215, s[24:27], s54 offen offset:3072 lds
    s_waitcnt lgkmcnt(2)
    v_mfma_f32_32x32x16_bf16 v[128:143], v[192:195], a[0:3], 0
    ds_read_b64_tr_b16 v[204:205], v221 offset:45056
    v_mfma_f32_32x32x16_bf16 v[144:159], v[192:195], a[4:7], 0
    ds_read_b64_tr_b16 v[206:207], v221 offset:45568
    s_add_u32 m0, s87, 0
    s_mul_i32 s54, s15, 4608
    s_add_u32 s54, s54, 128
    buffer_load_dwordx4 v212, s[20:23], s54 offen offset:0 lds
    v_mfma_f32_32x32x16_bf16 v[128:143], v[196:199], a[8:11], v[128:143]
    ds_read_b64_tr_b16 v[192:193], v231 offset:0
    v_mfma_f32_32x32x16_bf16 v[144:159], v[196:199], a[12:15], v[144:159]
    ds_read_b64_tr_b16 v[194:195], v231 offset:512
    v_mul_f32 v244, s53, v0
    buffer_load_dwordx4 v213, s[20:23], s54 offen offset:1024 lds
    s_waitcnt lgkmcnt(2)
    v_mfma_f32_32x32x16_bf16 v[128:143], v[200:203], a[16:19], v[128:143]
    ds_read_b64_tr_b16 v[196:197], v231 offset:16384
    v_exp_f32 v244, v244
    v_mul_f32 v8, v0, v8
    v_mfma_f32_32x32x16_bf16 v[144:159], v[200:203], a[20:23], v[144:159]
    ds_read_b64_tr_b16 v[198:199], v231 offset:16896
    v_add_f32 v244, 1.0, v244
    v_mul_f32 v245, s53, v1
    v_rcp_f32 v244, v244
    buffer_load_dwordx4 v214, s[24:27], s54 offen offset:2048 lds
    v_mfma_f32_32x32x16_bf16 v[128:143], v[204:207], a[24:27], v[128:143]
    ds_read_b64_tr_b16 v[200:201], v231 offset:32768
    v_exp_f32 v245, v245
    v_mul_f32 v9, v1, v9
    v_mul_f32 v8, v8, v244
    v_mfma_f32_32x32x16_bf16 v[144:159], v[204:207], a[28:31], v[144:159]
    ds_read_b64_tr_b16 v[202:203], v231 offset:33280
    v_add_f32 v245, 1.0, v245
    v_mul_f32 v246, s53, v2
    v_rcp_f32 v245, v245
    buffer_load_dwordx4 v215, s[24:27], s54 offen offset:3072 lds
    s_waitcnt lgkmcnt(2)
    v_mfma_f32_32x32x16_bf16 v[128:143], v[192:195], a[32:35], v[128:143]
    ds_read_b64_tr_b16 v[204:205], v231 offset:49152
    v_exp_f32 v246, v246
    v_mul_f32 v10, v2, v10
    v_mul_f32 v9, v9, v245
    v_mfma_f32_32x32x16_bf16 v[144:159], v[192:195], a[36:39], v[144:159]
    ds_read_b64_tr_b16 v[206:207], v231 offset:49664
    v_add_f32 v246, 1.0, v246
    v_mul_f32 v247, s53, v3
    v_cvt_pk_bf16_f32 v0, v8, v9
    v_rcp_f32 v246, v246
    s_add_u32 m0, s87, 4096
    s_mul_i32 s54, s47, 4608
    s_add_u32 s54, s54, 128
    buffer_load_dwordx4 v212, s[20:23], s54 offen offset:0 lds
    v_mfma_f32_32x32x16_bf16 v[128:143], v[196:199], a[40:43], v[128:143]
    v_exp_f32 v247, v247
    v_mul_f32 v11, v3, v11
    v_mul_f32 v10, v10, v246
    v_mfma_f32_32x32x16_bf16 v[144:159], v[196:199], a[44:47], v[144:159]
    v_add_f32 v247, 1.0, v247
    v_mul_f32 v244, s53, v4
    v_rcp_f32 v247, v247
    buffer_load_dwordx4 v213, s[20:23], s54 offen offset:1024 lds
    s_waitcnt vmcnt(10)
    s_barrier
    ds_read_b64_tr_b16 v[192:193], v231 offset:4096
    ds_read_b64_tr_b16 v[194:195], v231 offset:4608
    s_waitcnt lgkmcnt(2)
    v_mfma_f32_32x32x16_bf16 v[128:143], v[200:203], a[48:51], v[128:143]
    ds_read_b64_tr_b16 v[196:197], v231 offset:20480
    v_exp_f32 v244, v244
    v_mul_f32 v12, v4, v12
    v_mul_f32 v11, v11, v247
    v_mfma_f32_32x32x16_bf16 v[144:159], v[200:203], a[52:55], v[144:159]
    ds_read_b64_tr_b16 v[198:199], v231 offset:20992
    v_add_f32 v244, 1.0, v244
    v_mul_f32 v245, s53, v5
    v_cvt_pk_bf16_f32 v1, v10, v11
    v_rcp_f32 v244, v244
    buffer_load_dwordx4 v214, s[24:27], s54 offen offset:2048 lds
    v_mfma_f32_32x32x16_bf16 v[128:143], v[204:207], a[56:59], v[128:143]
    ds_read_b64_tr_b16 v[200:201], v231 offset:36864
    v_exp_f32 v245, v245
    v_mul_f32 v13, v5, v13
    v_mul_f32 v12, v12, v244
    v_mfma_f32_32x32x16_bf16 v[144:159], v[204:207], a[60:63], v[144:159]
    ds_read_b64_tr_b16 v[202:203], v231 offset:37376
    v_add_f32 v245, 1.0, v245
    v_mul_f32 v246, s53, v6
    v_rcp_f32 v245, v245
    buffer_load_dwordx4 v215, s[24:27], s54 offen offset:3072 lds
    s_waitcnt lgkmcnt(2)
    v_mfma_f32_32x32x16_bf16 v[128:143], v[192:195], a[64:67], v[128:143]
    ds_read_b64_tr_b16 v[204:205], v231 offset:53248
    v_exp_f32 v246, v246
    v_mul_f32 v14, v6, v14
    v_mul_f32 v13, v13, v245
    v_mfma_f32_32x32x16_bf16 v[144:159], v[192:195], a[68:71], v[144:159]
    ds_read_b64_tr_b16 v[206:207], v231 offset:53760
    v_add_f32 v246, 1.0, v246
    v_mul_f32 v247, s53, v7
    v_cvt_pk_bf16_f32 v2, v12, v13
    v_rcp_f32 v246, v246
    v_mfma_f32_32x32x16_bf16 v[128:143], v[196:199], a[72:75], v[128:143]
    ds_read_b64_tr_b16 v[192:193], v221 offset:0
    v_exp_f32 v247, v247
    v_mul_f32 v15, v7, v15
    v_mul_f32 v14, v14, v246
    v_mfma_f32_32x32x16_bf16 v[144:159], v[196:199], a[76:79], v[144:159]
    ds_read_b64_tr_b16 v[194:195], v221 offset:512
    v_add_f32 v247, 1.0, v247
    v_rcp_f32 v247, v247
    s_waitcnt lgkmcnt(2)
    v_mfma_f32_32x32x16_bf16 v[128:143], v[200:203], a[80:83], v[128:143]
    ds_read_b64_tr_b16 v[196:197], v221 offset:4096
    v_mul_f32 v244, s53, v16
    v_mul_f32 v15, v15, v247
    v_cvt_pk_bf16_f32 v3, v14, v15
    buffer_store_dwordx4 v[0:3], v225, s[32:35], s48 offen offset:0 sc1
    v_mfma_f32_32x32x16_bf16 v[144:159], v[200:203], a[84:87], v[144:159]
    ds_read_b64_tr_b16 v[198:199], v221 offset:4608
    v_exp_f32 v244, v244
    v_mul_f32 v24, v16, v24
    v_mfma_f32_32x32x16_bf16 v[128:143], v[204:207], a[88:91], v[128:143]
    ds_read_b64_tr_b16 v[200:201], v221 offset:8192
    v_add_f32 v244, 1.0, v244
    v_mul_f32 v245, s53, v17
    v_rcp_f32 v244, v244
    s_add_u32 m0, s59, 16384
    s_mul_i32 s54, s4, 4608
    buffer_load_dwordx4 v216, s[28:31], s54 offen lds
    v_mfma_f32_32x32x16_bf16 v[144:159], v[204:207], a[92:95], v[144:159]
    ds_read_b64_tr_b16 v[202:203], v221 offset:8704
    v_exp_f32 v245, v245
    v_mul_f32 v25, v17, v25
    v_mul_f32 v24, v24, v244
    s_waitcnt lgkmcnt(2)
    v_mfma_f32_32x32x16_bf16 v[128:143], v[192:195], a[96:99], v[128:143]
    ds_read_b64_tr_b16 v[204:205], v221 offset:12288
    v_add_f32 v245, 1.0, v245
    v_mul_f32 v246, s53, v18
    v_rcp_f32 v245, v245
    v_mfma_f32_32x32x16_bf16 v[144:159], v[192:195], a[100:103], v[144:159]
    ds_read_b64_tr_b16 v[206:207], v221 offset:12800
    v_exp_f32 v246, v246
    v_mul_f32 v26, v18, v26
    v_mul_f32 v25, v25, v245
    v_mfma_f32_32x32x16_bf16 v[128:143], v[196:199], a[104:107], v[128:143]
    ds_read_b64_tr_b16 v[192:193], v231 offset:8192
    v_add_f32 v246, 1.0, v246
    v_mul_f32 v247, s53, v19
    v_cvt_pk_bf16_f32 v16, v24, v25
    v_rcp_f32 v246, v246
    v_mfma_f32_32x32x16_bf16 v[144:159], v[196:199], a[108:111], v[144:159]
    ds_read_b64_tr_b16 v[194:195], v231 offset:8704
    v_exp_f32 v247, v247
    v_mul_f32 v27, v19, v27
    v_mul_f32 v26, v26, v246
    s_waitcnt lgkmcnt(2)
    v_mfma_f32_32x32x16_bf16 v[128:143], v[200:203], a[112:115], v[128:143]
    ds_read_b64_tr_b16 v[196:197], v231 offset:24576
    v_add_f32 v247, 1.0, v247
    v_mul_f32 v244, s53, v20
    v_rcp_f32 v247, v247
    v_mfma_f32_32x32x16_bf16 v[144:159], v[200:203], a[116:119], v[144:159]
    ds_read_b64_tr_b16 v[198:199], v231 offset:25088
    v_exp_f32 v244, v244
    v_mul_f32 v28, v20, v28
    v_mul_f32 v27, v27, v247
    v_mfma_f32_32x32x16_bf16 v[128:143], v[204:207], a[120:123], v[128:143]
    ds_read_b64_tr_b16 v[200:201], v231 offset:40960
    v_add_f32 v244, 1.0, v244
    v_mul_f32 v245, s53, v21
    v_cvt_pk_bf16_f32 v17, v26, v27
    v_rcp_f32 v244, v244
    v_mfma_f32_32x32x16_bf16 v[144:159], v[204:207], a[124:127], v[144:159]
    ds_read_b64_tr_b16 v[202:203], v231 offset:41472
    v_exp_f32 v245, v245
    v_mul_f32 v29, v21, v29
    v_mul_f32 v28, v28, v244
    s_waitcnt lgkmcnt(2)
    v_mfma_f32_32x32x16_bf16 v[128:143], v[192:195], a[128:131], v[128:143]
    ds_read_b64_tr_b16 v[204:205], v231 offset:57344
    v_add_f32 v245, 1.0, v245
    v_mul_f32 v246, s53, v22
    v_rcp_f32 v245, v245
    v_mfma_f32_32x32x16_bf16 v[144:159], v[192:195], a[132:135], v[144:159]
    ds_read_b64_tr_b16 v[206:207], v231 offset:57856
    v_exp_f32 v246, v246
    v_mul_f32 v30, v22, v30
    v_mul_f32 v29, v29, v245
    v_mfma_f32_32x32x16_bf16 v[128:143], v[196:199], a[136:139], v[128:143]
    ds_read_b64_tr_b16 v[192:193], v231 offset:12288
    v_add_f32 v246, 1.0, v246
    v_mul_f32 v247, s53, v23
    v_cvt_pk_bf16_f32 v18, v28, v29
    v_rcp_f32 v246, v246
    v_mfma_f32_32x32x16_bf16 v[144:159], v[196:199], a[140:143], v[144:159]
    ds_read_b64_tr_b16 v[194:195], v231 offset:12800
    v_exp_f32 v247, v247
    v_mul_f32 v31, v23, v31
    v_mul_f32 v30, v30, v246
    s_waitcnt lgkmcnt(2)
    v_mfma_f32_32x32x16_bf16 v[128:143], v[200:203], a[144:147], v[128:143]
    ds_read_b64_tr_b16 v[196:197], v231 offset:28672
    v_add_f32 v247, 1.0, v247
    v_rcp_f32 v247, v247
    v_mfma_f32_32x32x16_bf16 v[144:159], v[200:203], a[148:151], v[144:159]
    ds_read_b64_tr_b16 v[198:199], v231 offset:29184
    v_mul_f32 v244, s53, v32
    v_mul_f32 v31, v31, v247
    v_cvt_pk_bf16_f32 v19, v30, v31
    buffer_store_dwordx4 v[16:19], v225, s[32:35], s48 offen offset:2048 sc1
    v_mfma_f32_32x32x16_bf16 v[128:143], v[204:207], a[152:155], v[128:143]
    ds_read_b64_tr_b16 v[200:201], v231 offset:45056
    v_exp_f32 v244, v244
    v_mul_f32 v40, v32, v40
    v_mfma_f32_32x32x16_bf16 v[144:159], v[204:207], a[156:159], v[144:159]
    ds_read_b64_tr_b16 v[202:203], v231 offset:45568
    v_add_f32 v244, 1.0, v244
    v_mul_f32 v245, s53, v33
    v_rcp_f32 v244, v244
    s_waitcnt lgkmcnt(2)
    v_mfma_f32_32x32x16_bf16 v[128:143], v[192:195], a[160:163], v[128:143]
    ds_read_b64_tr_b16 v[204:205], v231 offset:61440
    v_exp_f32 v245, v245
    v_mul_f32 v41, v33, v41
    v_mul_f32 v40, v40, v244
    v_mfma_f32_32x32x16_bf16 v[144:159], v[192:195], a[164:167], v[144:159]
    ds_read_b64_tr_b16 v[206:207], v231 offset:61952
    v_add_f32 v245, 1.0, v245
    v_mul_f32 v246, s53, v34
    v_rcp_f32 v245, v245
    s_waitcnt vmcnt(3)
    s_barrier
    buffer_atomic_add v219, v217, s[72:75], 0 offen sc1
    v_mfma_f32_32x32x16_bf16 v[128:143], v[196:199], a[168:171], v[128:143]
    ds_read_b64_tr_b16 v[192:193], v221 offset:16384
    v_exp_f32 v246, v246
    v_mul_f32 v42, v34, v42
    v_mul_f32 v41, v41, v245
    v_mfma_f32_32x32x16_bf16 v[144:159], v[196:199], a[172:175], v[144:159]
    ds_read_b64_tr_b16 v[194:195], v221 offset:16896
    v_add_f32 v246, 1.0, v246
    v_mul_f32 v247, s53, v35
    v_cvt_pk_bf16_f32 v32, v40, v41
    v_rcp_f32 v246, v246
    s_waitcnt lgkmcnt(2)
    v_mfma_f32_32x32x16_bf16 v[128:143], v[200:203], a[176:179], v[128:143]
    ds_read_b64_tr_b16 v[196:197], v221 offset:20480
    v_exp_f32 v247, v247
    v_mul_f32 v43, v35, v43
    v_mul_f32 v42, v42, v246
    v_mfma_f32_32x32x16_bf16 v[144:159], v[200:203], a[180:183], v[144:159]
    ds_read_b64_tr_b16 v[198:199], v221 offset:20992
    v_add_f32 v247, 1.0, v247
    v_mul_f32 v244, s53, v36
    v_rcp_f32 v247, v247
    v_mfma_f32_32x32x16_bf16 v[128:143], v[204:207], a[184:187], v[128:143]
    ds_read_b64_tr_b16 v[200:201], v221 offset:24576
    v_exp_f32 v244, v244
    v_mul_f32 v44, v36, v44
    v_mul_f32 v43, v43, v247
    v_mfma_f32_32x32x16_bf16 v[144:159], v[204:207], a[188:191], v[144:159]
    ds_read_b64_tr_b16 v[202:203], v221 offset:25088
    v_add_f32 v244, 1.0, v244
    v_mul_f32 v245, s53, v37
    v_cvt_pk_bf16_f32 v33, v42, v43
    v_rcp_f32 v244, v244
    s_waitcnt lgkmcnt(2)
    v_mfma_f32_32x32x16_bf16 v[128:143], v[192:195], a[192:195], v[128:143]
    ds_read_b64_tr_b16 v[204:205], v221 offset:28672
    v_exp_f32 v245, v245
    v_mul_f32 v45, v37, v45
    v_mul_f32 v44, v44, v244
    v_mfma_f32_32x32x16_bf16 v[144:159], v[192:195], a[196:199], v[144:159]
    ds_read_b64_tr_b16 v[206:207], v221 offset:29184
    v_add_f32 v245, 1.0, v245
    v_mul_f32 v246, s53, v38
    v_rcp_f32 v245, v245
    v_mfma_f32_32x32x16_bf16 v[128:143], v[196:199], a[200:203], v[128:143]
    ds_read_b64_tr_b16 v[192:193], v248 offset:0
    v_exp_f32 v246, v246
    v_mul_f32 v46, v38, v46
    v_mul_f32 v45, v45, v245
    v_mfma_f32_32x32x16_bf16 v[144:159], v[196:199], a[204:207], v[144:159]
    ds_read_b64_tr_b16 v[194:195], v248 offset:512
    v_add_f32 v246, 1.0, v246
    v_mul_f32 v247, s53, v39
    v_cvt_pk_bf16_f32 v34, v44, v45
    v_rcp_f32 v246, v246
    s_waitcnt lgkmcnt(2)
    v_mfma_f32_32x32x16_bf16 v[128:143], v[200:203], a[208:211], v[128:143]
    ds_read_b64_tr_b16 v[196:197], v248 offset:8192
    v_exp_f32 v247, v247
    v_mul_f32 v47, v39, v47
    v_mul_f32 v46, v46, v246
    v_mfma_f32_32x32x16_bf16 v[144:159], v[200:203], a[212:215], v[144:159]
    ds_read_b64_tr_b16 v[198:199], v248 offset:8704
    v_add_f32 v247, 1.0, v247
    v_rcp_f32 v247, v247
    v_mfma_f32_32x32x16_bf16 v[128:143], v[204:207], a[216:219], v[128:143]
    ds_read_b64_tr_b16 v[200:201], v248 offset:16384
    v_mul_f32 v244, s53, v48
    v_mul_f32 v47, v47, v247
    v_cvt_pk_bf16_f32 v35, v46, v47
    buffer_store_dwordx4 v[32:35], v225, s[32:35], s48 offen offset:512 sc1
    v_mfma_f32_32x32x16_bf16 v[144:159], v[204:207], a[220:223], v[144:159]
    ds_read_b64_tr_b16 v[202:203], v248 offset:16896
    v_exp_f32 v244, v244
    v_mul_f32 v56, v48, v56
    s_waitcnt lgkmcnt(2)
    v_mfma_f32_32x32x16_bf16 v[128:143], v[192:195], a[224:227], v[128:143]
    ds_read_b64_tr_b16 v[204:205], v248 offset:24576
    v_add_f32 v244, 1.0, v244
    v_mul_f32 v245, s53, v49
    v_rcp_f32 v244, v244
    v_mfma_f32_32x32x16_bf16 v[144:159], v[192:195], a[228:231], v[144:159]
    ds_read_b64_tr_b16 v[206:207], v248 offset:25088
    v_exp_f32 v245, v245
    v_mul_f32 v57, v49, v57
    v_mul_f32 v56, v56, v244
    v_mfma_f32_32x32x16_bf16 v[128:143], v[196:199], a[232:235], v[128:143]
    ds_read_b64_tr_b16 v[192:193], v248 offset:4096
    v_add_f32 v245, 1.0, v245
    v_mul_f32 v246, s53, v50
    v_rcp_f32 v245, v245
    v_mfma_f32_32x32x16_bf16 v[144:159], v[196:199], a[236:239], v[144:159]
    ds_read_b64_tr_b16 v[194:195], v248 offset:4608
    v_exp_f32 v246, v246
    v_mul_f32 v58, v50, v58
    v_mul_f32 v57, v57, v245
    s_waitcnt lgkmcnt(2)
    v_mfma_f32_32x32x16_bf16 v[128:143], v[200:203], a[240:243], v[128:143]
    ds_read_b64_tr_b16 v[196:197], v248 offset:12288
    v_add_f32 v246, 1.0, v246
    v_mul_f32 v247, s53, v51
    v_cvt_pk_bf16_f32 v48, v56, v57
    v_rcp_f32 v246, v246
    v_mfma_f32_32x32x16_bf16 v[144:159], v[200:203], a[244:247], v[144:159]
    ds_read_b64_tr_b16 v[198:199], v248 offset:12800
    v_exp_f32 v247, v247
    v_mul_f32 v59, v51, v59
    v_mul_f32 v58, v58, v246
    s_add_u32 m0, s59, 20480
    s_mul_i32 s54, s5, 4608
    buffer_load_dwordx4 v216, s[28:31], s54 offen lds
    v_mfma_f32_32x32x16_bf16 v[128:143], v[204:207], a[248:251], v[128:143]
    ds_read_b64_tr_b16 v[200:201], v248 offset:20480
    v_add_f32 v247, 1.0, v247
    v_mul_f32 v244, s53, v52
    v_rcp_f32 v247, v247
    v_mfma_f32_32x32x16_bf16 v[144:159], v[204:207], a[252:255], v[144:159]
    ds_read_b64_tr_b16 v[202:203], v248 offset:20992
    v_exp_f32 v244, v244
    v_mul_f32 v60, v52, v60
    v_mul_f32 v59, v59, v247
    s_waitcnt lgkmcnt(2)
    v_mfma_f32_32x32x16_bf16 v[128:143], v[192:195], v[160:163], v[128:143]
    ds_read_b64_tr_b16 v[204:205], v248 offset:28672
    v_add_f32 v244, 1.0, v244
    v_mul_f32 v245, s53, v53
    v_cvt_pk_bf16_f32 v49, v58, v59
    v_rcp_f32 v244, v244
    v_mfma_f32_32x32x16_bf16 v[144:159], v[192:195], v[164:167], v[144:159]
    ds_read_b64_tr_b16 v[206:207], v248 offset:29184
    v_exp_f32 v245, v245
    v_mul_f32 v61, v53, v61
    v_mul_f32 v60, v60, v244
    v_mfma_f32_32x32x16_bf16 v[128:143], v[196:199], v[168:171], v[128:143]
    v_subrev_u32 v231, 0x10000, v222
    v_add_u32 v248, 0x10000, v222
    ds_read_b64_tr_b16 v[192:193], v222 offset:32768
    v_add_f32 v245, 1.0, v245
    v_mul_f32 v246, s53, v54
    v_rcp_f32 v245, v245
    v_mfma_f32_32x32x16_bf16 v[144:159], v[196:199], v[172:175], v[144:159]
    ds_read_b64_tr_b16 v[194:195], v222 offset:33280
    v_exp_f32 v246, v246
    v_mul_f32 v62, v54, v62
    v_mul_f32 v61, v61, v245
    s_waitcnt lgkmcnt(2)
    v_mfma_f32_32x32x16_bf16 v[128:143], v[200:203], v[176:179], v[128:143]
    ds_read_b64_tr_b16 v[196:197], v222 offset:36864
    v_add_f32 v246, 1.0, v246
    v_mul_f32 v247, s53, v55
    v_cvt_pk_bf16_f32 v50, v60, v61
    v_rcp_f32 v246, v246
    v_mfma_f32_32x32x16_bf16 v[144:159], v[200:203], v[180:183], v[144:159]
    ds_read_b64_tr_b16 v[198:199], v222 offset:37376
    v_exp_f32 v247, v247
    v_mul_f32 v63, v55, v63
    v_mul_f32 v62, v62, v246
    v_mfma_f32_32x32x16_bf16 v[128:143], v[204:207], v[184:187], v[128:143]
    ds_read_b64_tr_b16 v[200:201], v222 offset:40960
    v_add_f32 v247, 1.0, v247
    v_rcp_f32 v247, v247
    v_mfma_f32_32x32x16_bf16 v[144:159], v[204:207], v[188:191], v[144:159]
    ds_read_b64_tr_b16 v[202:203], v222 offset:41472
    v_mul_f32 v63, v63, v247
    v_cvt_pk_bf16_f32 v51, v62, v63
    buffer_store_dwordx4 v[48:51], v225, s[32:35], s48 offen offset:2560 sc1
    s_waitcnt lgkmcnt(2)
    v_mfma_f32_32x32x16_bf16 v[0:15], v[192:195], a[0:3], 0
    ds_read_b64_tr_b16 v[204:205], v222 offset:45056
    v_mfma_f32_32x32x16_bf16 v[16:31], v[192:195], a[4:7], 0
    ds_read_b64_tr_b16 v[206:207], v222 offset:45568
    s_add_u32 m0, s59, 24576
    s_mul_i32 s54, s6, 4608
    buffer_load_dwordx4 v216, s[28:31], s54 offen lds
    v_mfma_f32_32x32x16_bf16 v[0:15], v[196:199], a[8:11], v[0:15]
    ds_read_b64_tr_b16 v[192:193], v231 offset:0
    v_mfma_f32_32x32x16_bf16 v[16:31], v[196:199], a[12:15], v[16:31]
    ds_read_b64_tr_b16 v[194:195], v231 offset:512
    v_mul_f32 v244, s53, v64
    s_waitcnt lgkmcnt(2)
    v_mfma_f32_32x32x16_bf16 v[0:15], v[200:203], a[16:19], v[0:15]
    ds_read_b64_tr_b16 v[196:197], v231 offset:16384
    v_exp_f32 v244, v244
    v_mul_f32 v72, v64, v72
    v_mfma_f32_32x32x16_bf16 v[16:31], v[200:203], a[20:23], v[16:31]
    ds_read_b64_tr_b16 v[198:199], v231 offset:16896
    v_add_f32 v244, 1.0, v244
    v_mul_f32 v245, s53, v65
    v_rcp_f32 v244, v244
    v_mfma_f32_32x32x16_bf16 v[0:15], v[204:207], a[24:27], v[0:15]
    ds_read_b64_tr_b16 v[200:201], v231 offset:32768
    v_exp_f32 v245, v245
    v_mul_f32 v73, v65, v73
    v_mul_f32 v72, v72, v244
    v_mfma_f32_32x32x16_bf16 v[16:31], v[204:207], a[28:31], v[16:31]
    ds_read_b64_tr_b16 v[202:203], v231 offset:33280
    v_add_f32 v245, 1.0, v245
    v_mul_f32 v246, s53, v66
    v_rcp_f32 v245, v245
    s_waitcnt lgkmcnt(2)
    v_mfma_f32_32x32x16_bf16 v[0:15], v[192:195], a[32:35], v[0:15]
    ds_read_b64_tr_b16 v[204:205], v231 offset:49152
    v_exp_f32 v246, v246
    v_mul_f32 v74, v66, v74
    v_mul_f32 v73, v73, v245
    v_mfma_f32_32x32x16_bf16 v[16:31], v[192:195], a[36:39], v[16:31]
    ds_read_b64_tr_b16 v[206:207], v231 offset:49664
    v_add_f32 v246, 1.0, v246
    v_mul_f32 v247, s53, v67
    v_cvt_pk_bf16_f32 v64, v72, v73
    v_rcp_f32 v246, v246
    v_mfma_f32_32x32x16_bf16 v[0:15], v[196:199], a[40:43], v[0:15]
    ds_read_b64_tr_b16 v[192:193], v231 offset:4096
    v_exp_f32 v247, v247
    v_mul_f32 v75, v67, v75
    v_mul_f32 v74, v74, v246
    s_add_u32 m0, s59, 28672
    s_mul_i32 s54, s7, 4608
    buffer_load_dwordx4 v216, s[28:31], s54 offen lds
    v_mfma_f32_32x32x16_bf16 v[16:31], v[196:199], a[44:47], v[16:31]
    ds_read_b64_tr_b16 v[194:195], v231 offset:4608
    v_add_f32 v247, 1.0, v247
    v_mul_f32 v244, s53, v68
    v_rcp_f32 v247, v247
    s_waitcnt lgkmcnt(2)
    v_mfma_f32_32x32x16_bf16 v[0:15], v[200:203], a[48:51], v[0:15]
    ds_read_b64_tr_b16 v[196:197], v231 offset:20480
    v_exp_f32 v244, v244
    v_mul_f32 v76, v68, v76
    v_mul_f32 v75, v75, v247
    v_mfma_f32_32x32x16_bf16 v[16:31], v[200:203], a[52:55], v[16:31]
    ds_read_b64_tr_b16 v[198:199], v231 offset:20992
    v_add_f32 v244, 1.0, v244
    v_mul_f32 v245, s53, v69
    v_cvt_pk_bf16_f32 v65, v74, v75
    v_rcp_f32 v244, v244
    v_mfma_f32_32x32x16_bf16 v[0:15], v[204:207], a[56:59], v[0:15]
    ds_read_b64_tr_b16 v[200:201], v231 offset:36864
    v_exp_f32 v245, v245
    v_mul_f32 v77, v69, v77
    v_mul_f32 v76, v76, v244
    v_mfma_f32_32x32x16_bf16 v[16:31], v[204:207], a[60:63], v[16:31]
    ds_read_b64_tr_b16 v[202:203], v231 offset:37376
    v_add_f32 v245, 1.0, v245
    v_mul_f32 v246, s53, v70
    v_rcp_f32 v245, v245
    s_waitcnt lgkmcnt(2)
    v_mfma_f32_32x32x16_bf16 v[0:15], v[192:195], a[64:67], v[0:15]
    ds_read_b64_tr_b16 v[204:205], v231 offset:53248
    v_exp_f32 v246, v246
    v_mul_f32 v78, v70, v78
    v_mul_f32 v77, v77, v245
    v_mfma_f32_32x32x16_bf16 v[16:31], v[192:195], a[68:71], v[16:31]
    ds_read_b64_tr_b16 v[206:207], v231 offset:53760
    v_add_f32 v246, 1.0, v246
    v_mul_f32 v247, s53, v71
    v_cvt_pk_bf16_f32 v66, v76, v77
    v_rcp_f32 v246, v246
    v_mfma_f32_32x32x16_bf16 v[0:15], v[196:199], a[72:75], v[0:15]
    ds_read_b64_tr_b16 v[192:193], v222 offset:0
    v_exp_f32 v247, v247
    v_mul_f32 v79, v71, v79
    v_mul_f32 v78, v78, v246
    v_mfma_f32_32x32x16_bf16 v[16:31], v[196:199], a[76:79], v[16:31]
    ds_read_b64_tr_b16 v[194:195], v222 offset:512
    v_add_f32 v247, 1.0, v247
    v_rcp_f32 v247, v247
    s_waitcnt lgkmcnt(2)
    v_mfma_f32_32x32x16_bf16 v[0:15], v[200:203], a[80:83], v[0:15]
    ds_read_b64_tr_b16 v[196:197], v222 offset:4096
    v_mul_f32 v244, s53, v80
    v_mul_f32 v79, v79, v247
    v_cvt_pk_bf16_f32 v67, v78, v79
    buffer_store_dwordx4 v[64:67], v225, s[32:35], s49 offen offset:0 sc1
    v_mfma_f32_32x32x16_bf16 v[16:31], v[200:203], a[84:87], v[16:31]
    ds_read_b64_tr_b16 v[198:199], v222 offset:4608
    v_exp_f32 v244, v244
    v_mul_f32 v88, v80, v88
    v_mfma_f32_32x32x16_bf16 v[0:15], v[204:207], a[88:91], v[0:15]
    ds_read_b64_tr_b16 v[200:201], v222 offset:8192
    v_add_f32 v244, 1.0, v244
    v_mul_f32 v245, s53, v81
    v_rcp_f32 v244, v244
    buffer_load_dword v229, v250, s[36:39], 0 offen offset:0
    v_mfma_f32_32x32x16_bf16 v[16:31], v[204:207], a[92:95], v[16:31]
    ds_read_b64_tr_b16 v[202:203], v222 offset:8704
    v_exp_f32 v245, v245
    v_mul_f32 v89, v81, v89
    v_mul_f32 v88, v88, v244
    s_waitcnt lgkmcnt(2)
    v_mfma_f32_32x32x16_bf16 v[0:15], v[192:195], a[96:99], v[0:15]
    ds_read_b64_tr_b16 v[204:205], v222 offset:12288
    v_add_f32 v245, 1.0, v245
    v_mul_f32 v246, s53, v82
    v_rcp_f32 v245, v245
    v_mfma_f32_32x32x16_bf16 v[16:31], v[192:195], a[100:103], v[16:31]
    ds_read_b64_tr_b16 v[206:207], v222 offset:12800
    v_exp_f32 v246, v246
    v_mul_f32 v90, v82, v90
    v_mul_f32 v89, v89, v245
    v_mfma_f32_32x32x16_bf16 v[0:15], v[196:199], a[104:107], v[0:15]
    ds_read_b64_tr_b16 v[192:193], v231 offset:8192
    v_add_f32 v246, 1.0, v246
    v_mul_f32 v247, s53, v83
    v_cvt_pk_bf16_f32 v80, v88, v89
    v_rcp_f32 v246, v246
    v_mfma_f32_32x32x16_bf16 v[16:31], v[196:199], a[108:111], v[16:31]
    ds_read_b64_tr_b16 v[194:195], v231 offset:8704
    v_exp_f32 v247, v247
    v_mul_f32 v91, v83, v91
    v_mul_f32 v90, v90, v246
    s_waitcnt lgkmcnt(2)
    v_mfma_f32_32x32x16_bf16 v[0:15], v[200:203], a[112:115], v[0:15]
    ds_read_b64_tr_b16 v[196:197], v231 offset:24576
    v_add_f32 v247, 1.0, v247
    v_mul_f32 v244, s53, v84
    v_rcp_f32 v247, v247
    v_mfma_f32_32x32x16_bf16 v[16:31], v[200:203], a[116:119], v[16:31]
    ds_read_b64_tr_b16 v[198:199], v231 offset:25088
    v_exp_f32 v244, v244
    v_mul_f32 v92, v84, v92
    v_mul_f32 v91, v91, v247
    v_mfma_f32_32x32x16_bf16 v[0:15], v[204:207], a[120:123], v[0:15]
    ds_read_b64_tr_b16 v[200:201], v231 offset:40960
    v_add_f32 v244, 1.0, v244
    v_mul_f32 v245, s53, v85
    v_cvt_pk_bf16_f32 v81, v90, v91
    v_rcp_f32 v244, v244
    v_mfma_f32_32x32x16_bf16 v[16:31], v[204:207], a[124:127], v[16:31]
    ds_read_b64_tr_b16 v[202:203], v231 offset:41472
    v_exp_f32 v245, v245
    v_mul_f32 v93, v85, v93
    v_mul_f32 v92, v92, v244
    s_waitcnt lgkmcnt(2)
    v_mfma_f32_32x32x16_bf16 v[0:15], v[192:195], a[128:131], v[0:15]
    ds_read_b64_tr_b16 v[204:205], v231 offset:57344
    v_add_f32 v245, 1.0, v245
    v_mul_f32 v246, s53, v86
    v_rcp_f32 v245, v245
    v_mfma_f32_32x32x16_bf16 v[16:31], v[192:195], a[132:135], v[16:31]
    ds_read_b64_tr_b16 v[206:207], v231 offset:57856
    v_exp_f32 v246, v246
    v_mul_f32 v94, v86, v94
    v_mul_f32 v93, v93, v245
    v_mfma_f32_32x32x16_bf16 v[0:15], v[196:199], a[136:139], v[0:15]
    ds_read_b64_tr_b16 v[192:193], v231 offset:12288
    v_add_f32 v246, 1.0, v246
    v_mul_f32 v247, s53, v87
    v_cvt_pk_bf16_f32 v82, v92, v93
    v_rcp_f32 v246, v246
    v_mfma_f32_32x32x16_bf16 v[16:31], v[196:199], a[140:143], v[16:31]
    ds_read_b64_tr_b16 v[194:195], v231 offset:12800
    v_exp_f32 v247, v247
    v_mul_f32 v95, v87, v95
    v_mul_f32 v94, v94, v246
    s_waitcnt lgkmcnt(2)
    v_mfma_f32_32x32x16_bf16 v[0:15], v[200:203], a[144:147], v[0:15]
    ds_read_b64_tr_b16 v[196:197], v231 offset:28672
    v_add_f32 v247, 1.0, v247
    v_rcp_f32 v247, v247
    v_mfma_f32_32x32x16_bf16 v[16:31], v[200:203], a[148:151], v[16:31]
    ds_read_b64_tr_b16 v[198:199], v231 offset:29184
    v_mul_f32 v244, s53, v96
    v_mul_f32 v95, v95, v247
    v_cvt_pk_bf16_f32 v83, v94, v95
    buffer_store_dwordx4 v[80:83], v225, s[32:35], s49 offen offset:2048 sc1
    v_mfma_f32_32x32x16_bf16 v[0:15], v[204:207], a[152:155], v[0:15]
    ds_read_b64_tr_b16 v[200:201], v231 offset:45056
    v_exp_f32 v244, v244
    v_mul_f32 v104, v96, v104
    v_mfma_f32_32x32x16_bf16 v[16:31], v[204:207], a[156:159], v[16:31]
    ds_read_b64_tr_b16 v[202:203], v231 offset:45568
    v_add_f32 v244, 1.0, v244
    v_mul_f32 v245, s53, v97
    v_rcp_f32 v244, v244
    s_waitcnt lgkmcnt(2)
    v_mfma_f32_32x32x16_bf16 v[0:15], v[192:195], a[160:163], v[0:15]
    ds_read_b64_tr_b16 v[204:205], v231 offset:61440
    v_exp_f32 v245, v245
    v_mul_f32 v105, v97, v105
    v_mul_f32 v104, v104, v244
    v_mfma_f32_32x32x16_bf16 v[16:31], v[192:195], a[164:167], v[16:31]
    ds_read_b64_tr_b16 v[206:207], v231 offset:61952
    v_add_f32 v245, 1.0, v245
    v_mul_f32 v246, s53, v98
    v_rcp_f32 v245, v245
    v_mfma_f32_32x32x16_bf16 v[0:15], v[196:199], a[168:171], v[0:15]
    ds_read_b64_tr_b16 v[192:193], v222 offset:16384
    v_exp_f32 v246, v246
    v_mul_f32 v106, v98, v106
    v_mul_f32 v105, v105, v245
    v_mfma_f32_32x32x16_bf16 v[16:31], v[196:199], a[172:175], v[16:31]
    ds_read_b64_tr_b16 v[194:195], v222 offset:16896
    v_add_f32 v246, 1.0, v246
    v_mul_f32 v247, s53, v99
    v_cvt_pk_bf16_f32 v96, v104, v105
    v_rcp_f32 v246, v246
    s_waitcnt lgkmcnt(2)
    v_mfma_f32_32x32x16_bf16 v[0:15], v[200:203], a[176:179], v[0:15]
    ds_read_b64_tr_b16 v[196:197], v222 offset:20480
    v_exp_f32 v247, v247
    v_mul_f32 v107, v99, v107
    v_mul_f32 v106, v106, v246
    v_mfma_f32_32x32x16_bf16 v[16:31], v[200:203], a[180:183], v[16:31]
    ds_read_b64_tr_b16 v[198:199], v222 offset:20992
    v_add_f32 v247, 1.0, v247
    v_mul_f32 v244, s53, v100
    v_rcp_f32 v247, v247
    v_mfma_f32_32x32x16_bf16 v[0:15], v[204:207], a[184:187], v[0:15]
    ds_read_b64_tr_b16 v[200:201], v222 offset:24576
    v_exp_f32 v244, v244
    v_mul_f32 v108, v100, v108
    v_mul_f32 v107, v107, v247
    v_mfma_f32_32x32x16_bf16 v[16:31], v[204:207], a[188:191], v[16:31]
    ds_read_b64_tr_b16 v[202:203], v222 offset:25088
    v_add_f32 v244, 1.0, v244
    v_mul_f32 v245, s53, v101
    v_cvt_pk_bf16_f32 v97, v106, v107
    v_rcp_f32 v244, v244
    s_waitcnt lgkmcnt(2)
    v_mfma_f32_32x32x16_bf16 v[0:15], v[192:195], a[192:195], v[0:15]
    ds_read_b64_tr_b16 v[204:205], v222 offset:28672
    v_exp_f32 v245, v245
    v_mul_f32 v109, v101, v109
    v_mul_f32 v108, v108, v244
    v_mfma_f32_32x32x16_bf16 v[16:31], v[192:195], a[196:199], v[16:31]
    ds_read_b64_tr_b16 v[206:207], v222 offset:29184
    v_add_f32 v245, 1.0, v245
    v_mul_f32 v246, s53, v102
    v_rcp_f32 v245, v245
    v_mfma_f32_32x32x16_bf16 v[0:15], v[196:199], a[200:203], v[0:15]
    ds_read_b64_tr_b16 v[192:193], v248 offset:0
    v_exp_f32 v246, v246
    v_mul_f32 v110, v102, v110
    v_mul_f32 v109, v109, v245
    v_mfma_f32_32x32x16_bf16 v[16:31], v[196:199], a[204:207], v[16:31]
    ds_read_b64_tr_b16 v[194:195], v248 offset:512
    v_add_f32 v246, 1.0, v246
    v_mul_f32 v247, s53, v103
    v_cvt_pk_bf16_f32 v98, v108, v109
    v_rcp_f32 v246, v246
    s_waitcnt lgkmcnt(2)
    v_mfma_f32_32x32x16_bf16 v[0:15], v[200:203], a[208:211], v[0:15]
    ds_read_b64_tr_b16 v[196:197], v248 offset:8192
    v_exp_f32 v247, v247
    v_mul_f32 v111, v103, v111
    v_mul_f32 v110, v110, v246
    v_mfma_f32_32x32x16_bf16 v[16:31], v[200:203], a[212:215], v[16:31]
    ds_read_b64_tr_b16 v[198:199], v248 offset:8704
    v_add_f32 v247, 1.0, v247
    v_rcp_f32 v247, v247
    v_mfma_f32_32x32x16_bf16 v[0:15], v[204:207], a[216:219], v[0:15]
    ds_read_b64_tr_b16 v[200:201], v248 offset:16384
    v_mul_f32 v244, s53, v112
    v_mul_f32 v111, v111, v247
    v_cvt_pk_bf16_f32 v99, v110, v111
    buffer_store_dwordx4 v[96:99], v225, s[32:35], s49 offen offset:512 sc1
    v_mfma_f32_32x32x16_bf16 v[16:31], v[204:207], a[220:223], v[16:31]
    ds_read_b64_tr_b16 v[202:203], v248 offset:16896
    v_exp_f32 v244, v244
    v_mul_f32 v120, v112, v120
    s_waitcnt lgkmcnt(2)
    v_mfma_f32_32x32x16_bf16 v[0:15], v[192:195], a[224:227], v[0:15]
    ds_read_b64_tr_b16 v[204:205], v248 offset:24576
    v_add_f32 v244, 1.0, v244
    v_mul_f32 v245, s53, v113
    v_rcp_f32 v244, v244
    v_mfma_f32_32x32x16_bf16 v[16:31], v[192:195], a[228:231], v[16:31]
    ds_read_b64_tr_b16 v[206:207], v248 offset:25088
    v_exp_f32 v245, v245
    v_mul_f32 v121, v113, v121
    v_mul_f32 v120, v120, v244
    v_mfma_f32_32x32x16_bf16 v[0:15], v[196:199], a[232:235], v[0:15]
    ds_read_b64_tr_b16 v[192:193], v248 offset:4096
    v_add_f32 v245, 1.0, v245
    v_mul_f32 v246, s53, v114
    v_rcp_f32 v245, v245
    v_mfma_f32_32x32x16_bf16 v[16:31], v[196:199], a[236:239], v[16:31]
    ds_read_b64_tr_b16 v[194:195], v248 offset:4608
    v_exp_f32 v246, v246
    v_mul_f32 v122, v114, v122
    v_mul_f32 v121, v121, v245
    s_waitcnt lgkmcnt(2)
    v_mfma_f32_32x32x16_bf16 v[0:15], v[200:203], a[240:243], v[0:15]
    ds_read_b64_tr_b16 v[196:197], v248 offset:12288
    v_add_f32 v246, 1.0, v246
    v_mul_f32 v247, s53, v115
    v_cvt_pk_bf16_f32 v112, v120, v121
    v_rcp_f32 v246, v246
    v_mfma_f32_32x32x16_bf16 v[16:31], v[200:203], a[244:247], v[16:31]
    ds_read_b64_tr_b16 v[198:199], v248 offset:12800
    v_exp_f32 v247, v247
    v_mul_f32 v123, v115, v123
    v_mul_f32 v122, v122, v246
    v_mfma_f32_32x32x16_bf16 v[0:15], v[204:207], a[248:251], v[0:15]
    ds_read_b64_tr_b16 v[200:201], v248 offset:20480
    v_add_f32 v247, 1.0, v247
    v_mul_f32 v244, s53, v116
    v_rcp_f32 v247, v247
    v_mfma_f32_32x32x16_bf16 v[16:31], v[204:207], a[252:255], v[16:31]
    ds_read_b64_tr_b16 v[202:203], v248 offset:20992
    v_exp_f32 v244, v244
    v_mul_f32 v124, v116, v124
    v_mul_f32 v123, v123, v247
    s_waitcnt lgkmcnt(2)
    v_mfma_f32_32x32x16_bf16 v[0:15], v[192:195], v[160:163], v[0:15]
    ds_read_b64_tr_b16 v[204:205], v248 offset:28672
    v_add_f32 v244, 1.0, v244
    v_mul_f32 v245, s53, v117
    v_cvt_pk_bf16_f32 v113, v122, v123
    v_rcp_f32 v244, v244
    v_mfma_f32_32x32x16_bf16 v[16:31], v[192:195], v[164:167], v[16:31]
    ds_read_b64_tr_b16 v[206:207], v248 offset:29184
    v_exp_f32 v245, v245
    v_mul_f32 v125, v117, v125
    v_mul_f32 v124, v124, v244
    v_mfma_f32_32x32x16_bf16 v[0:15], v[196:199], v[168:171], v[0:15]
    v_subrev_u32 v231, 0x10000, v223
    v_add_u32 v248, 0x10000, v223
    ds_read_b64_tr_b16 v[192:193], v223 offset:32768
    v_add_f32 v245, 1.0, v245
    v_mul_f32 v246, s53, v118
    v_rcp_f32 v245, v245
    v_mfma_f32_32x32x16_bf16 v[16:31], v[196:199], v[172:175], v[16:31]
    ds_read_b64_tr_b16 v[194:195], v223 offset:33280
    v_exp_f32 v246, v246
    v_mul_f32 v126, v118, v126
    v_mul_f32 v125, v125, v245
    s_waitcnt lgkmcnt(2)
    v_mfma_f32_32x32x16_bf16 v[0:15], v[200:203], v[176:179], v[0:15]
    ds_read_b64_tr_b16 v[196:197], v223 offset:36864
    v_add_f32 v246, 1.0, v246
    v_mul_f32 v247, s53, v119
    v_cvt_pk_bf16_f32 v114, v124, v125
    v_rcp_f32 v246, v246
    v_mfma_f32_32x32x16_bf16 v[16:31], v[200:203], v[180:183], v[16:31]
    ds_read_b64_tr_b16 v[198:199], v223 offset:37376
    v_exp_f32 v247, v247
    v_mul_f32 v127, v119, v127
    v_mul_f32 v126, v126, v246
    v_mfma_f32_32x32x16_bf16 v[0:15], v[204:207], v[184:187], v[0:15]
    ds_read_b64_tr_b16 v[200:201], v223 offset:40960
    v_add_f32 v247, 1.0, v247
    v_rcp_f32 v247, v247
    v_mfma_f32_32x32x16_bf16 v[16:31], v[204:207], v[188:191], v[16:31]
    ds_read_b64_tr_b16 v[202:203], v223 offset:41472
    v_mul_f32 v127, v127, v247
    v_cvt_pk_bf16_f32 v115, v126, v127
    buffer_store_dwordx4 v[112:115], v225, s[32:35], s49 offen offset:2560 sc1
    s_waitcnt lgkmcnt(2)
    v_mfma_f32_32x32x16_bf16 v[32:47], v[192:195], a[0:3], 0
    ds_read_b64_tr_b16 v[204:205], v223 offset:45056
    v_mfma_f32_32x32x16_bf16 v[48:63], v[192:195], a[4:7], 0
    ds_read_b64_tr_b16 v[206:207], v223 offset:45568
    v_mfma_f32_32x32x16_bf16 v[32:47], v[196:199], a[8:11], v[32:47]
    ds_read_b64_tr_b16 v[192:193], v231 offset:0
    v_mfma_f32_32x32x16_bf16 v[48:63], v[196:199], a[12:15], v[48:63]
    ds_read_b64_tr_b16 v[194:195], v231 offset:512
    v_mul_f32 v244, s53, v128
    s_waitcnt lgkmcnt(2)
    v_mfma_f32_32x32x16_bf16 v[32:47], v[200:203], a[16:19], v[32:47]
    ds_read_b64_tr_b16 v[196:197], v231 offset:16384
    v_exp_f32 v244, v244
    v_mul_f32 v136, v128, v136
    v_mfma_f32_32x32x16_bf16 v[48:63], v[200:203], a[20:23], v[48:63]
    ds_read_b64_tr_b16 v[198:199], v231 offset:16896
    v_add_f32 v244, 1.0, v244
    v_mul_f32 v245, s53, v129
    v_rcp_f32 v244, v244
    v_mfma_f32_32x32x16_bf16 v[32:47], v[204:207], a[24:27], v[32:47]
    ds_read_b64_tr_b16 v[200:201], v231 offset:32768
    v_exp_f32 v245, v245
    v_mul_f32 v137, v129, v137
    v_mul_f32 v136, v136, v244
    v_mfma_f32_32x32x16_bf16 v[48:63], v[204:207], a[28:31], v[48:63]
    ds_read_b64_tr_b16 v[202:203], v231 offset:33280
    v_add_f32 v245, 1.0, v245
    v_mul_f32 v246, s53, v130
    v_rcp_f32 v245, v245
    s_waitcnt lgkmcnt(2)
    v_mfma_f32_32x32x16_bf16 v[32:47], v[192:195], a[32:35], v[32:47]
    ds_read_b64_tr_b16 v[204:205], v231 offset:49152
    v_exp_f32 v246, v246
    v_mul_f32 v138, v130, v138
    v_mul_f32 v137, v137, v245
    buffer_store_dwordx4 v[208:211], v232, s[32:35], s80 offen offset:0 sc1
    v_mfma_f32_32x32x16_bf16 v[48:63], v[192:195], a[36:39], v[48:63]
    ds_read_b64_tr_b16 v[206:207], v231 offset:49664
    v_add_f32 v246, 1.0, v246
    v_mul_f32 v247, s53, v131
    v_cvt_pk_bf16_f32 v128, v136, v137
    v_rcp_f32 v246, v246
    v_mfma_f32_32x32x16_bf16 v[32:47], v[196:199], a[40:43], v[32:47]
    ds_read_b64_tr_b16 v[192:193], v231 offset:4096
    v_exp_f32 v247, v247
    v_mul_f32 v139, v131, v139
    v_mul_f32 v138, v138, v246
    v_mfma_f32_32x32x16_bf16 v[48:63], v[196:199], a[44:47], v[48:63]
    ds_read_b64_tr_b16 v[194:195], v231 offset:4608
    v_add_f32 v247, 1.0, v247
    v_mul_f32 v244, s53, v132
    v_rcp_f32 v247, v247
    buffer_store_dwordx4 v[208:211], v232, s[32:35], s80 offen offset:1024 sc1
    s_waitcnt lgkmcnt(2)
    v_mfma_f32_32x32x16_bf16 v[32:47], v[200:203], a[48:51], v[32:47]
    ds_read_b64_tr_b16 v[196:197], v231 offset:20480
    v_exp_f32 v244, v244
    v_mul_f32 v140, v132, v140
    v_mul_f32 v139, v139, v247
    v_mfma_f32_32x32x16_bf16 v[48:63], v[200:203], a[52:55], v[48:63]
    ds_read_b64_tr_b16 v[198:199], v231 offset:20992
    v_add_f32 v244, 1.0, v244
    v_mul_f32 v245, s53, v133
    v_cvt_pk_bf16_f32 v129, v138, v139
    v_rcp_f32 v244, v244
    v_mfma_f32_32x32x16_bf16 v[32:47], v[204:207], a[56:59], v[32:47]
    ds_read_b64_tr_b16 v[200:201], v231 offset:36864
    v_exp_f32 v245, v245
    v_mul_f32 v141, v133, v141
    v_mul_f32 v140, v140, v244
    buffer_store_dwordx4 v[208:211], v232, s[32:35], s80 offen offset:2048 sc1
    v_mfma_f32_32x32x16_bf16 v[48:63], v[204:207], a[60:63], v[48:63]
    ds_read_b64_tr_b16 v[202:203], v231 offset:37376
    v_add_f32 v245, 1.0, v245
    v_mul_f32 v246, s53, v134
    v_rcp_f32 v245, v245
    s_waitcnt lgkmcnt(2)
    v_mfma_f32_32x32x16_bf16 v[32:47], v[192:195], a[64:67], v[32:47]
    ds_read_b64_tr_b16 v[204:205], v231 offset:53248
    v_exp_f32 v246, v246
    v_mul_f32 v142, v134, v142
    v_mul_f32 v141, v141, v245
    v_mfma_f32_32x32x16_bf16 v[48:63], v[192:195], a[68:71], v[48:63]
    ds_read_b64_tr_b16 v[206:207], v231 offset:53760
    v_add_f32 v246, 1.0, v246
    v_mul_f32 v247, s53, v135
    v_cvt_pk_bf16_f32 v130, v140, v141
    v_rcp_f32 v246, v246
    buffer_store_dwordx4 v[208:211], v232, s[32:35], s80 offen offset:3072 sc1
    v_mfma_f32_32x32x16_bf16 v[32:47], v[196:199], a[72:75], v[32:47]
    ds_read_b64_tr_b16 v[192:193], v223 offset:0
    v_exp_f32 v247, v247
    v_mul_f32 v143, v135, v143
    v_mul_f32 v142, v142, v246
    v_mfma_f32_32x32x16_bf16 v[48:63], v[196:199], a[76:79], v[48:63]
    ds_read_b64_tr_b16 v[194:195], v223 offset:512
    v_add_f32 v247, 1.0, v247
    v_rcp_f32 v247, v247
    s_waitcnt lgkmcnt(2)
    v_mfma_f32_32x32x16_bf16 v[32:47], v[200:203], a[80:83], v[32:47]
    ds_read_b64_tr_b16 v[196:197], v223 offset:4096
    v_mul_f32 v244, s53, v144
    v_mul_f32 v143, v143, v247
    v_cvt_pk_bf16_f32 v131, v142, v143
    buffer_store_dwordx4 v[128:131], v225, s[32:35], s50 offen offset:0 sc1
    v_mfma_f32_32x32x16_bf16 v[48:63], v[200:203], a[84:87], v[48:63]
    ds_read_b64_tr_b16 v[198:199], v223 offset:4608
    v_exp_f32 v244, v244
    v_mul_f32 v152, v144, v152
    v_mfma_f32_32x32x16_bf16 v[32:47], v[204:207], a[88:91], v[32:47]
    ds_read_b64_tr_b16 v[200:201], v223 offset:8192
    v_add_f32 v244, 1.0, v244
    v_mul_f32 v245, s53, v145
    v_rcp_f32 v244, v244
    buffer_store_dwordx4 v[208:211], v232, s[32:35], s81 offen offset:0 sc1
    v_mfma_f32_32x32x16_bf16 v[48:63], v[204:207], a[92:95], v[48:63]
    ds_read_b64_tr_b16 v[202:203], v223 offset:8704
    v_exp_f32 v245, v245
    v_mul_f32 v153, v145, v153
    v_mul_f32 v152, v152, v244
    s_waitcnt lgkmcnt(2)
    v_mfma_f32_32x32x16_bf16 v[32:47], v[192:195], a[96:99], v[32:47]
    ds_read_b64_tr_b16 v[204:205], v223 offset:12288
    v_add_f32 v245, 1.0, v245
    v_mul_f32 v246, s53, v146
    v_rcp_f32 v245, v245
    v_mfma_f32_32x32x16_bf16 v[48:63], v[192:195], a[100:103], v[48:63]
    ds_read_b64_tr_b16 v[206:207], v223 offset:12800
    v_exp_f32 v246, v246
    v_mul_f32 v154, v146, v154
    v_mul_f32 v153, v153, v245
    buffer_store_dwordx4 v[208:211], v232, s[32:35], s81 offen offset:1024 sc1
    v_mfma_f32_32x32x16_bf16 v[32:47], v[196:199], a[104:107], v[32:47]
    ds_read_b64_tr_b16 v[192:193], v231 offset:8192
    v_add_f32 v246, 1.0, v246
    v_mul_f32 v247, s53, v147
    v_cvt_pk_bf16_f32 v144, v152, v153
    v_rcp_f32 v246, v246
    v_mfma_f32_32x32x16_bf16 v[48:63], v[196:199], a[108:111], v[48:63]
    ds_read_b64_tr_b16 v[194:195], v231 offset:8704
    v_exp_f32 v247, v247
    v_mul_f32 v155, v147, v155
    v_mul_f32 v154, v154, v246
    s_waitcnt lgkmcnt(2)
    v_mfma_f32_32x32x16_bf16 v[32:47], v[200:203], a[112:115], v[32:47]
    ds_read_b64_tr_b16 v[196:197], v231 offset:24576
    v_add_f32 v247, 1.0, v247
    v_mul_f32 v244, s53, v148
    v_rcp_f32 v247, v247
    buffer_store_dwordx4 v[208:211], v220, s[32:35], 0 offen sc1
    v_mfma_f32_32x32x16_bf16 v[48:63], v[200:203], a[116:119], v[48:63]
    ds_read_b64_tr_b16 v[198:199], v231 offset:25088
    v_exp_f32 v244, v244
    v_mul_f32 v156, v148, v156
    v_mul_f32 v155, v155, v247
    v_mfma_f32_32x32x16_bf16 v[32:47], v[204:207], a[120:123], v[32:47]
    ds_read_b64_tr_b16 v[200:201], v231 offset:40960
    v_add_f32 v244, 1.0, v244
    v_mul_f32 v245, s53, v149
    v_cvt_pk_bf16_f32 v145, v154, v155
    v_rcp_f32 v244, v244
    v_mfma_f32_32x32x16_bf16 v[48:63], v[204:207], a[124:127], v[48:63]
    ds_read_b64_tr_b16 v[202:203], v231 offset:41472
    v_exp_f32 v245, v245
    v_mul_f32 v157, v149, v157
    v_mul_f32 v156, v156, v244
    s_waitcnt lgkmcnt(2)
    v_mfma_f32_32x32x16_bf16 v[32:47], v[192:195], a[128:131], v[32:47]
    ds_read_b64_tr_b16 v[204:205], v231 offset:57344
    v_add_f32 v245, 1.0, v245
    v_mul_f32 v246, s53, v150
    v_rcp_f32 v245, v245
    v_mfma_f32_32x32x16_bf16 v[48:63], v[192:195], a[132:135], v[48:63]
    ds_read_b64_tr_b16 v[206:207], v231 offset:57856
    v_exp_f32 v246, v246
    v_mul_f32 v158, v150, v158
    v_mul_f32 v157, v157, v245
    v_mfma_f32_32x32x16_bf16 v[32:47], v[196:199], a[136:139], v[32:47]
    ds_read_b64_tr_b16 v[192:193], v231 offset:12288
    v_add_f32 v246, 1.0, v246
    v_mul_f32 v247, s53, v151
    v_cvt_pk_bf16_f32 v146, v156, v157
    v_rcp_f32 v246, v246
    v_mfma_f32_32x32x16_bf16 v[48:63], v[196:199], a[140:143], v[48:63]
    ds_read_b64_tr_b16 v[194:195], v231 offset:12800
    v_exp_f32 v247, v247
    v_mul_f32 v159, v151, v159
    v_mul_f32 v158, v158, v246
    s_waitcnt lgkmcnt(2)
    v_mfma_f32_32x32x16_bf16 v[32:47], v[200:203], a[144:147], v[32:47]
    ds_read_b64_tr_b16 v[196:197], v231 offset:28672
    v_add_f32 v247, 1.0, v247
    v_rcp_f32 v247, v247
    v_mfma_f32_32x32x16_bf16 v[48:63], v[200:203], a[148:151], v[48:63]
    ds_read_b64_tr_b16 v[198:199], v231 offset:29184
    v_mul_f32 v244, s53, v0
    v_mul_f32 v159, v159, v247
    v_cvt_pk_bf16_f32 v147, v158, v159
    buffer_store_dwordx4 v[144:147], v225, s[32:35], s50 offen offset:2048 sc1
    v_mfma_f32_32x32x16_bf16 v[32:47], v[204:207], a[152:155], v[32:47]
    ds_read_b64_tr_b16 v[200:201], v231 offset:45056
    v_exp_f32 v244, v244
    v_mul_f32 v8, v0, v8
    v_mfma_f32_32x32x16_bf16 v[48:63], v[204:207], a[156:159], v[48:63]
    ds_read_b64_tr_b16 v[202:203], v231 offset:45568
    v_add_f32 v244, 1.0, v244
    v_mul_f32 v245, s53, v1
    v_rcp_f32 v244, v244
    buffer_load_dword v229, v250, s[36:39], 0 offen offset:128
    s_waitcnt lgkmcnt(2)
    v_mfma_f32_32x32x16_bf16 v[32:47], v[192:195], a[160:163], v[32:47]
    ds_read_b64_tr_b16 v[204:205], v231 offset:61440
    v_exp_f32 v245, v245
    v_mul_f32 v9, v1, v9
    v_mul_f32 v8, v8, v244
    v_mfma_f32_32x32x16_bf16 v[48:63], v[192:195], a[164:167], v[48:63]
    ds_read_b64_tr_b16 v[206:207], v231 offset:61952
    v_add_f32 v245, 1.0, v245
    v_mul_f32 v246, s53, v2
    v_rcp_f32 v245, v245
    v_mfma_f32_32x32x16_bf16 v[32:47], v[196:199], a[168:171], v[32:47]
    ds_read_b64_tr_b16 v[192:193], v223 offset:16384
    v_exp_f32 v246, v246
    v_mul_f32 v10, v2, v10
    v_mul_f32 v9, v9, v245
    v_mfma_f32_32x32x16_bf16 v[48:63], v[196:199], a[172:175], v[48:63]
    ds_read_b64_tr_b16 v[194:195], v223 offset:16896
    v_add_f32 v246, 1.0, v246
    v_mul_f32 v247, s53, v3
    v_cvt_pk_bf16_f32 v0, v8, v9
    v_rcp_f32 v246, v246
    s_waitcnt lgkmcnt(2)
    v_mfma_f32_32x32x16_bf16 v[32:47], v[200:203], a[176:179], v[32:47]
    ds_read_b64_tr_b16 v[196:197], v223 offset:20480
    v_exp_f32 v247, v247
    v_mul_f32 v11, v3, v11
    v_mul_f32 v10, v10, v246
    v_mfma_f32_32x32x16_bf16 v[48:63], v[200:203], a[180:183], v[48:63]
    ds_read_b64_tr_b16 v[198:199], v223 offset:20992
    v_add_f32 v247, 1.0, v247
    v_mul_f32 v244, s53, v4
    v_rcp_f32 v247, v247
    v_mfma_f32_32x32x16_bf16 v[32:47], v[204:207], a[184:187], v[32:47]
    ds_read_b64_tr_b16 v[200:201], v223 offset:24576
    v_exp_f32 v244, v244
    v_mul_f32 v12, v4, v12
    v_mul_f32 v11, v11, v247
    v_mfma_f32_32x32x16_bf16 v[48:63], v[204:207], a[188:191], v[48:63]
    ds_read_b64_tr_b16 v[202:203], v223 offset:25088
    v_add_f32 v244, 1.0, v244
    v_mul_f32 v245, s53, v5
    v_cvt_pk_bf16_f32 v1, v10, v11
    v_rcp_f32 v244, v244
    s_waitcnt lgkmcnt(2)
    v_mfma_f32_32x32x16_bf16 v[32:47], v[192:195], a[192:195], v[32:47]
    ds_read_b64_tr_b16 v[204:205], v223 offset:28672
    v_exp_f32 v245, v245
    v_mul_f32 v13, v5, v13
    v_mul_f32 v12, v12, v244
    v_mfma_f32_32x32x16_bf16 v[48:63], v[192:195], a[196:199], v[48:63]
    ds_read_b64_tr_b16 v[206:207], v223 offset:29184
    v_add_f32 v245, 1.0, v245
    v_mul_f32 v246, s53, v6
    v_rcp_f32 v245, v245
    v_mfma_f32_32x32x16_bf16 v[32:47], v[196:199], a[200:203], v[32:47]
    ds_read_b64_tr_b16 v[192:193], v248 offset:0
    v_exp_f32 v246, v246
    v_mul_f32 v14, v6, v14
    v_mul_f32 v13, v13, v245
    v_mfma_f32_32x32x16_bf16 v[48:63], v[196:199], a[204:207], v[48:63]
    ds_read_b64_tr_b16 v[194:195], v248 offset:512
    v_add_f32 v246, 1.0, v246
    v_mul_f32 v247, s53, v7
    v_cvt_pk_bf16_f32 v2, v12, v13
    v_rcp_f32 v246, v246
    s_waitcnt lgkmcnt(2)
    v_mfma_f32_32x32x16_bf16 v[32:47], v[200:203], a[208:211], v[32:47]
    ds_read_b64_tr_b16 v[196:197], v248 offset:8192
    v_exp_f32 v247, v247
    v_mul_f32 v15, v7, v15
    v_mul_f32 v14, v14, v246
    v_mfma_f32_32x32x16_bf16 v[48:63], v[200:203], a[212:215], v[48:63]
    ds_read_b64_tr_b16 v[198:199], v248 offset:8704
    v_add_f32 v247, 1.0, v247
    v_rcp_f32 v247, v247
    v_mfma_f32_32x32x16_bf16 v[32:47], v[204:207], a[216:219], v[32:47]
    ds_read_b64_tr_b16 v[200:201], v248 offset:16384
    v_mul_f32 v244, s53, v16
    v_mul_f32 v15, v15, v247
    v_cvt_pk_bf16_f32 v3, v14, v15
    buffer_store_dwordx4 v[0:3], v225, s[32:35], s50 offen offset:512 sc1
    v_mfma_f32_32x32x16_bf16 v[48:63], v[204:207], a[220:223], v[48:63]
    ds_read_b64_tr_b16 v[202:203], v248 offset:16896
    v_exp_f32 v244, v244
    v_mul_f32 v24, v16, v24
    s_waitcnt lgkmcnt(2)
    v_mfma_f32_32x32x16_bf16 v[32:47], v[192:195], a[224:227], v[32:47]
    ds_read_b64_tr_b16 v[204:205], v248 offset:24576
    v_add_f32 v244, 1.0, v244
    v_mul_f32 v245, s53, v17
    v_rcp_f32 v244, v244
    v_mfma_f32_32x32x16_bf16 v[48:63], v[192:195], a[228:231], v[48:63]
    ds_read_b64_tr_b16 v[206:207], v248 offset:25088
    v_exp_f32 v245, v245
    v_mul_f32 v25, v17, v25
    v_mul_f32 v24, v24, v244
    v_mfma_f32_32x32x16_bf16 v[32:47], v[196:199], a[232:235], v[32:47]
    ds_read_b64_tr_b16 v[192:193], v248 offset:4096
    v_add_f32 v245, 1.0, v245
    v_mul_f32 v246, s53, v18
    v_rcp_f32 v245, v245
    v_mfma_f32_32x32x16_bf16 v[48:63], v[196:199], a[236:239], v[48:63]
    ds_read_b64_tr_b16 v[194:195], v248 offset:4608
    v_exp_f32 v246, v246
    v_mul_f32 v26, v18, v26
    v_mul_f32 v25, v25, v245
    s_waitcnt lgkmcnt(2)
    v_mfma_f32_32x32x16_bf16 v[32:47], v[200:203], a[240:243], v[32:47]
    ds_read_b64_tr_b16 v[196:197], v248 offset:12288
    v_add_f32 v246, 1.0, v246
    v_mul_f32 v247, s53, v19
    v_cvt_pk_bf16_f32 v16, v24, v25
    v_rcp_f32 v246, v246
    v_mfma_f32_32x32x16_bf16 v[48:63], v[200:203], a[244:247], v[48:63]
    ds_read_b64_tr_b16 v[198:199], v248 offset:12800
    v_exp_f32 v247, v247
    v_mul_f32 v27, v19, v27
    v_mul_f32 v26, v26, v246
    v_mfma_f32_32x32x16_bf16 v[32:47], v[204:207], a[248:251], v[32:47]
    ds_read_b64_tr_b16 v[200:201], v248 offset:20480
    v_add_f32 v247, 1.0, v247
    v_mul_f32 v244, s53, v20
    v_rcp_f32 v247, v247
    v_mfma_f32_32x32x16_bf16 v[48:63], v[204:207], a[252:255], v[48:63]
    ds_read_b64_tr_b16 v[202:203], v248 offset:20992
    v_exp_f32 v244, v244
    v_mul_f32 v28, v20, v28
    v_mul_f32 v27, v27, v247
    s_waitcnt lgkmcnt(2)
    v_mfma_f32_32x32x16_bf16 v[32:47], v[192:195], v[160:163], v[32:47]
    ds_read_b64_tr_b16 v[204:205], v248 offset:28672
    v_add_f32 v244, 1.0, v244
    v_mul_f32 v245, s53, v21
    v_cvt_pk_bf16_f32 v17, v26, v27
    v_rcp_f32 v244, v244
    v_mfma_f32_32x32x16_bf16 v[48:63], v[192:195], v[164:167], v[48:63]
    ds_read_b64_tr_b16 v[206:207], v248 offset:29184
    v_exp_f32 v245, v245
    v_mul_f32 v29, v21, v29
    v_mul_f32 v28, v28, v244
    v_mfma_f32_32x32x16_bf16 v[32:47], v[196:199], v[168:171], v[32:47]
    v_subrev_u32 v231, 0x10000, v224
    v_add_u32 v248, 0x10000, v224
    ds_read_b64_tr_b16 v[192:193], v224 offset:32768
    v_add_f32 v245, 1.0, v245
    v_mul_f32 v246, s53, v22
    v_rcp_f32 v245, v245
    v_mfma_f32_32x32x16_bf16 v[48:63], v[196:199], v[172:175], v[48:63]
    ds_read_b64_tr_b16 v[194:195], v224 offset:33280
    v_exp_f32 v246, v246
    v_mul_f32 v30, v22, v30
    v_mul_f32 v29, v29, v245
    s_waitcnt lgkmcnt(2)
    v_mfma_f32_32x32x16_bf16 v[32:47], v[200:203], v[176:179], v[32:47]
    ds_read_b64_tr_b16 v[196:197], v224 offset:36864
    v_add_f32 v246, 1.0, v246
    v_mul_f32 v247, s53, v23
    v_cvt_pk_bf16_f32 v18, v28, v29
    v_rcp_f32 v246, v246
    v_mfma_f32_32x32x16_bf16 v[48:63], v[200:203], v[180:183], v[48:63]
    ds_read_b64_tr_b16 v[198:199], v224 offset:37376
    v_exp_f32 v247, v247
    v_mul_f32 v31, v23, v31
    v_mul_f32 v30, v30, v246
    v_mfma_f32_32x32x16_bf16 v[32:47], v[204:207], v[184:187], v[32:47]
    ds_read_b64_tr_b16 v[200:201], v224 offset:40960
    v_add_f32 v247, 1.0, v247
    v_rcp_f32 v247, v247
    v_mfma_f32_32x32x16_bf16 v[48:63], v[204:207], v[188:191], v[48:63]
    ds_read_b64_tr_b16 v[202:203], v224 offset:41472
    v_mul_f32 v31, v31, v247
    v_cvt_pk_bf16_f32 v19, v30, v31
    buffer_store_dwordx4 v[16:19], v225, s[32:35], s50 offen offset:2560 sc1
    s_waitcnt lgkmcnt(2)
    v_mfma_f32_32x32x16_bf16 v[64:79], v[192:195], a[0:3], 0
    ds_read_b64_tr_b16 v[204:205], v224 offset:45056
    v_mfma_f32_32x32x16_bf16 v[80:95], v[192:195], a[4:7], 0
    ds_read_b64_tr_b16 v[206:207], v224 offset:45568
    v_mfma_f32_32x32x16_bf16 v[64:79], v[196:199], a[8:11], v[64:79]
    ds_read_b64_tr_b16 v[192:193], v248 offset:0
    v_mfma_f32_32x32x16_bf16 v[80:95], v[196:199], a[12:15], v[80:95]
    ds_read_b64_tr_b16 v[194:195], v248 offset:512
    v_mul_f32 v244, s53, v32
    s_waitcnt lgkmcnt(2)
    v_mfma_f32_32x32x16_bf16 v[64:79], v[200:203], a[16:19], v[64:79]
    ds_read_b64_tr_b16 v[196:197], v231 offset:0
    v_exp_f32 v244, v244
    v_mul_f32 v40, v32, v40
    v_mfma_f32_32x32x16_bf16 v[80:95], v[200:203], a[20:23], v[80:95]
    ds_read_b64_tr_b16 v[198:199], v231 offset:512
    v_add_f32 v244, 1.0, v244
    v_mul_f32 v245, s53, v33
    v_rcp_f32 v244, v244
    v_mfma_f32_32x32x16_bf16 v[64:79], v[204:207], a[24:27], v[64:79]
    ds_read_b64_tr_b16 v[200:201], v231 offset:16384
    v_exp_f32 v245, v245
    v_mul_f32 v41, v33, v41
    v_mul_f32 v40, v40, v244
    v_mfma_f32_32x32x16_bf16 v[80:95], v[204:207], a[28:31], v[80:95]
    ds_read_b64_tr_b16 v[202:203], v231 offset:16896
    v_add_f32 v245, 1.0, v245
    v_mul_f32 v246, s53, v34
    v_rcp_f32 v245, v245
    s_waitcnt lgkmcnt(2)
    v_mfma_f32_32x32x16_bf16 v[64:79], v[192:195], a[224:227], v[64:79]
    ds_read_b64_tr_b16 v[204:205], v231 offset:32768
    v_exp_f32 v246, v246
    v_mul_f32 v42, v34, v42
    v_mul_f32 v41, v41, v245
    v_mfma_f32_32x32x16_bf16 v[80:95], v[192:195], a[228:231], v[80:95]
    ds_read_b64_tr_b16 v[206:207], v231 offset:33280
    v_add_f32 v246, 1.0, v246
    v_mul_f32 v247, s53, v35
    v_cvt_pk_bf16_f32 v32, v40, v41
    v_rcp_f32 v246, v246
    s_barrier
    v_mfma_f32_32x32x16_bf16 v[64:79], v[196:199], a[32:35], v[64:79]
    ds_read_b64_tr_b16 v[192:193], v231 offset:49152
    v_exp_f32 v247, v247
    v_mul_f32 v43, v35, v43
    v_mul_f32 v42, v42, v246
    s_add_u32 m0, s59, 0
    s_mul_i32 s54, s12, 4608
    buffer_load_dwordx4 v216, s[28:31], s54 offen lds
    v_mfma_f32_32x32x16_bf16 v[80:95], v[196:199], a[36:39], v[80:95]
    ds_read_b64_tr_b16 v[194:195], v231 offset:49664
    v_add_f32 v247, 1.0, v247
    v_mul_f32 v244, s53, v36
    v_rcp_f32 v247, v247
    s_waitcnt lgkmcnt(2)
    v_mfma_f32_32x32x16_bf16 v[64:79], v[200:203], a[40:43], v[64:79]
    ds_read_b64_tr_b16 v[196:197], v231 offset:4096
    v_exp_f32 v244, v244
    v_mul_f32 v44, v36, v44
    v_mul_f32 v43, v43, v247
    v_mfma_f32_32x32x16_bf16 v[80:95], v[200:203], a[44:47], v[80:95]
    ds_read_b64_tr_b16 v[198:199], v231 offset:4608
    v_add_f32 v244, 1.0, v244
    v_mul_f32 v245, s53, v37
    v_cvt_pk_bf16_f32 v33, v42, v43
    v_rcp_f32 v244, v244
    v_mfma_f32_32x32x16_bf16 v[64:79], v[204:207], a[48:51], v[64:79]
    ds_read_b64_tr_b16 v[200:201], v231 offset:20480
    v_exp_f32 v245, v245
    v_mul_f32 v45, v37, v45
    v_mul_f32 v44, v44, v244
    v_mfma_f32_32x32x16_bf16 v[80:95], v[204:207], a[52:55], v[80:95]
    ds_read_b64_tr_b16 v[202:203], v231 offset:20992
    v_add_f32 v245, 1.0, v245
    v_mul_f32 v246, s53, v38
    v_rcp_f32 v245, v245
    s_waitcnt lgkmcnt(2)
    v_mfma_f32_32x32x16_bf16 v[64:79], v[192:195], a[56:59], v[64:79]
    ds_read_b64_tr_b16 v[204:205], v231 offset:36864
    v_exp_f32 v246, v246
    v_mul_f32 v46, v38, v46
    v_mul_f32 v45, v45, v245
    v_mfma_f32_32x32x16_bf16 v[80:95], v[192:195], a[60:63], v[80:95]
    ds_read_b64_tr_b16 v[206:207], v231 offset:37376
    v_add_f32 v246, 1.0, v246
    v_mul_f32 v247, s53, v39
    v_cvt_pk_bf16_f32 v34, v44, v45
    v_rcp_f32 v246, v246
    v_mfma_f32_32x32x16_bf16 v[64:79], v[196:199], a[64:67], v[64:79]
    ds_read_b64_tr_b16 v[192:193], v231 offset:53248
    v_exp_f32 v247, v247
    v_mul_f32 v47, v39, v47
    v_mul_f32 v46, v46, v246
    v_mfma_f32_32x32x16_bf16 v[80:95], v[196:199], a[68:71], v[80:95]
    ds_read_b64_tr_b16 v[194:195], v231 offset:53760
    v_add_f32 v247, 1.0, v247
    v_rcp_f32 v247, v247
    s_waitcnt lgkmcnt(2)
    v_mfma_f32_32x32x16_bf16 v[64:79], v[200:203], a[72:75], v[64:79]
    ds_read_b64_tr_b16 v[196:197], v224 offset:0
    v_mul_f32 v244, s53, v48
    v_mul_f32 v47, v47, v247
    v_cvt_pk_bf16_f32 v35, v46, v47
    buffer_store_dwordx4 v[32:35], v225, s[32:35], s51 offen offset:0 sc1
    v_mfma_f32_32x32x16_bf16 v[80:95], v[200:203], a[76:79], v[80:95]
    ds_read_b64_tr_b16 v[198:199], v224 offset:512
    v_exp_f32 v244, v244
    v_mul_f32 v56, v48, v56
    v_mfma_f32_32x32x16_bf16 v[64:79], v[204:207], a[80:83], v[64:79]
    ds_read_b64_tr_b16 v[200:201], v224 offset:4096
    v_add_f32 v244, 1.0, v244
    v_mul_f32 v245, s53, v49
    v_rcp_f32 v244, v244
    s_add_u32 m0, s59, 4096
    s_mul_i32 s54, s13, 4608
    buffer_load_dwordx4 v216, s[28:31], s54 offen lds
    v_mfma_f32_32x32x16_bf16 v[80:95], v[204:207], a[84:87], v[80:95]
    ds_read_b64_tr_b16 v[202:203], v224 offset:4608
    v_exp_f32 v245, v245
    v_mul_f32 v57, v49, v57
    v_mul_f32 v56, v56, v244
    s_waitcnt lgkmcnt(2)
    v_mfma_f32_32x32x16_bf16 v[64:79], v[192:195], a[88:91], v[64:79]
    ds_read_b64_tr_b16 v[204:205], v224 offset:8192
    v_add_f32 v245, 1.0, v245
    v_mul_f32 v246, s53, v50
    v_rcp_f32 v245, v245
    v_mfma_f32_32x32x16_bf16 v[80:95], v[192:195], a[92:95], v[80:95]
    ds_read_b64_tr_b16 v[206:207], v224 offset:8704
    v_exp_f32 v246, v246
    v_mul_f32 v58, v50, v58
    v_mul_f32 v57, v57, v245
    v_mfma_f32_32x32x16_bf16 v[64:79], v[196:199], a[96:99], v[64:79]
    ds_read_b64_tr_b16 v[192:193], v224 offset:12288
    v_add_f32 v246, 1.0, v246
    v_mul_f32 v247, s53, v51
    v_cvt_pk_bf16_f32 v48, v56, v57
    v_rcp_f32 v246, v246
    v_mfma_f32_32x32x16_bf16 v[80:95], v[196:199], a[100:103], v[80:95]
    ds_read_b64_tr_b16 v[194:195], v224 offset:12800
    v_exp_f32 v247, v247
    v_mul_f32 v59, v51, v59
    v_mul_f32 v58, v58, v246
    s_waitcnt lgkmcnt(2)
    v_mfma_f32_32x32x16_bf16 v[64:79], v[200:203], a[104:107], v[64:79]
    ds_read_b64_tr_b16 v[196:197], v231 offset:8192
    v_add_f32 v247, 1.0, v247
    v_mul_f32 v244, s53, v52
    v_rcp_f32 v247, v247
    v_mfma_f32_32x32x16_bf16 v[80:95], v[200:203], a[108:111], v[80:95]
    ds_read_b64_tr_b16 v[198:199], v231 offset:8704
    v_exp_f32 v244, v244
    v_mul_f32 v60, v52, v60
    v_mul_f32 v59, v59, v247
    v_mfma_f32_32x32x16_bf16 v[64:79], v[204:207], a[112:115], v[64:79]
    ds_read_b64_tr_b16 v[200:201], v231 offset:24576
    v_add_f32 v244, 1.0, v244
    v_mul_f32 v245, s53, v53
    v_cvt_pk_bf16_f32 v49, v58, v59
    v_rcp_f32 v244, v244
    v_mfma_f32_32x32x16_bf16 v[80:95], v[204:207], a[116:119], v[80:95]
    ds_read_b64_tr_b16 v[202:203], v231 offset:25088
    v_exp_f32 v245, v245
    v_mul_f32 v61, v53, v61
    v_mul_f32 v60, v60, v244
    s_waitcnt lgkmcnt(2)
    v_mfma_f32_32x32x16_bf16 v[64:79], v[192:195], a[120:123], v[64:79]
    ds_read_b64_tr_b16 v[204:205], v231 offset:40960
    v_add_f32 v245, 1.0, v245
    v_mul_f32 v246, s53, v54
    v_rcp_f32 v245, v245
    v_mfma_f32_32x32x16_bf16 v[80:95], v[192:195], a[124:127], v[80:95]
    ds_read_b64_tr_b16 v[206:207], v231 offset:41472
    v_exp_f32 v246, v246
    v_mul_f32 v62, v54, v62
    v_mul_f32 v61, v61, v245
    v_mfma_f32_32x32x16_bf16 v[64:79], v[196:199], a[128:131], v[64:79]
    ds_read_b64_tr_b16 v[192:193], v231 offset:57344
    v_add_f32 v246, 1.0, v246
    v_mul_f32 v247, s53, v55
    v_cvt_pk_bf16_f32 v50, v60, v61
    v_rcp_f32 v246, v246
    v_mfma_f32_32x32x16_bf16 v[80:95], v[196:199], a[132:135], v[80:95]
    ds_read_b64_tr_b16 v[194:195], v231 offset:57856
    v_exp_f32 v247, v247
    v_mul_f32 v63, v55, v63
    v_mul_f32 v62, v62, v246
    s_waitcnt lgkmcnt(2)
    v_mfma_f32_32x32x16_bf16 v[64:79], v[200:203], a[136:139], v[64:79]
    ds_read_b64_tr_b16 v[196:197], v231 offset:12288
    v_add_f32 v247, 1.0, v247
    v_rcp_f32 v247, v247
    v_mfma_f32_32x32x16_bf16 v[80:95], v[200:203], a[140:143], v[80:95]
    ds_read_b64_tr_b16 v[198:199], v231 offset:12800
    v_mul_f32 v63, v63, v247
    v_cvt_pk_bf16_f32 v51, v62, v63
    buffer_store_dwordx4 v[48:51], v225, s[32:35], s51 offen offset:2048 sc1
    v_mfma_f32_32x32x16_bf16 v[64:79], v[204:207], a[144:147], v[64:79]
    ds_read_b64_tr_b16 v[200:201], v231 offset:28672
    s_bfe_u32 s69, s2, 0x20001
    s_lshr_b32 s70, s2, 6
    s_and_b32 s60, s2, 1
    s_lshl_b32 s60, s60, 5
    s_bfe_u32 s71, s2, 0x30003
    s_lshl_b32 s71, s71, 2
    s_add_u32 s71, s71, s60
    s_add_u32 s71, s71, s40
    v_lshrrev_b32 v249, 4, v232
    v_mfma_f32_32x32x16_bf16 v[80:95], v[204:207], a[148:151], v[80:95]
    ds_read_b64_tr_b16 v[202:203], v231 offset:29184
    s_mul_i32 s76, s2, 8448
    s_add_u32 s76, s76, 18874464
    s_add_u32 s77, s76, 4224
    s_lshr_b32 s61, s2, 2
    s_add_u32 s61, s61, 512
    s_mul_i32 s78, s61, 4224
    s_add_u32 s78, s78, 18874464
    v_and_b32 v250, 15, v249
    v_lshrrev_b32 v251, 4, v249
    s_add_u32 m0, s59, 8192
    s_mul_i32 s54, s14, 4608
    buffer_load_dwordx4 v216, s[28:31], s54 offen lds
    buffer_load_dword v229, v218, s[72:75], 0 offen sc1
    s_waitcnt lgkmcnt(2)
    v_mfma_f32_32x32x16_bf16 v[64:79], v[192:195], a[152:155], v[64:79]
    ds_read_b64_tr_b16 v[204:205], v231 offset:45056
    s_mul_i32 s79, s2, 12288
    s_lshl_b32 s44, s40, 10
    s_add_u32 s79, s79, s44
    s_add_u32 s79, s79, 21495808
    s_mul_i32 s41, s40, 4160
    s_add_u32 s42, s44, 16640
    s_lshl_b32 s43, s40, 12
    v_add_u32 v252, 1, v250
    v_and_b32 v253, 3, v252
    v_mfma_f32_32x32x16_bf16 v[80:95], v[192:195], a[156:159], v[80:95]
    ds_read_b64_tr_b16 v[206:207], v231 offset:45568
    s_mul_i32 s45, s70, 147456
    s_mul_i32 s60, s69, 36864
    s_add_u32 s45, s45, s60
    s_add_u32 s45, s45, s44
    s_add_u32 s45, s45, 24707072
    s_and_b32 s62, s2, 3
    v_mul_u32_u24 v253, 4160, v253
    v_and_b32 v252, 28, v252
    v_lshl_add_u32 v253, v252, 1, v253
    v_mfma_f32_32x32x16_bf16 v[64:79], v[196:199], a[160:163], v[64:79]
    ds_read_b64_tr_b16 v[192:193], v231 offset:61440
    s_lshl_b32 s60, s40, 7
    v_lshl_add_u32 v253, v251, 4, v253
    v_lshlrev_b32 v252, 4, v251
    v_lshlrev_b32 v254, 5, v250
    v_add_u32 v128, s60, v253
    s_add_u32 s60, s60, 17120
    v_sub_u32 v252, v252, v254
    v_add_u32 v129, s60, v252
    v_mfma_f32_32x32x16_bf16 v[80:95], v[196:199], a[164:167], v[80:95]
    ds_read_b64_tr_b16 v[194:195], v231 offset:61952
    s_add_u32 s60, s62, 5
    s_sub_u32 s63, 10, s62
    s_cmp_le_u32 s62, 2
    s_cselect_b32 s60, s60, s63
    s_cselect_b32 s63, 5, 3
    s_cselect_b32 s21, 1.0, 0
    s_cselect_b32 s24, 0, 1.0
    s_lshl_b32 s60, s60, 9
    s_lshl_b32 s63, s63, 9
    s_add_u32 s60, s60, 42496
    s_add_u32 s63, s63, 42496
    v_add_u32 v135, s60, v129
    v_add_u32 v130, s63, v128
    s_waitcnt lgkmcnt(2)
    v_mfma_f32_32x32x16_bf16 v[64:79], v[200:203], a[168:171], v[64:79]
    ds_read_b64_tr_b16 v[196:197], v224 offset:16384
    s_add_u32 s60, s62, 6
    s_sub_u32 s63, 9, s62
    s_cmp_le_u32 s62, 1
    s_cselect_b32 s60, s60, s63
    s_cselect_b32 s63, 6, 2
    s_cselect_b32 s22, 1.0, 0
    s_cselect_b32 s25, 0, 1.0
    s_lshl_b32 s60, s60, 9
    s_lshl_b32 s63, s63, 9
    s_add_u32 s60, s60, 42496
    s_add_u32 s63, s63, 42496
    v_add_u32 v136, s60, v129
    v_add_u32 v131, s63, v128
    v_mfma_f32_32x32x16_bf16 v[80:95], v[200:203], a[172:175], v[80:95]
    ds_read_b64_tr_b16 v[198:199], v224 offset:16896
    s_add_u32 s60, s62, 7
    s_sub_u32 s63, 8, s62
    s_cmp_le_u32 s62, 0
    s_cselect_b32 s60, s60, s63
    s_cselect_b32 s63, 7, 1
    s_cselect_b32 s23, 1.0, 0
    s_cselect_b32 s26, 0, 1.0
    s_lshl_b32 s60, s60, 9
    s_lshl_b32 s63, s63, 9
    s_add_u32 s60, s60, 42496
    s_add_u32 s63, s63, 42496
    v_add_u32 v137, s60, v129
    v_add_u32 v132, s63, v128
    v_mfma_f32_32x32x16_bf16 v[64:79], v[204:207], a[176:179], v[64:79]
    ds_read_b64_tr_b16 v[200:201], v224 offset:20480
    s_lshl_b32 s60, s62, 9
    s_sub_u32 s63, 3584, s60
    s_add_u32 s3, s60, 42496
    s_add_u32 s46, s63, 42496
    v_add_u32 v133, s3, v129
    v_add_u32 v134, s46, v129
    v_lshl_add_u32 v252, v251, 3, v254
    v_add_u32 v252, 32, v252
    v_mfma_f32_32x32x16_bf16 v[80:95], v[204:207], a[180:183], v[80:95]
    ds_read_b64_tr_b16 v[202:203], v224 offset:20992
    v_add_u32 v138, s44, v252
    v_add_u32 v139, s46, v252
    v_add_u32 v140, s3, v252
    s_lshl_b32 s3, s40, 13
    v_add_u32 v141, s3, v232
    s_waitcnt lgkmcnt(2)
    v_mfma_f32_32x32x16_bf16 v[64:79], v[192:195], a[184:187], v[64:79]
    ds_read_b64_tr_b16 v[204:205], v224 offset:24576
    s_lshl_b32 s3, s40, 11
    v_add_u32 v142, s3, v232
    v_add_u32 v144, 114688, v232
    v_lshrrev_b32 v252, 1, v251
    v_add_u32 v143, 114688, v142
    v_and_b32 v253, 1, v251
    s_add_u32 m0, s59, 12288
    s_mul_i32 s54, s15, 4608
    buffer_load_dwordx4 v216, s[28:31], s54 offen lds
    v_mfma_f32_32x32x16_bf16 v[80:95], v[192:195], a[188:191], v[80:95]
    ds_read_b64_tr_b16 v[206:207], v224 offset:25088
    v_lshl_add_u32 v254, v252, 4, v254
    s_lshl_b32 s3, s2, 13
    s_add_u32 s3, s3, s44
    s_add_u32 s3, s3, 34603008
    v_lshl_add_u32 v145, v253, 9, v254
    v_add_u32 v145, s3, v145
    v_mfma_f32_32x32x16_bf16 v[64:79], v[196:199], a[192:195], v[64:79]
    ds_read_b64_tr_b16 v[192:193], v224 offset:28672
    s_sub_u32 s60, s60, s63
    s_lshl_b32 s3, s61, 12
    s_add_u32 s3, s3, s63
    s_add_u32 s3, s3, 34603008
    s_cmp_eq_u32 s40, 0
    s_cselect_b32 s3, s3, 2130706432
    v_mad_i32_i24 v146, v253, s60, v254
    v_add_u32 v146, s3, v146
    v_mfma_f32_32x32x16_bf16 v[80:95], v[196:199], a[196:199], v[80:95]
    ds_read_b64_tr_b16 v[194:195], v224 offset:29184
    v_bfe_u32 v254, v249, 2, 2
    v_lshl_add_u32 v254, v253, 2, v254
    v_and_b32 v253, 3, v249
    v_lshlrev_b32 v253, 3, v253
    s_waitcnt lgkmcnt(2)
    v_mfma_f32_32x32x16_bf16 v[64:79], v[200:203], a[200:203], v[64:79]
    ds_read_b64_tr_b16 v[196:197], v248 offset:8192
    v_lshl_add_u32 v156, v252, 9, v253
    v_lshl_add_u32 v253, v252, 12, v253
    v_lshl_add_u32 v156, v254, 5, v156
    v_lshl_add_u32 v253, v254, 7, v253
    v_mfma_f32_32x32x16_bf16 v[80:95], v[200:203], a[204:207], v[80:95]
    ds_read_b64_tr_b16 v[198:199], v248 offset:8704
    v_add_u32 v156, 126976, v156
    v_lshrrev_b32 v254, 1, v254
    v_lshl_add_u32 v152, v254, 5, v253
    v_xor_b32 v153, 32, v152
    v_mfma_f32_32x32x16_bf16 v[64:79], v[204:207], a[208:211], v[64:79]
    ds_read_b64_tr_b16 v[200:201], v248 offset:16384
    v_xor_b32 v154, 64, v152
    v_xor_b32 v155, 0x60, v152
    v_add_u32 v236, 0x10000, v152
    v_add_u32 v237, 0x10000, v153
    v_mfma_f32_32x32x16_bf16 v[80:95], v[204:207], a[212:215], v[80:95]
    ds_read_b64_tr_b16 v[202:203], v248 offset:16896
    v_add_u32 v238, 0x10000, v154
    v_add_u32 v239, 0x10000, v155
    v_lshrrev_b32 v252, 3, v249
    v_and_b32 v253, 7, v249
    s_waitcnt lgkmcnt(2)
    v_mfma_f32_32x32x16_bf16 v[64:79], v[192:195], a[216:219], v[64:79]
    ds_read_b64_tr_b16 v[204:205], v248 offset:24576
    s_lshr_b32 s60, s71, 1
    s_lshl_b32 s60, s60, 2
    s_add_u32 s60, s60, s69
    s_lshl_b32 s60, s60, 7
    s_add_u32 s60, s60, 25296896
    v_lshl_add_u32 v157, v253, 2, s60
    v_and_b32 v254, 6, v252
    v_xor_b32 v253, v253, v254
    v_mfma_f32_32x32x16_bf16 v[80:95], v[192:195], a[220:223], v[80:95]
    ds_read_b64_tr_b16 v[206:207], v248 offset:25088
    s_mul_i32 s60, s69, 1152
    s_lshl_b32 s63, s40, 4
    s_add_u32 s60, s60, s63
    s_mul_i32 s60, s60, 1152
    s_lshl_b32 s63, s70, 8
    s_add_u32 s60, s60, s63
    s_add_u32 s60, s60, 4096
    v_lshlrev_b32 v253, 4, v253
    v_mul_u32_u24 v252, 1152, v252
    s_add_u32 m0, s59, 32768
    s_mul_i32 s54, s47, 4608
    buffer_load_dwordx4 v216, s[28:31], s54 offen lds
    v_mfma_f32_32x32x16_bf16 v[64:79], v[196:199], a[232:235], v[64:79]
    ds_read_b64_tr_b16 v[192:193], v248 offset:4096
    s_and_b32 s63, s69, 1
    s_lshl_b32 s63, s63, 7
    s_add_u32 s3, s60, s63
    s_sub_u32 s60, s60, s63
    s_sub_u32 s60, s60, 896
    v_add3_u32 v148, v252, v253, s3
    v_add3_u32 v149, v252, v253, s60
    v_mfma_f32_32x32x16_bf16 v[80:95], v[196:199], a[236:239], v[80:95]
    ds_read_b64_tr_b16 v[194:195], v248 offset:4608
    v_add_u32 v150, 7168, v148
    v_add_u32 v151, 7168, v149
    s_mul_i32 s60, s69, 4718592
    s_lshl_b32 s63, s71, 11
    s_add_u32 s60, s60, s63
    s_lshr_b32 s63, s69, 1
    s_lshl_b32 s63, s63, 10
    s_add_u32 s60, s60, s63
    v_add_u32 v158, s60, v232
    s_waitcnt lgkmcnt(2)
    v_mfma_f32_32x32x16_bf16 v[64:79], v[200:203], a[240:243], v[64:79]
    ds_read_b64_tr_b16 v[196:197], v248 offset:12288
    v_xor_b32 v159, 0x400, v158
    s_lshl_b32 s60, s40, 1
    v_add_u32 v233, s60, v232
    s_min_u32 s60, s40, 2
    s_mul_i32 s60, s60, 21248
    s_add_u32 s60, s60, 20736
    v_lshl_add_u32 v147, v249, 3, s60
    v_mfma_f32_32x32x16_bf16 v[80:95], v[200:203], a[244:247], v[80:95]
    ds_read_b64_tr_b16 v[198:199], v248 offset:12800
    v_mov_b32 v234, 0
    v_mov_b32 v235, 0
    s_movk_i32 s27, 4096
    v_mfma_f32_32x32x16_bf16 v[64:79], v[204:207], a[248:251], v[64:79]
    ds_read_b64_tr_b16 v[200:201], v248 offset:20480
    s_xor_b32 s60, s2, 2
    s_mul_i32 s60, s60, 28672
    s_mul_i32 s63, s40, 6144
    s_add_u32 s60, s60, s63
    s_add_u32 s16, s60, 25427968
    v_mfma_f32_32x32x16_bf16 v[80:95], v[204:207], a[252:255], v[80:95]
    ds_read_b64_tr_b16 v[202:203], v248 offset:20992
    s_xor_b32 s60, s2, 4
    s_mul_i32 s60, s60, 28672
    s_mul_i32 s63, s40, 6144
    s_add_u32 s60, s60, s63
    s_add_u32 s17, s60, 25430016
    s_waitcnt vmcnt(2)
    v_cmp_ne_u32 vcc, s82, v229
    s_nop 0
    s_cbranch_vccnz mk_SL_U
mk_BK_U:
    s_waitcnt lgkmcnt(2)
    v_mfma_f32_32x32x16_bf16 v[64:79], v[192:195], v[160:163], v[64:79]
    ds_read_b64_tr_b16 v[204:205], v248 offset:28672
    s_xor_b32 s60, s2, 6
    s_mul_i32 s60, s60, 28672
    s_mul_i32 s63, s40, 6144
    s_add_u32 s60, s60, s63
    s_add_u32 s18, s60, 25432064
    v_mfma_f32_32x32x16_bf16 v[80:95], v[192:195], v[164:167], v[80:95]
    ds_read_b64_tr_b16 v[206:207], v248 offset:29184
    v_mfma_f32_32x32x16_bf16 v[64:79], v[196:199], v[168:171], v[64:79]
    v_mfma_f32_32x32x16_bf16 v[80:95], v[196:199], v[172:175], v[80:95]
    s_waitcnt vmcnt(0)
    s_barrier
    buffer_store_dword v219, v228, s[32:35], 0 offen sc1
    ds_read_b64_tr_b16 v[192:193], v226 offset:16384
    ds_read_b64_tr_b16 v[194:195], v227 offset:16384
    s_waitcnt lgkmcnt(2)
    v_mfma_f32_32x32x16_bf16 v[64:79], v[200:203], v[176:179], v[64:79]
    ds_read_b64_tr_b16 v[196:197], v226 offset:16896
    v_mfma_f32_32x32x16_bf16 v[80:95], v[200:203], v[180:183], v[80:95]
    ds_read_b64_tr_b16 v[198:199], v227 offset:16896
    v_mfma_f32_32x32x16_bf16 v[64:79], v[204:207], v[184:187], v[64:79]
    ds_read_b64_tr_b16 v[200:201], v226 offset:18432
    v_mfma_f32_32x32x16_bf16 v[80:95], v[204:207], v[188:191], v[80:95]
    ds_read_b64_tr_b16 v[202:203], v227 offset:18432
    s_waitcnt lgkmcnt(2)
    v_mfma_f32_32x32x16_bf16 v[96:111], v[192:195], a[0:3], 0
    ds_read_b64_tr_b16 v[204:205], v226 offset:18944
    ds_read_b64_tr_b16 v[206:207], v227 offset:18944
    v_mfma_f32_32x32x16_bf16 v[96:111], v[196:199], a[8:11], v[96:111]
    ds_read_b64_tr_b16 v[192:193], v226 offset:20480
    ds_read_b64_tr_b16 v[194:195], v227 offset:20480
    s_nop 1
    v_mul_f32 v244, s53, v64
    ds_write_b64 v147, v[234:235]
    s_add_u32 m0, s42, 0
    s_add_u32 s54, s79, 0
    buffer_load_dwordx4 v232, s[32:35], s54 offen sc1 lds
    s_waitcnt lgkmcnt(3)
    v_mfma_f32_32x32x16_bf16 v[96:111], v[200:203], a[16:19], v[96:111]
    ds_read_b64_tr_b16 v[196:197], v226 offset:20992
    ds_read_b64_tr_b16 v[198:199], v227 offset:20992
    v_exp_f32 v244, v244
    v_mul_f32 v72, v64, v72
    v_mfma_f32_32x32x16_bf16 v[96:111], v[204:207], a[24:27], v[96:111]
    ds_read_b64_tr_b16 v[200:201], v226 offset:22528
    ds_read_b64_tr_b16 v[202:203], v227 offset:22528
    v_add_f32 v244, 1.0, v244
    v_mul_f32 v245, s53, v65
    v_rcp_f32 v244, v244
    s_waitcnt lgkmcnt(2)
    v_mfma_f32_32x32x16_bf16 v[96:111], v[192:195], a[32:35], v[96:111]
    ds_read_b64_tr_b16 v[204:205], v226 offset:23040
    ds_read_b64_tr_b16 v[206:207], v227 offset:23040
    v_exp_f32 v245, v245
    v_mul_f32 v73, v65, v73
    v_mul_f32 v72, v72, v244
    s_add_u32 m0, s41, 0
    s_nop 0
    buffer_load_dwordx4 v233, s[32:35], s76 offen offset:0 sc1 lds
    v_mfma_f32_32x32x16_bf16 v[96:111], v[196:199], a[40:43], v[96:111]
    ds_read_b64_tr_b16 v[192:193], v226 offset:24576
    ds_read_b64_tr_b16 v[194:195], v227 offset:24576
    v_add_f32 v245, 1.0, v245
    v_mul_f32 v246, s53, v66
    v_rcp_f32 v245, v245
    s_waitcnt lgkmcnt(2)
    v_mfma_f32_32x32x16_bf16 v[96:111], v[200:203], a[48:51], v[96:111]
    ds_read_b64_tr_b16 v[196:197], v226 offset:25088
    ds_read_b64_tr_b16 v[198:199], v227 offset:25088
    v_exp_f32 v246, v246
    v_mul_f32 v74, v66, v74
    v_mul_f32 v73, v73, v245
    v_mfma_f32_32x32x16_bf16 v[96:111], v[204:207], a[56:59], v[96:111]
    ds_read_b64_tr_b16 v[200:201], v226 offset:26624
    ds_read_b64_tr_b16 v[202:203], v227 offset:26624
    v_add_f32 v246, 1.0, v246
    v_mul_f32 v247, s53, v67
    v_cvt_pk_bf16_f32 v64, v72, v73
    v_rcp_f32 v246, v246
    buffer_load_dwordx4 v233, s[32:35], s76 offen offset:1024 sc1 lds
    s_waitcnt lgkmcnt(2)
    v_mfma_f32_32x32x16_bf16 v[96:111], v[192:195], a[64:67], v[96:111]
    ds_read_b64_tr_b16 v[204:205], v226 offset:27136
    ds_read_b64_tr_b16 v[206:207], v227 offset:27136
    v_exp_f32 v247, v247
    v_mul_f32 v75, v67, v75
    v_mul_f32 v74, v74, v246
    v_mfma_f32_32x32x16_bf16 v[96:111], v[196:199], a[72:75], v[96:111]
    ds_read_b64_tr_b16 v[192:193], v226 offset:28672
    ds_read_b64_tr_b16 v[194:195], v227 offset:28672
    v_add_f32 v247, 1.0, v247
    v_mul_f32 v244, s53, v68
    v_rcp_f32 v247, v247
    s_waitcnt lgkmcnt(2)
    v_mfma_f32_32x32x16_bf16 v[96:111], v[200:203], a[80:83], v[96:111]
    ds_read_b64_tr_b16 v[196:197], v226 offset:29184
    ds_read_b64_tr_b16 v[198:199], v227 offset:29184
    v_exp_f32 v244, v244
    v_mul_f32 v76, v68, v76
    v_mul_f32 v75, v75, v247
    buffer_load_dwordx4 v233, s[32:35], s76 offen offset:2048 sc1 lds
    v_mfma_f32_32x32x16_bf16 v[96:111], v[204:207], a[88:91], v[96:111]
    ds_read_b64_tr_b16 v[200:201], v226 offset:30720
    ds_read_b64_tr_b16 v[202:203], v227 offset:30720
    v_add_f32 v244, 1.0, v244
    v_mul_f32 v245, s53, v69
    v_cvt_pk_bf16_f32 v65, v74, v75
    v_rcp_f32 v244, v244
    s_waitcnt lgkmcnt(2)
    v_mfma_f32_32x32x16_bf16 v[96:111], v[192:195], a[96:99], v[96:111]
    ds_read_b64_tr_b16 v[204:205], v226 offset:31232
    ds_read_b64_tr_b16 v[206:207], v227 offset:31232
    v_exp_f32 v245, v245
    v_mul_f32 v77, v69, v77
    v_mul_f32 v76, v76, v244
    v_mfma_f32_32x32x16_bf16 v[96:111], v[196:199], a[104:107], v[96:111]
    ds_read_b64_tr_b16 v[192:193], v226 offset:0
    ds_read_b64_tr_b16 v[194:195], v227 offset:0
    v_add_f32 v245, 1.0, v245
    v_mul_f32 v246, s53, v70
    v_rcp_f32 v245, v245
    buffer_load_dwordx4 v233, s[32:35], s76 offen offset:3072 sc1 lds
    s_waitcnt lgkmcnt(2)
    v_mfma_f32_32x32x16_bf16 v[96:111], v[200:203], a[112:115], v[96:111]
    ds_read_b64_tr_b16 v[196:197], v226 offset:512
    ds_read_b64_tr_b16 v[198:199], v227 offset:512
    v_exp_f32 v246, v246
    v_mul_f32 v78, v70, v78
    v_mul_f32 v77, v77, v245
    v_mfma_f32_32x32x16_bf16 v[96:111], v[204:207], a[120:123], v[96:111]
    ds_read_b64_tr_b16 v[200:201], v226 offset:2048
    ds_read_b64_tr_b16 v[202:203], v227 offset:2048
    v_add_f32 v246, 1.0, v246
    v_mul_f32 v247, s53, v71
    v_cvt_pk_bf16_f32 v66, v76, v77
    v_rcp_f32 v246, v246
    s_waitcnt lgkmcnt(2)
    v_mfma_f32_32x32x16_bf16 v[96:111], v[192:195], a[128:131], v[96:111]
    ds_read_b64_tr_b16 v[204:205], v226 offset:2560
    ds_read_b64_tr_b16 v[206:207], v227 offset:2560
    v_exp_f32 v247, v247
    v_mul_f32 v79, v71, v79
    v_mul_f32 v78, v78, v246
    s_add_u32 m0, s41, 4096
    s_add_u32 s54, s76, 4096
    s_mov_b64 exec, 3
    buffer_load_dwordx4 v233, s[32:35], s54 offen sc1 lds
    s_mov_b64 exec, -1
    v_mfma_f32_32x32x16_bf16 v[96:111], v[196:199], a[136:139], v[96:111]
    ds_read_b64_tr_b16 v[192:193], v226 offset:4096
    ds_read_b64_tr_b16 v[194:195], v227 offset:4096
    v_add_f32 v247, 1.0, v247
    v_rcp_f32 v247, v247
    s_waitcnt lgkmcnt(2)
    v_mfma_f32_32x32x16_bf16 v[96:111], v[200:203], a[144:147], v[96:111]
    ds_read_b64_tr_b16 v[196:197], v226 offset:4608
    ds_read_b64_tr_b16 v[198:199], v227 offset:4608
    v_mul_f32 v244, s53, v80
    v_mul_f32 v79, v79, v247
    v_cvt_pk_bf16_f32 v67, v78, v79
    buffer_store_dwordx4 v[64:67], v225, s[32:35], s51 offen offset:512 sc1
    v_mfma_f32_32x32x16_bf16 v[96:111], v[204:207], a[152:155], v[96:111]
    ds_read_b64_tr_b16 v[200:201], v226 offset:6144
    ds_read_b64_tr_b16 v[202:203], v227 offset:6144
    v_exp_f32 v244, v244
    v_mul_f32 v88, v80, v88
    s_waitcnt lgkmcnt(2)
    v_mfma_f32_32x32x16_bf16 v[96:111], v[192:195], a[160:163], v[96:111]
    ds_read_b64_tr_b16 v[204:205], v226 offset:6656
    ds_read_b64_tr_b16 v[206:207], v227 offset:6656
    v_add_f32 v244, 1.0, v244
    v_mul_f32 v245, s53, v81
    v_rcp_f32 v244, v244
    s_add_u32 m0, s42, 42496
    s_add_u32 s54, s79, 8192
    buffer_load_dwordx4 v232, s[32:35], s54 offen sc1 lds
    v_mfma_f32_32x32x16_bf16 v[96:111], v[196:199], a[168:171], v[96:111]
    ds_read_b64_tr_b16 v[192:193], v226 offset:8192
    ds_read_b64_tr_b16 v[194:195], v227 offset:8192
    v_exp_f32 v245, v245
    v_mul_f32 v89, v81, v89
    v_mul_f32 v88, v88, v244
    s_waitcnt lgkmcnt(2)
    v_mfma_f32_32x32x16_bf16 v[96:111], v[200:203], a[176:179], v[96:111]
    ds_read_b64_tr_b16 v[196:197], v226 offset:8704
    ds_read_b64_tr_b16 v[198:199], v227 offset:8704
    v_add_f32 v245, 1.0, v245
    v_mul_f32 v246, s53, v82
    v_rcp_f32 v245, v245
    v_mfma_f32_32x32x16_bf16 v[96:111], v[204:207], a[184:187], v[96:111]
    ds_read_b64_tr_b16 v[200:201], v226 offset:10240
    ds_read_b64_tr_b16 v[202:203], v227 offset:10240
    v_exp_f32 v246, v246
    v_mul_f32 v90, v82, v90
    v_mul_f32 v89, v89, v245
    s_add_u32 m0, s41, 42496
    s_nop 0
    buffer_load_dwordx4 v233, s[32:35], s78 offen offset:0 sc1 lds
    s_waitcnt lgkmcnt(2)
    v_mfma_f32_32x32x16_bf16 v[96:111], v[192:195], a[192:195], v[96:111]
    ds_read_b64_tr_b16 v[204:205], v226 offset:10752
    ds_read_b64_tr_b16 v[206:207], v227 offset:10752
    v_add_f32 v246, 1.0, v246
    v_mul_f32 v247, s53, v83
    v_cvt_pk_bf16_f32 v80, v88, v89
    v_rcp_f32 v246, v246
    v_mfma_f32_32x32x16_bf16 v[96:111], v[196:199], a[200:203], v[96:111]
    ds_read_b64_tr_b16 v[192:193], v226 offset:12288
    ds_read_b64_tr_b16 v[194:195], v227 offset:12288
    v_exp_f32 v247, v247
    v_mul_f32 v91, v83, v91
    v_mul_f32 v90, v90, v246
    s_waitcnt lgkmcnt(2)
    v_mfma_f32_32x32x16_bf16 v[96:111], v[200:203], a[208:211], v[96:111]
    ds_read_b64_tr_b16 v[196:197], v226 offset:12800
    ds_read_b64_tr_b16 v[198:199], v227 offset:12800
    v_add_f32 v247, 1.0, v247
    v_mul_f32 v244, s53, v84
    v_rcp_f32 v247, v247
    buffer_load_dwordx4 v233, s[32:35], s78 offen offset:1024 sc1 lds
    v_mfma_f32_32x32x16_bf16 v[96:111], v[204:207], a[216:219], v[96:111]
    ds_read_b64_tr_b16 v[200:201], v226 offset:14336
    ds_read_b64_tr_b16 v[202:203], v227 offset:14336
    v_exp_f32 v244, v244
    v_mul_f32 v92, v84, v92
    v_mul_f32 v91, v91, v247
    s_waitcnt lgkmcnt(2)
    v_mfma_f32_32x32x16_bf16 v[96:111], v[192:195], a[224:227], v[96:111]
    ds_read_b64_tr_b16 v[204:205], v226 offset:14848
    ds_read_b64_tr_b16 v[206:207], v227 offset:14848
    v_add_f32 v244, 1.0, v244
    v_mul_f32 v245, s53, v85
    v_cvt_pk_bf16_f32 v81, v90, v91
    v_rcp_f32 v244, v244
    v_mfma_f32_32x32x16_bf16 v[96:111], v[196:199], a[232:235], v[96:111]
    ds_read_b64_tr_b16 v[192:193], v226 offset:32768
    ds_read_b64_tr_b16 v[194:195], v227 offset:32768
    v_exp_f32 v245, v245
    v_mul_f32 v93, v85, v93
    v_mul_f32 v92, v92, v244
    buffer_load_dwordx4 v233, s[32:35], s78 offen offset:2048 sc1 lds
    s_waitcnt lgkmcnt(2)
    v_mfma_f32_32x32x16_bf16 v[96:111], v[200:203], a[240:243], v[96:111]
    ds_read_b64_tr_b16 v[196:197], v226 offset:33280
    ds_read_b64_tr_b16 v[198:199], v227 offset:33280
    v_add_f32 v245, 1.0, v245
    v_mul_f32 v246, s53, v86
    v_rcp_f32 v245, v245
    v_mfma_f32_32x32x16_bf16 v[96:111], v[204:207], a[248:251], v[96:111]
    ds_read_b64_tr_b16 v[200:201], v226 offset:34816
    ds_read_b64_tr_b16 v[202:203], v227 offset:34816
    v_exp_f32 v246, v246
    v_mul_f32 v94, v86, v94
    v_mul_f32 v93, v93, v245
    s_waitcnt lgkmcnt(2)
    v_mfma_f32_32x32x16_bf16 v[96:111], v[192:195], v[160:163], v[96:111]
    ds_read_b64_tr_b16 v[204:205], v226 offset:35328
    ds_read_b64_tr_b16 v[206:207], v227 offset:35328
    v_add_f32 v246, 1.0, v246
    v_mul_f32 v247, s53, v87
    v_cvt_pk_bf16_f32 v82, v92, v93
    v_rcp_f32 v246, v246
    buffer_load_dwordx4 v233, s[32:35], s78 offen offset:3072 sc1 lds
    v_mfma_f32_32x32x16_bf16 v[96:111], v[196:199], v[168:171], v[96:111]
    ds_read_b64_tr_b16 v[192:193], v226 offset:16384
    ds_read_b64_tr_b16 v[194:195], v227 offset:16384
    v_exp_f32 v247, v247
    v_mul_f32 v95, v87, v95
    v_mul_f32 v94, v94, v246
    s_waitcnt lgkmcnt(2)
    v_mfma_f32_32x32x16_bf16 v[96:111], v[200:203], v[176:179], v[96:111]
    ds_read_b64_tr_b16 v[196:197], v226 offset:16896
    ds_read_b64_tr_b16 v[198:199], v227 offset:16896
    v_add_f32 v247, 1.0, v247
    v_rcp_f32 v247, v247
    v_mfma_f32_32x32x16_bf16 v[96:111], v[204:207], v[184:187], v[96:111]
    ds_read_b64_tr_b16 v[200:201], v226 offset:18432
    ds_read_b64_tr_b16 v[202:203], v227 offset:18432
    v_mul_f32 v95, v95, v247
    v_cvt_pk_bf16_f32 v83, v94, v95
    buffer_store_dwordx4 v[80:83], v225, s[32:35], s51 offen offset:2560 sc1
    s_waitcnt lgkmcnt(2)
    v_mfma_f32_32x32x16_bf16 v[112:127], v[192:195], a[4:7], 0
    ds_read_b64_tr_b16 v[204:205], v226 offset:18944
    ds_read_b64_tr_b16 v[206:207], v227 offset:18944
    v_mfma_f32_32x32x16_bf16 v[112:127], v[196:199], a[12:15], v[112:127]
    ds_read_b64_tr_b16 v[192:193], v226 offset:20480
    ds_read_b64_tr_b16 v[194:195], v227 offset:20480
    v_mul_f32 v244, s53, v96
    s_add_u32 m0, s41, 46592
    s_add_u32 s54, s78, 4096
    s_mov_b64 exec, 3
    buffer_load_dwordx4 v233, s[32:35], s54 offen sc1 lds
    s_mov_b64 exec, -1
    s_waitcnt lgkmcnt(2)
    v_mfma_f32_32x32x16_bf16 v[112:127], v[200:203], a[20:23], v[112:127]
    ds_read_b64_tr_b16 v[196:197], v226 offset:20992
    ds_read_b64_tr_b16 v[198:199], v227 offset:20992
    v_exp_f32 v244, v244
    v_mul_f32 v104, v96, v104
    s_add_u32 m0, s42, 21248
    s_add_u32 s54, s79, 4096
    buffer_load_dwordx4 v232, s[32:35], s54 offen sc1 lds
    v_mfma_f32_32x32x16_bf16 v[112:127], v[204:207], a[28:31], v[112:127]
    ds_read_b64_tr_b16 v[200:201], v226 offset:22528
    ds_read_b64_tr_b16 v[202:203], v227 offset:22528
    v_add_f32 v244, 1.0, v244
    v_mul_f32 v245, s53, v97
    v_rcp_f32 v244, v244
    s_waitcnt lgkmcnt(2)
    v_mfma_f32_32x32x16_bf16 v[112:127], v[192:195], a[36:39], v[112:127]
    ds_read_b64_tr_b16 v[204:205], v226 offset:23040
    ds_read_b64_tr_b16 v[206:207], v227 offset:23040
    v_exp_f32 v245, v245
    v_mul_f32 v105, v97, v105
    v_mul_f32 v104, v104, v244
    v_mfma_f32_32x32x16_bf16 v[112:127], v[196:199], a[44:47], v[112:127]
    ds_read_b64_tr_b16 v[192:193], v226 offset:24576
    ds_read_b64_tr_b16 v[194:195], v227 offset:24576
    v_add_f32 v245, 1.0, v245
    v_mul_f32 v246, s53, v98
    v_rcp_f32 v245, v245
    s_add_u32 m0, s41, 21248
    s_nop 0
    buffer_load_dwordx4 v233, s[32:35], s77 offen offset:0 sc1 lds
    s_waitcnt lgkmcnt(2)
    v_mfma_f32_32x32x16_bf16 v[112:127], v[200:203], a[52:55], v[112:127]
    ds_read_b64_tr_b16 v[196:197], v226 offset:25088
    ds_read_b64_tr_b16 v[198:199], v227 offset:25088
    v_exp_f32 v246, v246
    v_mul_f32 v106, v98, v106
    v_mul_f32 v105, v105, v245
    v_mfma_f32_32x32x16_bf16 v[112:127], v[204:207], a[60:63], v[112:127]
    ds_read_b64_tr_b16 v[200:201], v226 offset:26624
    ds_read_b64_tr_b16 v[202:203], v227 offset:26624
    v_add_f32 v246, 1.0, v246
    v_mul_f32 v247, s53, v99
    v_cvt_pk_bf16_f32 v96, v104, v105
    v_rcp_f32 v246, v246
    s_waitcnt lgkmcnt(2)
    v_mfma_f32_32x32x16_bf16 v[112:127], v[192:195], a[68:71], v[112:127]
    ds_read_b64_tr_b16 v[204:205], v226 offset:27136
    ds_read_b64_tr_b16 v[206:207], v227 offset:27136
    v_exp_f32 v247, v247
    v_mul_f32 v107, v99, v107
    v_mul_f32 v106, v106, v246
    buffer_load_dwordx4 v233, s[32:35], s77 offen offset:1024 sc1 lds
    v_mfma_f32_32x32x16_bf16 v[112:127], v[196:199], a[76:79], v[112:127]
    ds_read_b64_tr_b16 v[192:193], v226 offset:28672
    ds_read_b64_tr_b16 v[194:195], v227 offset:28672
    v_add_f32 v247, 1.0, v247
    v_mul_f32 v244, s53, v100
    v_rcp_f32 v247, v247
    s_waitcnt lgkmcnt(2)
    v_mfma_f32_32x32x16_bf16 v[112:127], v[200:203], a[84:87], v[112:127]
    ds_read_b64_tr_b16 v[196:197], v226 offset:29184
    ds_read_b64_tr_b16 v[198:199], v227 offset:29184
    v_exp_f32 v244, v244
    v_mul_f32 v108, v100, v108
    v_mul_f32 v107, v107, v247
    v_mfma_f32_32x32x16_bf16 v[112:127], v[204:207], a[92:95], v[112:127]
    ds_read_b64_tr_b16 v[200:201], v226 offset:30720
    ds_read_b64_tr_b16 v[202:203], v227 offset:30720
    v_add_f32 v244, 1.0, v244
    v_mul_f32 v245, s53, v101
    v_cvt_pk_bf16_f32 v97, v106, v107
    v_rcp_f32 v244, v244
    buffer_load_dwordx4 v233, s[32:35], s77 offen offset:2048 sc1 lds
    s_waitcnt lgkmcnt(2)
    v_mfma_f32_32x32x16_bf16 v[112:127], v[192:195], a[100:103], v[112:127]
    ds_read_b64_tr_b16 v[204:205], v226 offset:31232
    ds_read_b64_tr_b16 v[206:207], v227 offset:31232
    v_exp_f32 v245, v245
    v_mul_f32 v109, v101, v109
    v_mul_f32 v108, v108, v244
    v_mfma_f32_32x32x16_bf16 v[112:127], v[196:199], a[108:111], v[112:127]
    ds_read_b64_tr_b16 v[192:193], v226 offset:0
    ds_read_b64_tr_b16 v[194:195], v227 offset:0
    v_add_f32 v245, 1.0, v245
    v_mul_f32 v246, s53, v102
    v_rcp_f32 v245, v245
    s_waitcnt lgkmcnt(2)
    v_mfma_f32_32x32x16_bf16 v[112:127], v[200:203], a[116:119], v[112:127]
    ds_read_b64_tr_b16 v[196:197], v226 offset:512
    ds_read_b64_tr_b16 v[198:199], v227 offset:512
    v_exp_f32 v246, v246
    v_mul_f32 v110, v102, v110
    v_mul_f32 v109, v109, v245
    buffer_load_dwordx4 v233, s[32:35], s77 offen offset:3072 sc1 lds
    s_waitcnt vmcnt(13)
    s_barrier
    v_mfma_f32_32x32x16_bf16 v[112:127], v[204:207], a[124:127], v[112:127]
    ds_read_b64_tr_b16 v[200:201], v226 offset:2048
    ds_read_b64_tr_b16 v[202:203], v227 offset:2048
    ds_read_b128 a[192:195], v129 offset:3584
    v_add_f32 v246, 1.0, v246
    v_mul_f32 v247, s53, v103
    v_cvt_pk_bf16_f32 v98, v108, v109
    v_rcp_f32 v246, v246
    s_waitcnt lgkmcnt(3)
    v_mfma_f32_32x32x16_bf16 v[112:127], v[192:195], a[132:135], v[112:127]
    ds_read_b64_tr_b16 v[204:205], v226 offset:2560
    ds_read_b64_tr_b16 v[206:207], v227 offset:2560
    ds_read_b64 a[128:129], v128 offset:0
    v_exp_f32 v247, v247
    v_mul_f32 v111, v103, v111
    v_mul_f32 v110, v110, v246
    v_mfma_f32_32x32x16_bf16 v[112:127], v[196:199], a[140:143], v[112:127]
    ds_read_b64_tr_b16 v[192:193], v226 offset:4096
    ds_read_b64_tr_b16 v[194:195], v227 offset:4096
    ds_read_b64 a[130:131], v128 offset:8
    v_add_f32 v247, 1.0, v247
    v_rcp_f32 v247, v247
    s_add_u32 m0, s41, 25344
    s_add_u32 s54, s77, 4096
    s_mov_b64 exec, 3
    buffer_load_dwordx4 v233, s[32:35], s54 offen sc1 lds
    s_mov_b64 exec, -1
    s_waitcnt lgkmcnt(4)
    v_mfma_f32_32x32x16_bf16 v[112:127], v[200:203], a[148:151], v[112:127]
    ds_read_b64_tr_b16 v[196:197], v226 offset:4608
    ds_read_b64_tr_b16 v[198:199], v227 offset:4608
    ds_read_b64 a[136:137], v128 offset:512
    v_mul_f32 v111, v111, v247
    v_cvt_pk_bf16_f32 v99, v110, v111
    buffer_store_dwordx4 v[96:99], v225, s[32:35], s52 offen offset:0 sc1
    v_mfma_f32_32x32x16_bf16 v[112:127], v[204:207], a[156:159], v[112:127]
    ds_read_b64_tr_b16 v[200:201], v226 offset:6144
    ds_read_b64_tr_b16 v[202:203], v227 offset:6144
    ds_read_b64 a[138:139], v128 offset:520
    s_waitcnt lgkmcnt(4)
    v_mfma_f32_32x32x16_bf16 v[112:127], v[192:195], a[164:167], v[112:127]
    ds_read_b64_tr_b16 v[204:205], v226 offset:6656
    ds_read_b64_tr_b16 v[206:207], v227 offset:6656
    ds_read_b64 a[144:145], v128 offset:1024
    s_add_u32 m0, s43, 65536
    s_mov_b32 s54, 0
    buffer_load_dwordx4 v148, s[36:39], s54 offen offset:0 lds
    v_mfma_f32_32x32x16_bf16 v[112:127], v[196:199], a[172:175], v[112:127]
    ds_read_b64_tr_b16 v[192:193], v226 offset:8192
    ds_read_b64_tr_b16 v[194:195], v227 offset:8192
    ds_read_b64 a[146:147], v128 offset:1032
    s_waitcnt lgkmcnt(4)
    v_mfma_f32_32x32x16_bf16 v[112:127], v[200:203], a[180:183], v[112:127]
    ds_read_b64_tr_b16 v[196:197], v226 offset:8704
    ds_read_b64_tr_b16 v[198:199], v227 offset:8704
    ds_read_b64 a[152:153], v128 offset:1536
    v_mfma_f32_32x32x16_bf16 v[112:127], v[204:207], a[188:191], v[112:127]
    ds_read_b64_tr_b16 v[200:201], v226 offset:10240
    ds_read_b64_tr_b16 v[202:203], v227 offset:10240
    ds_read_b64 a[154:155], v128 offset:1544
    buffer_load_dwordx4 v149, s[36:39], s54 offen offset:1024 lds
    s_waitcnt lgkmcnt(4)
    v_mfma_f32_32x32x16_bf16 v[112:127], v[192:195], a[196:199], v[112:127]
    ds_read_b64_tr_b16 v[204:205], v226 offset:10752
    ds_read_b64_tr_b16 v[206:207], v227 offset:10752
    ds_read_b64 a[160:161], v128 offset:2048
    v_mfma_f32_32x32x16_bf16 v[112:127], v[196:199], a[204:207], v[112:127]
    ds_read_b64_tr_b16 v[192:193], v226 offset:12288
    ds_read_b64_tr_b16 v[194:195], v227 offset:12288
    ds_read_b64 a[162:163], v128 offset:2056
    s_waitcnt lgkmcnt(4)
    v_mfma_f32_32x32x16_bf16 v[112:127], v[200:203], a[212:215], v[112:127]
    ds_read_b64_tr_b16 v[196:197], v226 offset:12800
    ds_read_b64_tr_b16 v[198:199], v227 offset:12800
    ds_read_b64 a[168:169], v128 offset:2560
    buffer_load_dwordx4 v150, s[36:39], s54 offen offset:2048 lds
    v_mfma_f32_32x32x16_bf16 v[112:127], v[204:207], a[220:223], v[112:127]
    ds_read_b64_tr_b16 v[200:201], v226 offset:14336
    ds_read_b64_tr_b16 v[202:203], v227 offset:14336
    ds_read_b64 a[170:171], v128 offset:2568
    s_waitcnt lgkmcnt(4)
    v_mfma_f32_32x32x16_bf16 v[112:127], v[192:195], a[228:231], v[112:127]
    ds_read_b64_tr_b16 v[204:205], v226 offset:14848
    ds_read_b64_tr_b16 v[206:207], v227 offset:14848
    ds_read_b64 a[176:177], v128 offset:3072
    v_mfma_f32_32x32x16_bf16 v[112:127], v[196:199], a[236:239], v[112:127]
    ds_read_b64_tr_b16 v[192:193], v226 offset:32768
    ds_read_b64_tr_b16 v[194:195], v227 offset:32768
    ds_read_b64 a[178:179], v128 offset:3080
    buffer_load_dwordx4 v151, s[36:39], s54 offen offset:3072 lds
    s_waitcnt lgkmcnt(4)
    v_mfma_f32_32x32x16_bf16 v[112:127], v[200:203], a[244:247], v[112:127]
    ds_read_b64_tr_b16 v[196:197], v226 offset:33280
    ds_read_b64_tr_b16 v[198:199], v227 offset:33280
    ds_read_b64 a[184:185], v128 offset:3584
    v_mfma_f32_32x32x16_bf16 v[112:127], v[204:207], a[252:255], v[112:127]
    ds_read_b64_tr_b16 v[200:201], v226 offset:34816
    ds_read_b64_tr_b16 v[202:203], v227 offset:34816
    ds_read_b64 a[186:187], v128 offset:3592
    s_waitcnt lgkmcnt(4)
    v_mfma_f32_32x32x16_bf16 v[112:127], v[192:195], v[164:167], v[112:127]
    ds_read_b64_tr_b16 v[204:205], v226 offset:35328
    ds_read_b64_tr_b16 v[206:207], v227 offset:35328
    ds_read_b128 a[200:203], v129 offset:3072
    s_add_u32 m0, s44, 135168
    s_add_u32 s54, s45, 0
    buffer_load_dwordx4 v232, s[32:35], s54 offen sc1 lds
    v_mfma_f32_32x32x16_bf16 v[112:127], v[196:199], v[172:175], v[112:127]
    ds_read_b128 a[208:211], v129 offset:2560
    s_waitcnt lgkmcnt(2)
    v_mfma_f32_32x32x16_bf16 v[112:127], v[200:203], v[180:183], v[112:127]
    ds_read_b128 a[216:219], v129 offset:2048
    v_mfma_f32_32x32x16_bf16 v[112:127], v[204:207], v[188:191], v[112:127]
    ds_read_b128 a[224:227], v129 offset:1536
    s_add_u32 m0, s43, 81920
    s_mov_b32 s54, 147456
    buffer_load_dwordx4 v148, s[36:39], s54 offen offset:0 lds
    v_mfma_f32_16x16x32_bf16 v[0:3], a[128:131], a[192:195], 0
    ds_read_b128 a[232:235], v129 offset:1024
    buffer_load_dwordx4 v149, s[36:39], s54 offen offset:1024 lds
    v_mfma_f32_16x16x32_bf16 v[4:7], a[136:139], a[192:195], 0
    s_waitcnt vmcnt(8)
    s_barrier
    v_mov_b32 v234, 2
    v_mov_b32 v235, 3
    buffer_store_dword v234, v228, s[32:35], 0 offen sc1
    ds_read_b128 a[240:243], v129 offset:512
    v_mfma_f32_16x16x32_bf16 v[8:11], a[144:147], a[192:195], 0
    ds_read_b128 a[248:251], v129 offset:0
    v_mfma_f32_16x16x32_bf16 v[12:15], a[152:155], a[192:195], 0
    ds_read_b128 a[64:67], v129 offset:3648
    v_mul_f32 v244, s53, v112
    buffer_load_dwordx4 v150, s[36:39], s54 offen offset:2048 lds
    v_mfma_f32_16x16x32_bf16 v[16:19], a[160:163], a[192:195], 0
    ds_read_b64 a[0:1], v128 offset:64
    v_exp_f32 v244, v244
    v_mfma_f32_16x16x32_bf16 v[20:23], a[168:171], a[192:195], 0
    ds_read_b64 a[2:3], v128 offset:72
    v_mul_f32 v120, v112, v120
    v_add_f32 v244, 1.0, v244
    v_mfma_f32_16x16x32_bf16 v[24:27], a[176:179], a[192:195], 0
    ds_read_b64 a[8:9], v128 offset:576
    v_mul_f32 v245, s53, v113
    buffer_load_dwordx4 v151, s[36:39], s54 offen offset:3072 lds
    v_mfma_f32_16x16x32_bf16 v[28:31], a[184:187], a[192:195], 0
    ds_read_b64 a[10:11], v128 offset:584
    v_rcp_f32 v244, v244
    s_waitcnt lgkmcnt(11)
    v_mfma_f32_16x16x32_bf16 v[4:7], a[128:131], a[200:203], v[4:7]
    ds_read_b64 a[16:17], v128 offset:1088
    v_exp_f32 v245, v245
    v_mfma_f32_16x16x32_bf16 v[8:11], a[136:139], a[200:203], v[8:11]
    ds_read_b64 a[18:19], v128 offset:1096
    v_mul_f32 v121, v113, v121
    v_mul_f32 v120, v120, v244
    s_add_u32 m0, s44, 139264
    s_add_u32 s54, s45, 4096
    buffer_load_dwordx4 v232, s[32:35], s54 offen sc1 lds
    v_mfma_f32_16x16x32_bf16 v[12:15], a[144:147], a[200:203], v[12:15]
    ds_read_b64 a[24:25], v128 offset:1600
    ds_read_b64 a[26:27], v128 offset:1608
    v_add_f32 v245, 1.0, v245
    v_mul_f32 v246, s53, v114
    v_mfma_f32_16x16x32_bf16 v[16:19], a[152:155], a[200:203], v[16:19]
    ds_read_b64 a[32:33], v128 offset:2112
    ds_read_b64 a[34:35], v128 offset:2120
    v_rcp_f32 v245, v245
    v_mfma_f32_16x16x32_bf16 v[20:23], a[160:163], a[200:203], v[20:23]
    ds_read_b64 a[40:41], v128 offset:2624
    ds_read_b64 a[42:43], v128 offset:2632
    v_exp_f32 v246, v246
    buffer_load_dword v147, v157, s[32:35], 0 offen sc1
    v_mfma_f32_16x16x32_bf16 v[24:27], a[168:171], a[200:203], v[24:27]
    ds_read_b64 a[48:49], v128 offset:3136
    ds_read_b64 a[50:51], v128 offset:3144
    v_mul_f32 v122, v114, v122
    v_mul_f32 v121, v121, v245
    v_mfma_f32_16x16x32_bf16 v[28:31], a[176:179], a[200:203], v[28:31]
    ds_read_b64 a[56:57], v128 offset:3648
    ds_read_b64 a[58:59], v128 offset:3656
    v_add_f32 v246, 1.0, v246
    v_mul_f32 v247, s53, v115
    s_add_u32 m0, s43, 98304
    s_mov_b32 s54, 294912
    buffer_load_dwordx4 v148, s[36:39], s54 offen offset:0 lds
    s_waitcnt lgkmcnt(15)
    v_mfma_f32_16x16x32_bf16 v[8:11], a[128:131], a[208:211], v[8:11]
    ds_read_b128 a[72:75], v129 offset:3136
    v_cvt_pk_bf16_f32 v112, v120, v121
    v_mfma_f32_16x16x32_bf16 v[12:15], a[136:139], a[208:211], v[12:15]
    ds_read_b128 a[80:83], v129 offset:2624
    v_rcp_f32 v246, v246
    v_mfma_f32_16x16x32_bf16 v[16:19], a[144:147], a[208:211], v[16:19]
    ds_read_b128 a[88:91], v129 offset:2112
    v_exp_f32 v247, v247
    v_mfma_f32_16x16x32_bf16 v[20:23], a[152:155], a[208:211], v[20:23]
    ds_read_b128 a[96:99], v129 offset:1600
    v_mul_f32 v123, v115, v123
    v_mul_f32 v122, v122, v246
    buffer_load_dwordx4 v149, s[36:39], s54 offen offset:1024 lds
    v_mfma_f32_16x16x32_bf16 v[24:27], a[160:163], a[208:211], v[24:27]
    ds_read_b128 a[104:107], v129 offset:1088
    v_add_f32 v247, 1.0, v247
    v_mul_f32 v244, s53, v116
    v_mfma_f32_16x16x32_bf16 v[28:31], a[168:171], a[208:211], v[28:31]
    ds_read_b128 a[112:115], v129 offset:576
    v_rcp_f32 v247, v247
    v_mfma_f32_16x16x32_bf16 v[12:15], a[128:131], a[216:219], v[12:15]
    ds_read_b128 a[120:123], v129 offset:64
    v_exp_f32 v244, v244
    v_mfma_f32_16x16x32_bf16 v[16:19], a[136:139], a[216:219], v[16:19]
    ds_read_b128 a[68:71], v133 offset:0
    v_mul_f32 v124, v116, v124
    v_mul_f32 v123, v123, v247
    buffer_load_dwordx4 v150, s[36:39], s54 offen offset:2048 lds
    v_mfma_f32_16x16x32_bf16 v[20:23], a[144:147], a[216:219], v[20:23]
    ds_read_b64 a[4:5], v128 offset:42496
    v_add_f32 v244, 1.0, v244
    v_mul_f32 v245, s53, v117
    v_mfma_f32_16x16x32_bf16 v[24:27], a[152:155], a[216:219], v[24:27]
    ds_read_b64 a[6:7], v128 offset:42504
    v_cvt_pk_bf16_f32 v113, v122, v123
    v_mfma_f32_16x16x32_bf16 v[28:31], a[160:163], a[216:219], v[28:31]
    ds_read_b128 a[108:111], v135 offset:0
    v_rcp_f32 v244, v244
    v_mfma_f32_16x16x32_bf16 v[16:19], a[128:131], a[224:227], v[16:19]
    ds_read_b64 a[44:45], v130 offset:0
    v_exp_f32 v245, v245
    buffer_load_dwordx4 v151, s[36:39], s54 offen offset:3072 lds
    v_mfma_f32_16x16x32_bf16 v[20:23], a[136:139], a[224:227], v[20:23]
    ds_read_b64 a[46:47], v130 offset:8
    v_mul_f32 v125, v117, v125
    v_mul_f32 v124, v124, v244
    v_mfma_f32_16x16x32_bf16 v[24:27], a[144:147], a[224:227], v[24:27]
    ds_read_b128 a[76:79], v133 offset:512
    v_add_f32 v245, 1.0, v245
    v_mul_f32 v246, s53, v118
    v_mfma_f32_16x16x32_bf16 v[28:31], a[152:155], a[224:227], v[28:31]
    ds_read_b64 a[12:13], v128 offset:43008
    v_rcp_f32 v245, v245
    v_mfma_f32_16x16x32_bf16 v[20:23], a[128:131], a[232:235], v[20:23]
    ds_read_b64 a[14:15], v128 offset:43016
    v_exp_f32 v246, v246
    s_add_u32 m0, s44, 143360
    s_add_u32 s54, s45, 8192
    buffer_load_dwordx4 v232, s[32:35], s54 offen sc1 lds
    v_mfma_f32_16x16x32_bf16 v[24:27], a[136:139], a[232:235], v[24:27]
    ds_read_b128 a[116:119], v136 offset:0
    v_mul_f32 v126, v118, v126
    v_mul_f32 v125, v125, v245
    v_mfma_f32_16x16x32_bf16 v[28:31], a[144:147], a[232:235], v[28:31]
    ds_read_b64 a[52:53], v131 offset:0
    v_add_f32 v246, 1.0, v246
    v_mul_f32 v247, s53, v119
    v_mfma_f32_16x16x32_bf16 v[24:27], a[128:131], a[240:243], v[24:27]
    ds_read_b64 a[54:55], v131 offset:8
    v_cvt_pk_bf16_f32 v114, v124, v125
    v_mfma_f32_16x16x32_bf16 v[28:31], a[136:139], a[240:243], v[28:31]
    ds_read_b128 a[84:87], v133 offset:1024
    v_rcp_f32 v246, v246
    s_add_u32 m0, s44, 147456
    s_add_u32 s54, s45, 12288
    buffer_load_dwordx4 v232, s[32:35], s54 offen sc1 lds
    v_mfma_f32_16x16x32_bf16 v[28:31], a[128:131], a[248:251], v[28:31]
    s_waitcnt vmcnt(6)
    v_cmp_eq_u32 vcc, 0, v147
    s_nop 0
    s_cbranch_vccnz mk_SL_H1
mk_BK_H1:
    ds_read_b64 a[20:21], v128 offset:43520
    v_exp_f32 v247, v247
    s_waitcnt lgkmcnt(15)
    v_mfma_f32_16x16x32_bf16 v[0:3], a[0:3], a[64:67], v[0:3]
    ds_read_b64 a[22:23], v128 offset:43528
    v_mul_f32 v127, v119, v127
    v_mul_f32 v126, v126, v246
    v_mfma_f32_16x16x32_bf16 v[4:7], a[8:11], a[64:67], v[4:7]
    ds_read_b128 a[124:127], v137 offset:0
    v_add_f32 v247, 1.0, v247
    v_mfma_f32_16x16x32_bf16 v[8:11], a[16:19], a[64:67], v[8:11]
    ds_read_b64 a[60:61], v132 offset:0
    v_rcp_f32 v247, v247
    s_mov_b32 s55, 0
    buffer_load_dwordx4 a[128:131], v158, s[32:35], s55 offen sc1
    v_mfma_f32_16x16x32_bf16 v[12:15], a[24:27], a[64:67], v[12:15]
    ds_read_b64 a[62:63], v132 offset:8
    v_mul_f32 v127, v127, v247
    v_cvt_pk_bf16_f32 v115, v126, v127
    v_mfma_f32_16x16x32_bf16 v[16:19], a[32:35], a[64:67], v[16:19]
    ds_read_b128 a[92:95], v133 offset:1536
    buffer_store_dwordx4 v[112:115], v225, s[32:35], s52 offen offset:2048 sc1
    v_mfma_f32_16x16x32_bf16 v[20:23], a[40:43], a[64:67], v[20:23]
    ds_read_b64 a[28:29], v128 offset:44032
    v_mfma_f32_16x16x32_bf16 v[24:27], a[48:51], a[64:67], v[24:27]
    ds_read_b64 a[30:31], v128 offset:44040
    buffer_load_dwordx4 a[132:135], v159, s[32:35], s55 offen sc1
    v_mfma_f32_16x16x32_bf16 v[28:31], a[56:59], a[64:67], v[28:31]
    ds_read_b128 a[196:199], v134 offset:0
    v_mfma_f32_16x16x32_bf16 v[4:7], a[0:3], a[72:75], v[4:7]
    ds_read_b128 a[100:103], v133 offset:2048
    v_mfma_f32_16x16x32_bf16 v[8:11], a[8:11], a[72:75], v[8:11]
    ds_read_b64 a[36:37], v128 offset:44544
    v_mfma_f32_16x16x32_bf16 v[12:15], a[16:19], a[72:75], v[12:15]
    ds_read_b64 a[38:39], v128 offset:44552
    s_mov_b32 s55, 131072
    buffer_load_dwordx4 a[136:139], v158, s[32:35], s55 offen sc1
    v_mfma_f32_16x16x32_bf16 v[16:19], a[24:27], a[72:75], v[16:19]
    ds_read_b128 v[184:187], v135 offset:64
    v_mfma_f32_16x16x32_bf16 v[20:23], a[32:35], a[72:75], v[20:23]
    ds_read_b64 a[244:245], v130 offset:64
    v_mfma_f32_16x16x32_bf16 v[24:27], a[40:43], a[72:75], v[24:27]
    ds_read_b64 a[246:247], v130 offset:72
    v_mfma_f32_16x16x32_bf16 v[28:31], a[48:51], a[72:75], v[28:31]
    ds_read_b128 v[164:167], v133 offset:64
    buffer_load_dwordx4 a[140:143], v159, s[32:35], s55 offen sc1
    v_mfma_f32_16x16x32_bf16 v[8:11], a[0:3], a[80:83], v[8:11]
    ds_read_b64 a[204:205], v128 offset:42560
    v_mfma_f32_16x16x32_bf16 v[12:15], a[8:11], a[80:83], v[12:15]
    ds_read_b64 a[206:207], v128 offset:42568
    v_mfma_f32_16x16x32_bf16 v[16:19], a[16:19], a[80:83], v[16:19]
    ds_read_b128 v[188:191], v136 offset:64
    v_mfma_f32_16x16x32_bf16 v[20:23], a[24:27], a[80:83], v[20:23]
    ds_read_b64 a[252:253], v131 offset:64
    ds_read_b64 a[254:255], v131 offset:72
    s_mov_b32 s55, 524288
    buffer_load_dwordx4 a[144:147], v158, s[32:35], s55 offen sc1
    v_mfma_f32_16x16x32_bf16 v[24:27], a[32:35], a[80:83], v[24:27]
    ds_read_b128 v[168:171], v133 offset:576
    ds_read_b64 a[212:213], v128 offset:43072
    v_mfma_f32_16x16x32_bf16 v[28:31], a[40:43], a[80:83], v[28:31]
    ds_read_b64 a[214:215], v128 offset:43080
    ds_read_b128 v[192:195], v137 offset:64
    v_mfma_f32_16x16x32_bf16 v[12:15], a[0:3], a[88:91], v[12:15]
    ds_read_b64 v[160:161], v132 offset:64
    ds_read_b64 v[162:163], v132 offset:72
    v_mfma_f32_16x16x32_bf16 v[16:19], a[8:11], a[88:91], v[16:19]
    ds_read_b128 v[172:175], v133 offset:1088
    ds_read_b64 a[220:221], v128 offset:43584
    buffer_load_dwordx4 a[148:151], v159, s[32:35], s55 offen sc1
    v_mfma_f32_16x16x32_bf16 v[20:23], a[16:19], a[88:91], v[20:23]
    ds_read_b64 a[222:223], v128 offset:43592
    ds_read_b128 v[196:199], v134 offset:64
    v_mfma_f32_16x16x32_bf16 v[24:27], a[24:27], a[88:91], v[24:27]
    ds_read_b128 v[176:179], v133 offset:1600
    ds_read_b64 a[228:229], v128 offset:44096
    v_mfma_f32_16x16x32_bf16 v[28:31], a[32:35], a[88:91], v[28:31]
    ds_read_b64 a[230:231], v128 offset:44104
    ds_read_b128 v[180:183], v133 offset:2112
    v_mfma_f32_16x16x32_bf16 v[16:19], a[0:3], a[96:99], v[16:19]
    ds_read_b64 a[236:237], v128 offset:44608
    ds_read_b64 a[238:239], v128 offset:44616
    s_add_u32 m0, s44, 151552
    s_add_u32 s54, s45, 16384
    buffer_load_dwordx4 v232, s[32:35], s54 offen sc1 lds
    v_mfma_f32_16x16x32_bf16 v[20:23], a[8:11], a[96:99], v[20:23]
    ds_read_b128 v[200:203], v129 offset:24832
    ds_read_b64 a[192:193], v128 offset:21248
    v_mfma_f32_16x16x32_bf16 v[24:27], a[16:19], a[96:99], v[24:27]
    ds_read_b64 a[194:195], v128 offset:21256
    ds_read_b64 a[200:201], v128 offset:21760
    v_mfma_f32_16x16x32_bf16 v[28:31], a[24:27], a[96:99], v[28:31]
    ds_read_b64 a[202:203], v128 offset:21768
    ds_read_b64 a[208:209], v128 offset:22272
    v_mfma_f32_16x16x32_bf16 v[20:23], a[0:3], a[104:107], v[20:23]
    ds_read_b64 a[210:211], v128 offset:22280
    ds_read_b64 a[216:217], v128 offset:22784
    s_add_u32 m0, s44, 155648
    s_add_u32 s54, s45, 20480
    buffer_load_dwordx4 v232, s[32:35], s54 offen sc1 lds
    v_mfma_f32_16x16x32_bf16 v[24:27], a[8:11], a[104:107], v[24:27]
    ds_read_b64 a[218:219], v128 offset:22792
    ds_read_b64 a[224:225], v128 offset:23296
    v_mfma_f32_16x16x32_bf16 v[28:31], a[16:19], a[104:107], v[28:31]
    ds_read_b64 a[226:227], v128 offset:23304
    ds_read_b64 a[232:233], v128 offset:23808
    v_mfma_f32_16x16x32_bf16 v[24:27], a[0:3], a[112:115], v[24:27]
    ds_read_b64 a[234:235], v128 offset:23816
    ds_read_b64 a[240:241], v128 offset:24320
    v_mfma_f32_16x16x32_bf16 v[28:31], a[8:11], a[112:115], v[28:31]
    ds_read_b64 a[242:243], v128 offset:24328
    ds_read_b64 a[248:249], v128 offset:24832
    s_add_u32 m0, s44, 159744
    s_add_u32 s54, s45, 24576
    buffer_load_dwordx4 v232, s[32:35], s54 offen sc1 lds
    s_waitcnt lgkmcnt(15)
    v_mfma_f32_16x16x32_bf16 v[28:31], a[0:3], a[120:123], v[28:31]
    ds_read_b64 a[250:251], v128 offset:24840
    ds_read_b128 v[204:207], v129 offset:24320
    v_mfma_f32_16x16x32_bf16 v[64:67], a[4:7], a[68:71], 0
    ds_read_b128 v[208:211], v129 offset:23808
    v_mfma_f32_16x16x32_bf16 v[72:75], a[44:47], a[108:111], 0
    ds_read_b128 v[212:215], v129 offset:23296
    v_mfma_f32_16x16x32_bf16 v[64:67], a[12:15], a[76:79], v[64:67]
    ds_read_b128 v[216:219], v129 offset:22784
    s_add_u32 m0, s44, 126976
    s_add_u32 s54, s45, 28672
    buffer_load_dwordx4 v232, s[32:35], s54 offen sc1 lds
    v_mfma_f32_16x16x32_bf16 v[76:79], a[52:55], a[116:119], 0
    ds_read_b128 v[220:223], v129 offset:22272
    v_mfma_f32_16x16x32_bf16 v[64:67], a[20:23], a[84:87], v[64:67]
    ds_read_b128 v[84:87], v129 offset:21760
    v_mfma_f32_16x16x32_bf16 v[80:83], a[60:63], a[124:127], 0
    ds_read_b128 v[88:91], v129 offset:21248
    v_mfma_f32_16x16x32_bf16 v[64:67], a[28:31], a[92:95], v[64:67]
    ds_read_b128 a[64:67], v129 offset:24896
    s_add_u32 m0, s44, 131072
    s_add_u32 s54, s45, 32768
    buffer_load_dwordx4 v232, s[32:35], s54 offen sc1 lds
    v_mfma_f32_16x16x32_bf16 v[68:71], a[4:7], a[196:199], 0
    ds_read_b64 a[0:1], v128 offset:21312
    v_mfma_f32_16x16x32_bf16 v[64:67], a[36:39], a[100:103], v[64:67]
    ds_read_b64 a[2:3], v128 offset:21320
    v_mfma_f32_16x16x32_bf16 v[72:75], a[244:247], v[184:187], v[72:75]
    ds_read_b64 a[8:9], v128 offset:21824
    v_mfma_f32_16x16x32_bf16 v[64:67], a[204:207], v[164:167], v[64:67]
    ds_read_b64 a[10:11], v128 offset:21832
    s_mov_b32 s55, 655360
    buffer_load_dwordx4 a[152:155], v158, s[32:35], s55 offen sc1
    v_mfma_f32_16x16x32_bf16 v[76:79], a[252:255], v[188:191], v[76:79]
    ds_read_b64 a[16:17], v128 offset:22336
    v_mfma_f32_16x16x32_bf16 v[64:67], a[212:215], v[168:171], v[64:67]
    ds_read_b64 a[18:19], v128 offset:22344
    v_mfma_f32_16x16x32_bf16 v[80:83], v[160:163], v[192:195], v[80:83]
    ds_read_b64 a[24:25], v128 offset:22848
    v_mfma_f32_16x16x32_bf16 v[64:67], a[220:223], v[172:175], v[64:67]
    ds_read_b64 a[26:27], v128 offset:22856
    buffer_load_dwordx4 a[156:159], v159, s[32:35], s55 offen sc1
    v_mfma_f32_16x16x32_bf16 v[68:71], a[204:207], v[196:199], v[68:71]
    ds_read_b64 a[32:33], v128 offset:23360
    v_mfma_f32_16x16x32_bf16 v[64:67], a[228:231], v[176:179], v[64:67]
    ds_read_b64 a[34:35], v128 offset:23368
    v_mfma_f32_16x16x32_bf16 v[64:67], a[236:239], v[180:183], v[64:67]
    ds_read_b64 a[40:41], v128 offset:23872
    s_waitcnt lgkmcnt(15)
    v_mfma_f32_16x16x32_bf16 v[32:35], a[192:195], v[200:203], 0
    ds_read_b64 a[42:43], v128 offset:23880
    s_waitcnt vmcnt(12)
    buffer_store_dword v235, v228, s[32:35], 0 offen sc1
    v_mfma_f32_16x16x32_bf16 v[36:39], a[200:203], v[200:203], 0
    ds_read_b64 a[48:49], v128 offset:24384
    v_fmac_f32 v64, s21, v72
    v_fmac_f32 v68, s24, v72
    s_mov_b32 s55, 1048576
    buffer_load_dwordx4 a[160:163], v158, s[32:35], s55 offen sc1
    v_mfma_f32_16x16x32_bf16 v[40:43], a[208:211], v[200:203], 0
    ds_read_b64 a[50:51], v128 offset:24392
    v_fmac_f32 v65, s21, v73
    v_fmac_f32 v69, s24, v73
    v_mfma_f32_16x16x32_bf16 v[44:47], a[216:219], v[200:203], 0
    ds_read_b64 a[56:57], v128 offset:24896
    v_fmac_f32 v66, s21, v74
    v_fmac_f32 v70, s24, v74
    v_mfma_f32_16x16x32_bf16 v[48:51], a[224:227], v[200:203], 0
    ds_read_b64 a[58:59], v128 offset:24904
    v_fmac_f32 v67, s21, v75
    v_fmac_f32 v71, s24, v75
    v_mfma_f32_16x16x32_bf16 v[52:55], a[232:235], v[200:203], 0
    ds_read_b128 a[72:75], v129 offset:24384
    v_fmac_f32 v64, s22, v76
    v_fmac_f32 v68, s25, v76
    buffer_load_dwordx4 a[164:167], v159, s[32:35], s55 offen sc1
    v_mfma_f32_16x16x32_bf16 v[56:59], a[240:243], v[200:203], 0
    ds_read_b128 a[80:83], v129 offset:23872
    v_fmac_f32 v65, s22, v77
    v_fmac_f32 v69, s25, v77
    v_mfma_f32_16x16x32_bf16 v[60:63], a[248:251], v[200:203], 0
    ds_read_b128 a[88:91], v129 offset:23360
    v_fmac_f32 v66, s22, v78
    v_fmac_f32 v70, s25, v78
    v_mfma_f32_16x16x32_bf16 v[36:39], a[192:195], v[204:207], v[36:39]
    ds_read_b128 a[96:99], v129 offset:22848
    v_fmac_f32 v67, s22, v79
    v_fmac_f32 v71, s25, v79
    v_mfma_f32_16x16x32_bf16 v[40:43], a[200:203], v[204:207], v[40:43]
    ds_read_b128 a[104:107], v129 offset:22336
    v_fmac_f32 v64, s23, v80
    v_fmac_f32 v68, s26, v80
    s_mov_b32 s55, 1179648
    buffer_load_dwordx4 a[168:171], v158, s[32:35], s55 offen sc1
    v_mfma_f32_16x16x32_bf16 v[44:47], a[208:211], v[204:207], v[44:47]
    ds_read_b128 a[112:115], v129 offset:21824
    v_fmac_f32 v65, s23, v81
    v_fmac_f32 v69, s26, v81
    v_mfma_f32_16x16x32_bf16 v[48:51], a[216:219], v[204:207], v[48:51]
    ds_read_b128 a[120:123], v129 offset:21312
    ds_read_b64 v[100:101], v138 offset:0
    v_fmac_f32 v66, s23, v82
    v_fmac_f32 v70, s26, v82
    v_mfma_f32_16x16x32_bf16 v[52:55], a[224:227], v[204:207], v[52:55]
    ds_read_b64 v[102:103], v138 offset:512
    ds_read_b64 v[104:105], v138 offset:21248
    v_fmac_f32 v67, s23, v83
    v_fmac_f32 v71, s26, v83
    v_mfma_f32_16x16x32_bf16 v[56:59], a[232:235], v[204:207], v[56:59]
    ds_read_b64 v[106:107], v138 offset:21760
    ds_read_b64 v[108:109], v139 offset:0
    buffer_load_dwordx4 a[172:175], v159, s[32:35], s55 offen sc1
    v_mfma_f32_16x16x32_bf16 v[60:63], a[240:243], v[204:207], v[60:63]
    ds_read_b64 v[110:111], v140 offset:0
    v_mfma_f32_16x16x32_bf16 v[40:43], a[192:195], v[208:211], v[40:43]
    v_mfma_f32_16x16x32_bf16 v[44:47], a[200:203], v[208:211], v[44:47]
    v_mfma_f32_16x16x32_bf16 v[48:51], a[208:211], v[208:211], v[48:51]
    s_mov_b32 s55, 1572864
    buffer_load_dwordx4 a[176:179], v158, s[32:35], s55 offen sc1
    v_mfma_f32_16x16x32_bf16 v[52:55], a[216:219], v[208:211], v[52:55]
    v_mfma_f32_16x16x32_bf16 v[56:59], a[224:227], v[208:211], v[56:59]
    v_mfma_f32_16x16x32_bf16 v[60:63], a[232:235], v[208:211], v[60:63]
    v_mfma_f32_16x16x32_bf16 v[44:47], a[192:195], v[212:215], v[44:47]
    buffer_load_dwordx4 a[180:183], v159, s[32:35], s55 offen sc1
    v_mfma_f32_16x16x32_bf16 v[48:51], a[200:203], v[212:215], v[48:51]
    v_mfma_f32_16x16x32_bf16 v[52:55], a[208:211], v[212:215], v[52:55]
    v_mfma_f32_16x16x32_bf16 v[56:59], a[216:219], v[212:215], v[56:59]
    v_mfma_f32_16x16x32_bf16 v[60:63], a[224:227], v[212:215], v[60:63]
    v_mfma_f32_16x16x32_bf16 v[48:51], a[192:195], v[216:219], v[48:51]
    v_mfma_f32_16x16x32_bf16 v[52:55], a[200:203], v[216:219], v[52:55]
    v_mfma_f32_16x16x32_bf16 v[56:59], a[208:211], v[216:219], v[56:59]
    v_mfma_f32_16x16x32_bf16 v[60:63], a[216:219], v[216:219], v[60:63]
    s_waitcnt lgkmcnt(15)
    v_mfma_f32_16x16x32_bf16 v[52:55], a[192:195], v[220:223], v[52:55]
    v_mfma_f32_16x16x32_bf16 v[56:59], a[200:203], v[220:223], v[56:59]
    v_mfma_f32_16x16x32_bf16 v[60:63], a[208:211], v[220:223], v[60:63]
    v_mfma_f32_16x16x32_bf16 v[56:59], a[192:195], v[84:87], v[56:59]
    v_mfma_f32_16x16x32_bf16 v[60:63], a[200:203], v[84:87], v[60:63]
    s_waitcnt lgkmcnt(0)
    s_barrier
    ds_write_b128 v141, v[0:3] offset:0
    v_mfma_f32_16x16x32_bf16 v[60:63], a[192:195], v[88:91], v[60:63]
    v_mfma_f32_16x16x32_bf16 v[32:35], a[0:3], a[64:67], v[32:35]
    ds_write_b128 v141, v[4:7] offset:1024
    v_mfma_f32_16x16x32_bf16 v[36:39], a[8:11], a[64:67], v[36:39]
    v_mfma_f32_16x16x32_bf16 v[40:43], a[16:19], a[64:67], v[40:43]
    ds_write_b128 v141, v[8:11] offset:2048
    v_mfma_f32_16x16x32_bf16 v[44:47], a[24:27], a[64:67], v[44:47]
    v_mfma_f32_16x16x32_bf16 v[48:51], a[32:35], a[64:67], v[48:51]
    ds_write_b128 v141, v[12:15] offset:3072
    v_mfma_f32_16x16x32_bf16 v[52:55], a[40:43], a[64:67], v[52:55]
    v_mfma_f32_16x16x32_bf16 v[56:59], a[48:51], a[64:67], v[56:59]
    ds_write_b128 v141, v[16:19] offset:4096
    v_mfma_f32_16x16x32_bf16 v[60:63], a[56:59], a[64:67], v[60:63]
    v_mfma_f32_16x16x32_bf16 v[36:39], a[0:3], a[72:75], v[36:39]
    ds_write_b128 v141, v[20:23] offset:5120
    v_mfma_f32_16x16x32_bf16 v[40:43], a[8:11], a[72:75], v[40:43]
    v_mfma_f32_16x16x32_bf16 v[44:47], a[16:19], a[72:75], v[44:47]
    ds_write_b128 v141, v[24:27] offset:6144
    v_mfma_f32_16x16x32_bf16 v[48:51], a[24:27], a[72:75], v[48:51]
    v_mfma_f32_16x16x32_bf16 v[52:55], a[32:35], a[72:75], v[52:55]
    ds_write_b128 v141, v[28:31] offset:7168
    v_mfma_f32_16x16x32_bf16 v[56:59], a[40:43], a[72:75], v[56:59]
    v_mfma_f32_16x16x32_bf16 v[60:63], a[48:51], a[72:75], v[60:63]
    ds_write_b128 v143, v[64:67]
    v_mfma_f32_16x16x32_bf16 v[40:43], a[0:3], a[80:83], v[40:43]
    v_mfma_f32_16x16x32_bf16 v[44:47], a[8:11], a[80:83], v[44:47]
    ds_write_b128 v143, v[68:71] offset:1024
    v_mfma_f32_16x16x32_bf16 v[48:51], a[16:19], a[80:83], v[48:51]
    v_mfma_f32_16x16x32_bf16 v[52:55], a[24:27], a[80:83], v[52:55]
    ds_write_b128 v141, v[32:35] offset:32768
    v_mfma_f32_16x16x32_bf16 v[56:59], a[32:35], a[80:83], v[56:59]
    v_mfma_f32_16x16x32_bf16 v[60:63], a[40:43], a[80:83], v[60:63]
    ds_read_b64_tr_b16 a[192:193], v236 offset:0
    ds_write_b128 v141, v[36:39] offset:33792
    v_mfma_f32_16x16x32_bf16 v[44:47], a[0:3], a[88:91], v[44:47]
    ds_read_b64_tr_b16 a[194:195], v236 offset:2048
    v_mfma_f32_16x16x32_bf16 v[48:51], a[8:11], a[88:91], v[48:51]
    ds_read_b64_tr_b16 a[196:197], v237 offset:0
    ds_write_b128 v141, v[40:43] offset:34816
    v_mfma_f32_16x16x32_bf16 v[52:55], a[16:19], a[88:91], v[52:55]
    ds_read_b64_tr_b16 a[198:199], v237 offset:2048
    v_mfma_f32_16x16x32_bf16 v[56:59], a[24:27], a[88:91], v[56:59]
    ds_read_b64_tr_b16 a[200:201], v238 offset:0
    ds_write_b128 v141, v[44:47] offset:35840
    v_mfma_f32_16x16x32_bf16 v[60:63], a[32:35], a[88:91], v[60:63]
    ds_read_b64_tr_b16 a[202:203], v238 offset:2048
    v_mfma_f32_16x16x32_bf16 v[48:51], a[0:3], a[96:99], v[48:51]
    ds_read_b64_tr_b16 a[204:205], v239 offset:0
    v_mfma_f32_16x16x32_bf16 v[52:55], a[8:11], a[96:99], v[52:55]
    ds_read_b64_tr_b16 a[206:207], v239 offset:2048
    v_mfma_f32_16x16x32_bf16 v[56:59], a[16:19], a[96:99], v[56:59]
    ds_read_b64_tr_b16 a[208:209], v236 offset:1024
    v_mfma_f32_16x16x32_bf16 v[60:63], a[24:27], a[96:99], v[60:63]
    ds_read_b64_tr_b16 a[210:211], v236 offset:3072
    s_nop 0
    ds_write_b128 v141, v[48:51] offset:36864
    v_mfma_f32_16x16x32_bf16 v[52:55], a[0:3], a[104:107], v[52:55]
    ds_read_b64_tr_b16 a[212:213], v237 offset:1024
    v_mfma_f32_16x16x32_bf16 v[56:59], a[8:11], a[104:107], v[56:59]
    ds_read_b64_tr_b16 a[214:215], v237 offset:3072
    v_mfma_f32_16x16x32_bf16 v[60:63], a[16:19], a[104:107], v[60:63]
    v_mfma_f32_16x16x32_bf16 v[56:59], a[0:3], a[112:115], v[56:59]
    s_nop 2
    ds_write_b128 v141, v[52:55] offset:37888
    v_mfma_f32_16x16x32_bf16 v[60:63], a[8:11], a[112:115], v[60:63]
    v_mfma_f32_16x16x32_bf16 v[60:63], a[0:3], a[120:123], v[60:63]
    s_waitcnt vmcnt(18) lgkmcnt(11)
    v_mfma_f32_16x16x32_bf16 v[160:163], a[192:195], a[128:131], 0
    ds_read_b64_tr_b16 a[216:217], v238 offset:1024
    ds_write_b128 v141, v[56:59] offset:38912
    s_mov_b32 s55, 1703936
    buffer_load_dwordx4 a[184:187], v158, s[32:35], s55 offen sc1
    v_mfma_f32_16x16x32_bf16 v[164:167], a[192:195], a[132:135], 0
    ds_read_b64_tr_b16 a[218:219], v238 offset:3072
    v_mfma_f32_16x16x32_bf16 v[168:171], a[196:199], a[128:131], 0
    ds_read_b64_tr_b16 a[220:221], v239 offset:1024
    ds_write_b128 v141, v[60:63] offset:39936
    v_mfma_f32_16x16x32_bf16 v[172:175], a[196:199], a[132:135], 0
    ds_read_b64_tr_b16 a[222:223], v239 offset:3072
    s_waitcnt lgkmcnt(12)
    v_mfma_f32_16x16x32_bf16 v[176:179], a[200:203], a[128:131], 0
    ds_read_b64_tr_b16 a[192:193], v156 offset:8192
    buffer_load_dwordx4 a[188:191], v159, s[32:35], s55 offen sc1
    v_mfma_f32_16x16x32_bf16 v[180:183], a[200:203], a[132:135], 0
    ds_read_b64_tr_b16 a[194:195], v156 offset:8448
    v_mfma_f32_16x16x32_bf16 v[184:187], a[204:207], a[128:131], 0
    ds_read_b64_tr_b16 a[196:197], v236 offset:8192
    v_mfma_f32_16x16x32_bf16 v[188:191], a[204:207], a[132:135], 0
    ds_read_b64_tr_b16 a[198:199], v236 offset:10240
    s_waitcnt lgkmcnt(11)
    v_mfma_f32_16x16x32_bf16 v[192:195], a[208:211], a[128:131], 0
    s_waitcnt lgkmcnt(5)
    s_barrier
    ds_read_b64_tr_b16 a[200:201], v237 offset:8192
    ds_read_b128 v[0:3], v142 offset:0
    v_mfma_f32_16x16x32_bf16 v[196:199], a[208:211], a[132:135], 0
    ds_read_b64_tr_b16 a[202:203], v237 offset:10240
    ds_read_b128 v[4:7], v142 offset:8192
    v_mfma_f32_16x16x32_bf16 v[200:203], a[212:215], a[128:131], 0
    ds_read_b64_tr_b16 a[204:205], v238 offset:8192
    ds_read_b128 v[8:11], v142 offset:16384
    v_mfma_f32_16x16x32_bf16 v[204:207], a[212:215], a[132:135], 0
    ds_read_b64_tr_b16 a[206:207], v238 offset:10240
    ds_read_b128 v[12:15], v142 offset:24576
    s_waitcnt lgkmcnt(12)
    v_mfma_f32_16x16x32_bf16 v[208:211], a[216:219], a[128:131], 0
    ds_read_b64_tr_b16 a[208:209], v239 offset:8192
    ds_read_b128 v[16:19], v142 offset:1024
    v_mfma_f32_16x16x32_bf16 v[212:215], a[216:219], a[132:135], 0
    ds_read_b64_tr_b16 a[210:211], v239 offset:10240
    ds_read_b128 v[20:23], v142 offset:9216
    v_mfma_f32_16x16x32_bf16 v[216:219], a[220:223], a[128:131], 0
    ds_read_b64_tr_b16 a[212:213], v236 offset:9216
    ds_read_b128 v[24:27], v142 offset:17408
    v_mfma_f32_16x16x32_bf16 v[220:223], a[220:223], a[132:135], 0
    ds_read_b64_tr_b16 a[214:215], v236 offset:11264
    ds_read_b128 v[28:31], v142 offset:25600
    s_waitcnt lgkmcnt(15)
    v_mfma_f32_16x16x32_bf16 v[224:227], a[192:195], a[128:131], 0
    ds_read_b64_tr_b16 a[216:217], v237 offset:9216
    ds_read_b128 v[32:35], v142 offset:32768
    v_mfma_f32_16x16x32_bf16 v[228:231], a[192:195], a[132:135], 0
    ds_read_b64_tr_b16 a[218:219], v237 offset:11264
    ds_read_b128 v[36:39], v142 offset:40960
    s_waitcnt lgkmcnt(12)
    v_add_f32 v0, v0, v4
    v_add_f32 v8, v8, v12
    s_waitcnt vmcnt(18)
    v_mfma_f32_16x16x32_bf16 v[160:163], a[196:199], a[136:139], v[160:163]
    ds_read_b64_tr_b16 a[220:221], v238 offset:9216
    ds_read_b128 v[40:43], v142 offset:49152
    v_add_f32 v1, v1, v5
    v_add_f32 v9, v9, v13
    s_mov_b32 s55, 2359296
    buffer_load_dwordx4 a[128:131], v158, s[32:35], s55 offen sc1
    v_mfma_f32_16x16x32_bf16 v[164:167], a[196:199], a[140:143], v[164:167]
    ds_read_b64_tr_b16 a[222:223], v238 offset:11264
    ds_read_b128 v[44:47], v142 offset:57344
    v_add_f32 v2, v2, v6
    v_add_f32 v10, v10, v14
    v_mfma_f32_16x16x32_bf16 v[168:171], a[200:203], a[136:139], v[168:171]
    ds_read_b64_tr_b16 a[192:193], v239 offset:9216
    ds_read_b128 v[48:51], v142 offset:33792
    v_add_f32 v3, v3, v7
    v_add_f32 v11, v11, v15
    v_mfma_f32_16x16x32_bf16 v[172:175], a[200:203], a[140:143], v[172:175]
    ds_read_b64_tr_b16 a[194:195], v239 offset:11264
    ds_read_b128 v[52:55], v142 offset:41984
    v_lshlrev_b32 v4, 16, v100
    v_and_b32 v5, 0xffff0000, v100
    v_mfma_f32_16x16x32_bf16 v[176:179], a[204:207], a[136:139], v[176:179]
    ds_read_b64_tr_b16 a[196:197], v156 offset:9216
    ds_read_b128 v[56:59], v142 offset:50176
    v_lshlrev_b32 v6, 16, v101
    v_and_b32 v7, 0xffff0000, v101
    buffer_load_dwordx4 a[132:135], v159, s[32:35], s55 offen sc1
    v_mfma_f32_16x16x32_bf16 v[180:183], a[204:207], a[140:143], v[180:183]
    ds_read_b64_tr_b16 a[198:199], v156 offset:9472
    ds_read_b128 v[60:63], v142 offset:58368
    v_add_f32 v0, v0, v8
    v_add_f32 v1, v1, v9
    s_waitcnt lgkmcnt(15)
    v_mfma_f32_16x16x32_bf16 v[184:187], a[208:211], a[136:139], v[184:187]
    ds_read_b128 v[112:115], v144 offset:0
    v_add_f32 v2, v2, v10
    v_add_f32 v3, v3, v11
    v_mfma_f32_16x16x32_bf16 v[188:191], a[208:211], a[140:143], v[188:191]
    ds_read_b128 v[116:119], v144 offset:2048
    v_fmac_f32 v0, s66, v4
    v_fmac_f32 v1, s66, v5
    v_mfma_f32_16x16x32_bf16 v[192:195], a[212:215], a[136:139], v[192:195]
    s_waitcnt lgkmcnt(2)
    s_barrier
    ds_read_b64_tr_b16 a[200:201], v236 offset:16384
    ds_read_b64_tr_b16 a[202:203], v236 offset:18432
    v_fmac_f32 v2, s66, v6
    v_fmac_f32 v3, s66, v7
    s_add_u32 m0, s43, 0
    s_mov_b32 s54, 442368
    buffer_load_dwordx4 v148, s[36:39], s54 offen offset:0 lds
    v_mfma_f32_16x16x32_bf16 v[196:199], a[212:215], a[140:143], v[196:199]
    ds_read_b64_tr_b16 a[204:205], v237 offset:16384
    ds_read_b128 v[120:123], v144 offset:4096
    v_add_f32 v16, v16, v20
    v_add_f32 v24, v24, v28
    v_mfma_f32_16x16x32_bf16 v[200:203], a[216:219], a[136:139], v[200:203]
    ds_read_b64_tr_b16 a[206:207], v237 offset:18432
    ds_read_b128 v[124:127], v144 offset:6144
    v_add_f32 v17, v17, v21
    v_add_f32 v25, v25, v29
    buffer_load_dwordx4 v149, s[36:39], s54 offen offset:1024 lds
    v_mfma_f32_16x16x32_bf16 v[204:207], a[216:219], a[140:143], v[204:207]
    ds_read_b64_tr_b16 a[208:209], v238 offset:16384
    ds_read_b128 v[72:75], v144 offset:1024
    v_add_f32 v18, v18, v22
    v_add_f32 v26, v26, v30
    v_mfma_f32_16x16x32_bf16 v[208:211], a[220:223], a[136:139], v[208:211]
    ds_read_b64_tr_b16 a[210:211], v238 offset:18432
    ds_read_b128 v[76:79], v144 offset:3072
    v_add_f32 v19, v19, v23
    v_add_f32 v27, v27, v31
    s_add_u32 m0, s43, 0
    s_mov_b32 s54, 442368
    buffer_load_dwordx4 v150, s[36:39], s54 offen offset:2048 lds
    v_mfma_f32_16x16x32_bf16 v[212:215], a[220:223], a[140:143], v[212:215]
    ds_read_b64_tr_b16 a[212:213], v239 offset:16384
    ds_read_b128 v[80:83], v144 offset:5120
    v_lshlrev_b32 v20, 16, v102
    v_and_b32 v21, 0xffff0000, v102
    v_mfma_f32_16x16x32_bf16 v[216:219], a[192:195], a[136:139], v[216:219]
    ds_read_b64_tr_b16 a[214:215], v239 offset:18432
    ds_read_b128 v[84:87], v144 offset:7168
    v_lshlrev_b32 v22, 16, v103
    v_and_b32 v23, 0xffff0000, v103
    buffer_load_dwordx4 v151, s[36:39], s54 offen offset:3072 lds
    v_mfma_f32_16x16x32_bf16 v[220:223], a[192:195], a[140:143], v[220:223]
    ds_read_b64_tr_b16 a[216:217], v236 offset:17408
    v_add_f32 v16, v16, v24
    v_add_f32 v17, v17, v25
    v_mfma_f32_16x16x32_bf16 v[224:227], a[196:199], a[136:139], v[224:227]
    ds_read_b64_tr_b16 a[218:219], v236 offset:19456
    v_add_f32 v18, v18, v26
    v_add_f32 v19, v19, v27
    v_mfma_f32_16x16x32_bf16 v[228:231], a[196:199], a[140:143], v[228:231]
    ds_read_b64_tr_b16 a[220:221], v237 offset:17408
    v_fmac_f32 v16, s66, v20
    v_fmac_f32 v17, s66, v21
    s_waitcnt vmcnt(22) lgkmcnt(12)
    v_mfma_f32_16x16x32_bf16 v[160:163], a[200:203], a[144:147], v[160:163]
    ds_read_b64_tr_b16 a[222:223], v237 offset:19456
    v_fmac_f32 v18, s66, v22
    v_fmac_f32 v19, s66, v23
    s_mov_b32 s55, 2490368
    buffer_load_dwordx4 a[136:139], v158, s[32:35], s55 offen sc1
    v_mfma_f32_16x16x32_bf16 v[164:167], a[200:203], a[148:151], v[164:167]
    ds_read_b64_tr_b16 a[192:193], v238 offset:17408
    v_cvt_pk_bf16_f32 v8, v0, v1
    v_cvt_pk_bf16_f32 v10, v16, v17
    v_mfma_f32_16x16x32_bf16 v[168:171], a[204:207], a[144:147], v[168:171]
    ds_read_b64_tr_b16 a[194:195], v238 offset:19456
    v_cvt_pk_bf16_f32 v9, v2, v3
    v_cvt_pk_bf16_f32 v11, v18, v19
    v_mfma_f32_16x16x32_bf16 v[172:175], a[204:207], a[148:151], v[172:175]
    ds_read_b64_tr_b16 a[196:197], v239 offset:17408
    v_permlane16_swap_b32 v8, v10
    v_permlane16_swap_b32 v9, v11
    s_waitcnt lgkmcnt(8)
    v_mfma_f32_16x16x32_bf16 v[176:179], a[208:211], a[144:147], v[176:179]
    ds_read_b64_tr_b16 a[198:199], v239 offset:19456
    buffer_store_dwordx4 v[8:11], v145, s[32:35], 0 offen sc1
    v_add_f32 v32, v32, v36
    v_mfma_f32_16x16x32_bf16 v[180:183], a[208:211], a[148:151], v[180:183]
    ds_read_b64_tr_b16 a[200:201], v156 offset:12288
    v_add_f32 v40, v40, v44
    v_add_f32 v33, v33, v37
    v_mfma_f32_16x16x32_bf16 v[184:187], a[212:215], a[144:147], v[184:187]
    ds_read_b64_tr_b16 a[202:203], v156 offset:12544
    v_add_f32 v41, v41, v45
    v_add_f32 v34, v34, v38
    buffer_load_dwordx4 a[140:143], v159, s[32:35], s55 offen sc1
    v_mfma_f32_16x16x32_bf16 v[188:191], a[212:215], a[148:151], v[188:191]
    ds_read_b64_tr_b16 a[204:205], v236 offset:24576
    v_add_f32 v42, v42, v46
    v_add_f32 v35, v35, v39
    s_waitcnt lgkmcnt(7)
    v_mfma_f32_16x16x32_bf16 v[192:195], a[216:219], a[144:147], v[192:195]
    ds_read_b64_tr_b16 a[206:207], v236 offset:26624
    v_add_f32 v43, v43, v47
    v_lshlrev_b32 v36, 16, v104
    v_mfma_f32_16x16x32_bf16 v[196:199], a[216:219], a[148:151], v[196:199]
    ds_read_b64_tr_b16 a[208:209], v237 offset:24576
    v_and_b32 v37, 0xffff0000, v104
    v_lshlrev_b32 v38, 16, v105
    v_mfma_f32_16x16x32_bf16 v[200:203], a[220:223], a[144:147], v[200:203]
    ds_read_b64_tr_b16 a[210:211], v237 offset:26624
    v_and_b32 v39, 0xffff0000, v105
    v_add_f32 v32, v32, v40
    s_add_u32 m0, s43, 16384
    s_mov_b32 s54, 663552
    buffer_load_dwordx4 v148, s[36:39], s54 offen offset:0 lds
    v_mfma_f32_16x16x32_bf16 v[204:207], a[220:223], a[148:151], v[204:207]
    ds_read_b64_tr_b16 a[212:213], v238 offset:24576
    v_add_f32 v33, v33, v41
    v_add_f32 v34, v34, v42
    s_waitcnt lgkmcnt(7)
    v_mfma_f32_16x16x32_bf16 v[208:211], a[192:195], a[144:147], v[208:211]
    ds_read_b64_tr_b16 a[214:215], v238 offset:26624
    v_add_f32 v35, v35, v43
    v_fmac_f32 v32, s67, v36
    buffer_load_dwordx4 v149, s[36:39], s54 offen offset:1024 lds
    v_mfma_f32_16x16x32_bf16 v[212:215], a[192:195], a[148:151], v[212:215]
    ds_read_b64_tr_b16 a[216:217], v239 offset:24576
    v_fmac_f32 v33, s67, v37
    v_fmac_f32 v34, s67, v38
    v_mfma_f32_16x16x32_bf16 v[216:219], a[196:199], a[144:147], v[216:219]
    ds_read_b64_tr_b16 a[218:219], v239 offset:26624
    v_fmac_f32 v35, s67, v39
    v_add_f32 v48, v48, v52
    s_add_u32 m0, s43, 16384
    s_mov_b32 s54, 663552
    buffer_load_dwordx4 v150, s[36:39], s54 offen offset:2048 lds
    v_mfma_f32_16x16x32_bf16 v[220:223], a[196:199], a[148:151], v[220:223]
    ds_read_b64_tr_b16 a[220:221], v236 offset:25600
    v_add_f32 v56, v56, v60
    v_add_f32 v49, v49, v53
    s_waitcnt lgkmcnt(7)
    v_mfma_f32_16x16x32_bf16 v[224:227], a[200:203], a[144:147], v[224:227]
    ds_read_b64_tr_b16 a[222:223], v236 offset:27648
    v_add_f32 v57, v57, v61
    v_add_f32 v50, v50, v54
    buffer_load_dwordx4 v151, s[36:39], s54 offen offset:3072 lds
    v_mfma_f32_16x16x32_bf16 v[228:231], a[200:203], a[148:151], v[228:231]
    ds_read_b64_tr_b16 a[192:193], v237 offset:25600
    v_add_f32 v58, v58, v62
    v_add_f32 v51, v51, v55
    s_waitcnt vmcnt(22)
    v_mfma_f32_16x16x32_bf16 v[160:163], a[204:207], a[152:155], v[160:163]
    ds_read_b64_tr_b16 a[194:195], v237 offset:27648
    v_add_f32 v59, v59, v63
    v_lshlrev_b32 v52, 16, v106
    s_mov_b32 s55, 2883584
    buffer_load_dwordx4 a[144:147], v158, s[32:35], s55 offen sc1
    v_mfma_f32_16x16x32_bf16 v[164:167], a[204:207], a[156:159], v[164:167]
    ds_read_b64_tr_b16 a[196:197], v238 offset:25600
    v_and_b32 v53, 0xffff0000, v106
    v_lshlrev_b32 v54, 16, v107
    s_waitcnt lgkmcnt(7)
    v_mfma_f32_16x16x32_bf16 v[168:171], a[208:211], a[152:155], v[168:171]
    ds_read_b64_tr_b16 a[198:199], v238 offset:27648
    v_and_b32 v55, 0xffff0000, v107
    v_add_f32 v48, v48, v56
    v_mfma_f32_16x16x32_bf16 v[172:175], a[208:211], a[156:159], v[172:175]
    ds_read_b64_tr_b16 a[200:201], v239 offset:25600
    v_add_f32 v49, v49, v57
    v_add_f32 v50, v50, v58
    v_mfma_f32_16x16x32_bf16 v[176:179], a[212:215], a[152:155], v[176:179]
    ds_read_b64_tr_b16 a[202:203], v239 offset:27648
    v_add_f32 v51, v51, v59
    v_fmac_f32 v48, s67, v52
    buffer_load_dwordx4 a[148:151], v159, s[32:35], s55 offen sc1
    v_mfma_f32_16x16x32_bf16 v[180:183], a[212:215], a[156:159], v[180:183]
    ds_read_b64_tr_b16 a[204:205], v156 offset:13312
    v_fmac_f32 v49, s67, v53
    v_fmac_f32 v50, s67, v54
    s_waitcnt lgkmcnt(7)
    v_mfma_f32_16x16x32_bf16 v[184:187], a[216:219], a[152:155], v[184:187]
    ds_read_b64_tr_b16 a[206:207], v156 offset:13568
    v_fmac_f32 v51, s67, v55
    v_cvt_pk_bf16_f32 v40, v32, v33
    v_mfma_f32_16x16x32_bf16 v[188:191], a[216:219], a[156:159], v[188:191]
    ds_read_b64_tr_b16 a[208:209], v236 offset:32768
    v_cvt_pk_bf16_f32 v42, v48, v49
    v_cvt_pk_bf16_f32 v41, v34, v35
    v_mfma_f32_16x16x32_bf16 v[192:195], a[220:223], a[152:155], v[192:195]
    ds_read_b64_tr_b16 a[210:211], v236 offset:34816
    v_cvt_pk_bf16_f32 v43, v50, v51
    v_permlane16_swap_b32 v40, v42
    s_add_u32 m0, s43, 32768
    s_mov_b32 s54, 811008
    buffer_load_dwordx4 v148, s[36:39], s54 offen offset:0 lds
    v_mfma_f32_16x16x32_bf16 v[196:199], a[220:223], a[156:159], v[196:199]
    ds_read_b64_tr_b16 a[212:213], v237 offset:32768
    v_permlane16_swap_b32 v41, v43
    buffer_store_dwordx4 v[40:43], v145, s[32:35], s27 offen sc1
    s_waitcnt lgkmcnt(7)
    v_mfma_f32_16x16x32_bf16 v[200:203], a[192:195], a[152:155], v[200:203]
    ds_read_b64_tr_b16 a[214:215], v237 offset:34816
    v_add_f32 v112, v112, v116
    v_add_f32 v120, v120, v124
    v_mfma_f32_16x16x32_bf16 v[204:207], a[192:195], a[156:159], v[204:207]
    ds_read_b64_tr_b16 a[216:217], v238 offset:32768
    v_add_f32 v113, v113, v117
    v_add_f32 v121, v121, v125
    buffer_load_dwordx4 v149, s[36:39], s54 offen offset:1024 lds
    v_mfma_f32_16x16x32_bf16 v[208:211], a[196:199], a[152:155], v[208:211]
    ds_read_b64_tr_b16 a[218:219], v238 offset:34816
    v_add_f32 v114, v114, v118
    v_add_f32 v122, v122, v126
    v_mfma_f32_16x16x32_bf16 v[212:215], a[196:199], a[156:159], v[212:215]
    ds_read_b64_tr_b16 a[220:221], v239 offset:32768
    v_add_f32 v115, v115, v119
    v_add_f32 v123, v123, v127
    s_add_u32 m0, s43, 32768
    s_mov_b32 s54, 811008
    buffer_load_dwordx4 v150, s[36:39], s54 offen offset:2048 lds
    s_waitcnt lgkmcnt(7)
    v_mfma_f32_16x16x32_bf16 v[216:219], a[200:203], a[152:155], v[216:219]
    ds_read_b64_tr_b16 a[222:223], v239 offset:34816
    v_lshlrev_b32 v116, 16, v108
    v_and_b32 v117, 0xffff0000, v108
    v_mfma_f32_16x16x32_bf16 v[220:223], a[200:203], a[156:159], v[220:223]
    ds_read_b64_tr_b16 a[192:193], v236 offset:33792
    v_lshlrev_b32 v118, 16, v109
    v_and_b32 v119, 0xffff0000, v109
    buffer_load_dwordx4 v151, s[36:39], s54 offen offset:3072 lds
    v_mfma_f32_16x16x32_bf16 v[224:227], a[204:207], a[152:155], v[224:227]
    ds_read_b64_tr_b16 a[194:195], v236 offset:35840
    v_add_f32 v112, v112, v120
    v_add_f32 v113, v113, v121
    v_mfma_f32_16x16x32_bf16 v[228:231], a[204:207], a[156:159], v[228:231]
    ds_read_b64_tr_b16 a[196:197], v237 offset:33792
    v_add_f32 v114, v114, v122
    v_add_f32 v115, v115, v123
    s_waitcnt vmcnt(26) lgkmcnt(7)
    v_mfma_f32_16x16x32_bf16 v[160:163], a[208:211], a[160:163], v[160:163]
    ds_read_b64_tr_b16 a[198:199], v237 offset:35840
    v_fmac_f32 v112, s68, v116
    v_fmac_f32 v113, s68, v117
    s_mov_b32 s55, 3014656
    buffer_load_dwordx4 a[152:155], v158, s[32:35], s55 offen sc1
    v_mfma_f32_16x16x32_bf16 v[164:167], a[208:211], a[164:167], v[164:167]
    ds_read_b64_tr_b16 a[200:201], v238 offset:33792
    v_fmac_f32 v114, s68, v118
    v_fmac_f32 v115, s68, v119
    v_mfma_f32_16x16x32_bf16 v[168:171], a[212:215], a[160:163], v[168:171]
    ds_read_b64_tr_b16 a[202:203], v238 offset:35840
    v_add_f32 v72, v72, v76
    v_add_f32 v80, v80, v84
    v_mfma_f32_16x16x32_bf16 v[172:175], a[212:215], a[164:167], v[172:175]
    ds_read_b64_tr_b16 a[204:205], v239 offset:33792
    v_add_f32 v73, v73, v77
    v_add_f32 v81, v81, v85
    s_waitcnt lgkmcnt(7)
    v_mfma_f32_16x16x32_bf16 v[176:179], a[216:219], a[160:163], v[176:179]
    ds_read_b64_tr_b16 a[206:207], v239 offset:35840
    v_add_f32 v74, v74, v78
    v_add_f32 v82, v82, v86
    buffer_load_dwordx4 a[156:159], v159, s[32:35], s55 offen sc1
    v_mfma_f32_16x16x32_bf16 v[180:183], a[216:219], a[164:167], v[180:183]
    ds_read_b64_tr_b16 a[208:209], v156 offset:16384
    v_add_f32 v75, v75, v79
    v_add_f32 v83, v83, v87
    v_mfma_f32_16x16x32_bf16 v[184:187], a[220:223], a[160:163], v[184:187]
    ds_read_b64_tr_b16 a[210:211], v156 offset:16640
    v_lshlrev_b32 v76, 16, v110
    v_and_b32 v77, 0xffff0000, v110
    v_mfma_f32_16x16x32_bf16 v[188:191], a[220:223], a[164:167], v[188:191]
    ds_read_b64_tr_b16 a[212:213], v236 offset:40960
    v_lshlrev_b32 v78, 16, v111
    v_and_b32 v79, 0xffff0000, v111
    s_waitcnt lgkmcnt(7)
    v_mfma_f32_16x16x32_bf16 v[192:195], a[192:195], a[160:163], v[192:195]
    ds_read_b64_tr_b16 a[214:215], v236 offset:43008
    v_add_f32 v72, v72, v80
    v_add_f32 v73, v73, v81
    s_add_u32 m0, s43, 49152
    s_mov_b32 s54, 958464
    buffer_load_dwordx4 v148, s[36:39], s54 offen offset:0 lds
    v_mfma_f32_16x16x32_bf16 v[196:199], a[192:195], a[164:167], v[196:199]
    ds_read_b64_tr_b16 a[216:217], v237 offset:40960
    v_add_f32 v74, v74, v82
    v_add_f32 v75, v75, v83
    v_mfma_f32_16x16x32_bf16 v[200:203], a[196:199], a[160:163], v[200:203]
    ds_read_b64_tr_b16 a[218:219], v237 offset:43008
    v_fmac_f32 v72, s68, v76
    v_fmac_f32 v73, s68, v77
    buffer_load_dwordx4 v149, s[36:39], s54 offen offset:1024 lds
    v_mfma_f32_16x16x32_bf16 v[204:207], a[196:199], a[164:167], v[204:207]
    ds_read_b64_tr_b16 a[220:221], v238 offset:40960
    v_fmac_f32 v74, s68, v78
    v_fmac_f32 v75, s68, v79
    s_waitcnt lgkmcnt(7)
    v_mfma_f32_16x16x32_bf16 v[208:211], a[200:203], a[160:163], v[208:211]
    ds_read_b64_tr_b16 a[222:223], v238 offset:43008
    v_cvt_pk_bf16_f32 v120, v112, v113
    v_cvt_pk_bf16_f32 v122, v72, v73
    s_add_u32 m0, s43, 49152
    s_mov_b32 s54, 958464
    buffer_load_dwordx4 v150, s[36:39], s54 offen offset:2048 lds
    v_mfma_f32_16x16x32_bf16 v[212:215], a[200:203], a[164:167], v[212:215]
    ds_read_b64_tr_b16 a[192:193], v239 offset:40960
    v_cvt_pk_bf16_f32 v121, v114, v115
    v_cvt_pk_bf16_f32 v123, v74, v75
    v_mfma_f32_16x16x32_bf16 v[216:219], a[204:207], a[160:163], v[216:219]
    ds_read_b64_tr_b16 a[194:195], v239 offset:43008
    v_permlane16_swap_b32 v120, v122
    v_permlane16_swap_b32 v121, v123
    buffer_load_dwordx4 v151, s[36:39], s54 offen offset:3072 lds
    v_mfma_f32_16x16x32_bf16 v[220:223], a[204:207], a[164:167], v[220:223]
    ds_read_b64_tr_b16 a[196:197], v236 offset:41984
    buffer_store_dwordx4 v[120:123], v146, s[32:35], 0 offen sc1
    s_waitcnt lgkmcnt(7)
    v_mfma_f32_16x16x32_bf16 v[224:227], a[208:211], a[160:163], v[224:227]
    ds_read_b64_tr_b16 a[198:199], v236 offset:44032
    v_mfma_f32_16x16x32_bf16 v[228:231], a[208:211], a[164:167], v[228:231]
    ds_read_b64_tr_b16 a[200:201], v237 offset:41984
    v_lshrrev_b32 v26, 4, v232
    s_lshl_b32 s60, s70, 2
    s_and_b32 s63, s2, 3
    s_waitcnt vmcnt(31)
    v_mfma_f32_16x16x32_bf16 v[160:163], a[212:215], a[168:171], v[160:163]
    ds_read_b64_tr_b16 a[202:203], v237 offset:44032
    s_add_u32 s63, s63, s60
    s_lshl_b32 s63, s63, 7
    s_add_u32 s63, s63, 25329664
    s_cmp_eq_u32 s40, 0
    s_cselect_b32 s63, s63, 2130706432
    s_mov_b32 s55, 3407872
    buffer_load_dwordx4 a[160:163], v158, s[32:35], s55 offen sc1
    v_mfma_f32_16x16x32_bf16 v[164:167], a[212:215], a[172:175], v[164:167]
    ds_read_b64_tr_b16 a[204:205], v238 offset:41984
    v_mov_b32 v19, 2130706432
    v_mov_b32 v27, s63
    s_waitcnt lgkmcnt(7)
    v_mfma_f32_16x16x32_bf16 v[168:171], a[216:219], a[168:171], v[168:171]
    ds_read_b64_tr_b16 a[206:207], v238 offset:44032
    v_cmp_eq_u32 vcc, 0, v26
    v_mov_b32 v20, 1
    v_and_b32 v28, 3, v26
    v_cndmask_b32 v19, v19, v27, vcc
    v_mfma_f32_16x16x32_bf16 v[172:175], a[216:219], a[172:175], v[172:175]
    ds_read_b64_tr_b16 a[208:209], v239 offset:41984
    s_lshl_b32 s60, s60, 7
    s_add_u32 s60, s60, 25329664
    v_lshl_add_u32 v18, v28, 7, s60
    v_mfma_f32_16x16x32_bf16 v[176:179], a[220:223], a[168:171], v[176:179]
    ds_read_b64_tr_b16 a[210:211], v239 offset:44032
    buffer_load_dwordx4 a[164:167], v159, s[32:35], s55 offen sc1
    v_mfma_f32_16x16x32_bf16 v[180:183], a[220:223], a[172:175], v[180:183]
    ds_read_b64_tr_b16 a[212:213], v156 offset:17408
    s_waitcnt lgkmcnt(7)
    v_mfma_f32_16x16x32_bf16 v[184:187], a[192:195], a[168:171], v[184:187]
    ds_read_b64_tr_b16 a[214:215], v156 offset:17664
    v_mfma_f32_16x16x32_bf16 v[188:191], a[192:195], a[172:175], v[188:191]
    v_mfma_f32_16x16x32_bf16 v[192:195], a[196:199], a[168:171], v[192:195]
    s_waitcnt vmcnt(16)
    s_barrier
    ds_read_b64_tr_b16 a[216:217], v152 offset:0
    ds_read_b64_tr_b16 a[218:219], v152 offset:2048
    s_add_u32 m0, s43, 65536
    s_mov_b32 s54, 1105920
    buffer_load_dwordx4 v148, s[36:39], s54 offen offset:0 lds
    v_mfma_f32_16x16x32_bf16 v[196:199], a[196:199], a[172:175], v[196:199]
    ds_read_b64_tr_b16 a[220:221], v153 offset:0
    s_waitcnt lgkmcnt(7)
    v_mfma_f32_16x16x32_bf16 v[200:203], a[200:203], a[168:171], v[200:203]
    ds_read_b64_tr_b16 a[222:223], v153 offset:2048
    buffer_load_dwordx4 v149, s[36:39], s54 offen offset:1024 lds
    v_mfma_f32_16x16x32_bf16 v[204:207], a[200:203], a[172:175], v[204:207]
    ds_read_b64_tr_b16 a[192:193], v154 offset:0
    v_mfma_f32_16x16x32_bf16 v[208:211], a[204:207], a[168:171], v[208:211]
    ds_read_b64_tr_b16 a[194:195], v154 offset:2048
    s_add_u32 m0, s43, 65536
    s_mov_b32 s54, 1105920
    buffer_load_dwordx4 v150, s[36:39], s54 offen offset:2048 lds
    v_mfma_f32_16x16x32_bf16 v[212:215], a[204:207], a[172:175], v[212:215]
    ds_read_b64_tr_b16 a[196:197], v155 offset:0
    s_waitcnt lgkmcnt(7)
    v_mfma_f32_16x16x32_bf16 v[216:219], a[208:211], a[168:171], v[216:219]
    ds_read_b64_tr_b16 a[198:199], v155 offset:2048
    buffer_load_dwordx4 v151, s[36:39], s54 offen offset:3072 lds
    v_mfma_f32_16x16x32_bf16 v[220:223], a[208:211], a[172:175], v[220:223]
    ds_read_b64_tr_b16 a[200:201], v152 offset:1024
    v_mfma_f32_16x16x32_bf16 v[224:227], a[212:215], a[168:171], v[224:227]
    ds_read_b64_tr_b16 a[202:203], v152 offset:3072
    buffer_load_dword v147, v157, s[32:35], 0 offen sc1
    v_mfma_f32_16x16x32_bf16 v[228:231], a[212:215], a[172:175], v[228:231]
    ds_read_b64_tr_b16 a[204:205], v153 offset:1024
    s_waitcnt lgkmcnt(7)
    v_mfma_f32_16x16x32_bf16 v[160:163], a[216:219], a[176:179], v[160:163]
    ds_read_b64_tr_b16 a[206:207], v153 offset:3072
    s_mov_b32 s55, 3538944
    buffer_load_dwordx4 a[168:171], v158, s[32:35], s55 offen sc1
    v_mfma_f32_16x16x32_bf16 v[164:167], a[216:219], a[180:183], v[164:167]
    ds_read_b64_tr_b16 a[208:209], v154 offset:1024
    v_mfma_f32_16x16x32_bf16 v[168:171], a[220:223], a[176:179], v[168:171]
    ds_read_b64_tr_b16 a[210:211], v154 offset:3072
    v_mfma_f32_16x16x32_bf16 v[172:175], a[220:223], a[180:183], v[172:175]
    ds_read_b64_tr_b16 a[212:213], v155 offset:1024
    s_waitcnt lgkmcnt(7)
    v_mfma_f32_16x16x32_bf16 v[176:179], a[192:195], a[176:179], v[176:179]
    ds_read_b64_tr_b16 a[214:215], v155 offset:3072
    buffer_load_dwordx4 a[172:175], v159, s[32:35], s55 offen sc1
    v_mfma_f32_16x16x32_bf16 v[180:183], a[192:195], a[180:183], v[180:183]
    ds_read_b64_tr_b16 a[216:217], v156 offset:20480
    v_mfma_f32_16x16x32_bf16 v[184:187], a[196:199], a[176:179], v[184:187]
    ds_read_b64_tr_b16 a[218:219], v156 offset:20736
    v_mfma_f32_16x16x32_bf16 v[188:191], a[196:199], a[180:183], v[188:191]
    ds_read_b64_tr_b16 a[220:221], v152 offset:8192
    s_waitcnt lgkmcnt(7)
    v_mfma_f32_16x16x32_bf16 v[192:195], a[200:203], a[176:179], v[192:195]
    ds_read_b64_tr_b16 a[222:223], v152 offset:10240
    s_add_u32 m0, s43, 81920
    s_mov_b32 s54, 73728
    buffer_load_dwordx4 v148, s[36:39], s54 offen offset:0 lds
    v_mfma_f32_16x16x32_bf16 v[196:199], a[200:203], a[180:183], v[196:199]
    ds_read_b64_tr_b16 a[192:193], v153 offset:8192
    v_mfma_f32_16x16x32_bf16 v[200:203], a[204:207], a[176:179], v[200:203]
    ds_read_b64_tr_b16 a[194:195], v153 offset:10240
    buffer_load_dwordx4 v149, s[36:39], s54 offen offset:1024 lds
    v_mfma_f32_16x16x32_bf16 v[204:207], a[204:207], a[180:183], v[204:207]
    ds_read_b64_tr_b16 a[196:197], v154 offset:8192
    s_waitcnt lgkmcnt(7)
    v_mfma_f32_16x16x32_bf16 v[208:211], a[208:211], a[176:179], v[208:211]
    ds_read_b64_tr_b16 a[198:199], v154 offset:10240
    s_add_u32 m0, s43, 81920
    s_mov_b32 s54, 73728
    buffer_load_dwordx4 v150, s[36:39], s54 offen offset:2048 lds
    v_mfma_f32_16x16x32_bf16 v[212:215], a[208:211], a[180:183], v[212:215]
    ds_read_b64_tr_b16 a[200:201], v155 offset:8192
    v_mfma_f32_16x16x32_bf16 v[216:219], a[212:215], a[176:179], v[216:219]
    ds_read_b64_tr_b16 a[202:203], v155 offset:10240
    buffer_load_dwordx4 v151, s[36:39], s54 offen offset:3072 lds
    v_mfma_f32_16x16x32_bf16 v[220:223], a[212:215], a[180:183], v[220:223]
    ds_read_b64_tr_b16 a[204:205], v152 offset:9216
    s_waitcnt lgkmcnt(7)
    v_mfma_f32_16x16x32_bf16 v[224:227], a[216:219], a[176:179], v[224:227]
    ds_read_b64_tr_b16 a[206:207], v152 offset:11264
    v_mfma_f32_16x16x32_bf16 v[228:231], a[216:219], a[180:183], v[228:231]
    ds_read_b64_tr_b16 a[208:209], v153 offset:9216
    v_mfma_f32_16x16x32_bf16 v[160:163], a[220:223], a[184:187], v[160:163]
    ds_read_b64_tr_b16 a[210:211], v153 offset:11264
    s_mov_b32 s55, 3932160
    buffer_load_dwordx4 a[176:179], v158, s[32:35], s55 offen sc1
    v_mfma_f32_16x16x32_bf16 v[164:167], a[220:223], a[188:191], v[164:167]
    ds_read_b64_tr_b16 a[212:213], v154 offset:9216
    s_waitcnt lgkmcnt(7)
    v_mfma_f32_16x16x32_bf16 v[168:171], a[192:195], a[184:187], v[168:171]
    ds_read_b64_tr_b16 a[214:215], v154 offset:11264
    v_mfma_f32_16x16x32_bf16 v[172:175], a[192:195], a[188:191], v[172:175]
    ds_read_b64_tr_b16 a[216:217], v155 offset:9216
    v_mfma_f32_16x16x32_bf16 v[176:179], a[196:199], a[184:187], v[176:179]
    ds_read_b64_tr_b16 a[218:219], v155 offset:11264
    buffer_load_dwordx4 a[180:183], v159, s[32:35], s55 offen sc1
    v_mfma_f32_16x16x32_bf16 v[180:183], a[196:199], a[188:191], v[180:183]
    ds_read_b64_tr_b16 a[220:221], v156 offset:21504
    s_waitcnt lgkmcnt(7)
    v_mfma_f32_16x16x32_bf16 v[184:187], a[200:203], a[184:187], v[184:187]
    ds_read_b64_tr_b16 a[222:223], v156 offset:21760
    v_mfma_f32_16x16x32_bf16 v[188:191], a[200:203], a[188:191], v[188:191]
    ds_read_b64_tr_b16 a[192:193], v152 offset:16384
    v_mfma_f32_16x16x32_bf16 v[192:195], a[204:207], a[184:187], v[192:195]
    ds_read_b64_tr_b16 a[194:195], v152 offset:18432
    v_mfma_f32_16x16x32_bf16 v[196:199], a[204:207], a[188:191], v[196:199]
    ds_read_b64_tr_b16 a[196:197], v153 offset:16384
    s_waitcnt lgkmcnt(7)
    v_mfma_f32_16x16x32_bf16 v[200:203], a[208:211], a[184:187], v[200:203]
    ds_read_b64_tr_b16 a[198:199], v153 offset:18432
    v_mfma_f32_16x16x32_bf16 v[204:207], a[208:211], a[188:191], v[204:207]
    ds_read_b64_tr_b16 a[200:201], v154 offset:16384
    v_mfma_f32_16x16x32_bf16 v[208:211], a[212:215], a[184:187], v[208:211]
    ds_read_b64_tr_b16 a[202:203], v154 offset:18432
    v_mfma_f32_16x16x32_bf16 v[212:215], a[212:215], a[188:191], v[212:215]
    ds_read_b64_tr_b16 a[204:205], v155 offset:16384
    s_waitcnt lgkmcnt(7)
    v_mfma_f32_16x16x32_bf16 v[216:219], a[216:219], a[184:187], v[216:219]
    ds_read_b64_tr_b16 a[206:207], v155 offset:18432
    v_mfma_f32_16x16x32_bf16 v[220:223], a[216:219], a[188:191], v[220:223]
    ds_read_b64_tr_b16 a[208:209], v152 offset:17408
    v_mfma_f32_16x16x32_bf16 v[224:227], a[220:223], a[184:187], v[224:227]
    ds_read_b64_tr_b16 a[210:211], v152 offset:19456
    v_mfma_f32_16x16x32_bf16 v[228:231], a[220:223], a[188:191], v[228:231]
    ds_read_b64_tr_b16 a[212:213], v153 offset:17408
    s_waitcnt lgkmcnt(7)
    v_mfma_f32_16x16x32_bf16 v[160:163], a[192:195], a[128:131], v[160:163]
    ds_read_b64_tr_b16 a[214:215], v153 offset:19456
    s_mov_b32 s55, 4063232
    buffer_load_dwordx4 a[184:187], v158, s[32:35], s55 offen sc1
    v_mfma_f32_16x16x32_bf16 v[164:167], a[192:195], a[132:135], v[164:167]
    ds_read_b64_tr_b16 a[216:217], v154 offset:17408
    v_mfma_f32_16x16x32_bf16 v[168:171], a[196:199], a[128:131], v[168:171]
    ds_read_b64_tr_b16 a[218:219], v154 offset:19456
    v_mfma_f32_16x16x32_bf16 v[172:175], a[196:199], a[132:135], v[172:175]
    ds_read_b64_tr_b16 a[220:221], v155 offset:17408
    s_waitcnt lgkmcnt(7)
    v_mfma_f32_16x16x32_bf16 v[176:179], a[200:203], a[128:131], v[176:179]
    ds_read_b64_tr_b16 a[222:223], v155 offset:19456
    buffer_load_dwordx4 a[188:191], v159, s[32:35], s55 offen sc1
    v_mfma_f32_16x16x32_bf16 v[180:183], a[200:203], a[132:135], v[180:183]
    ds_read_b64_tr_b16 a[192:193], v156 offset:26624
    v_mfma_f32_16x16x32_bf16 v[184:187], a[204:207], a[128:131], v[184:187]
    ds_read_b64_tr_b16 a[194:195], v156 offset:26880
    v_mfma_f32_16x16x32_bf16 v[188:191], a[204:207], a[132:135], v[188:191]
    ds_read_b64_tr_b16 a[196:197], v152 offset:24576
    s_waitcnt lgkmcnt(7)
    v_mfma_f32_16x16x32_bf16 v[192:195], a[208:211], a[128:131], v[192:195]
    ds_read_b64_tr_b16 a[198:199], v152 offset:26624
    v_mfma_f32_16x16x32_bf16 v[196:199], a[208:211], a[132:135], v[196:199]
    ds_read_b64_tr_b16 a[200:201], v153 offset:24576
    v_mfma_f32_16x16x32_bf16 v[200:203], a[212:215], a[128:131], v[200:203]
    ds_read_b64_tr_b16 a[202:203], v153 offset:26624
    v_mfma_f32_16x16x32_bf16 v[204:207], a[212:215], a[132:135], v[204:207]
    ds_read_b64_tr_b16 a[204:205], v154 offset:24576
    s_waitcnt lgkmcnt(7)
    v_mfma_f32_16x16x32_bf16 v[208:211], a[216:219], a[128:131], v[208:211]
    ds_read_b64_tr_b16 a[206:207], v154 offset:26624
    v_mfma_f32_16x16x32_bf16 v[212:215], a[216:219], a[132:135], v[212:215]
    ds_read_b64_tr_b16 a[208:209], v155 offset:24576
    v_mfma_f32_16x16x32_bf16 v[216:219], a[220:223], a[128:131], v[216:219]
    ds_read_b64_tr_b16 a[210:211], v155 offset:26624
    v_mfma_f32_16x16x32_bf16 v[220:223], a[220:223], a[132:135], v[220:223]
    ds_read_b64_tr_b16 a[212:213], v152 offset:25600
    s_waitcnt lgkmcnt(7)
    v_mfma_f32_16x16x32_bf16 v[224:227], a[192:195], a[128:131], v[224:227]
    ds_read_b64_tr_b16 a[214:215], v152 offset:27648
    v_mfma_f32_16x16x32_bf16 v[228:231], a[192:195], a[132:135], v[228:231]
    s_waitcnt vmcnt(10)
    v_cmp_gt_u32 vcc, 2, v147
    s_nop 0
    s_cbranch_vccnz mk_SL_H2
mk_BK_H2:
    ds_read_b64_tr_b16 a[216:217], v153 offset:25600
    v_mfma_f32_16x16x32_bf16 v[160:163], a[196:199], a[136:139], v[160:163]
    ds_read_b64_tr_b16 a[218:219], v153 offset:27648
    s_mov_b32 s55, 262144
    buffer_load_dwordx4 a[128:131], v158, s[32:35], s55 offen sc1
    v_mfma_f32_16x16x32_bf16 v[164:167], a[196:199], a[140:143], v[164:167]
    ds_read_b64_tr_b16 a[220:221], v154 offset:25600
    s_waitcnt lgkmcnt(7)
    v_mfma_f32_16x16x32_bf16 v[168:171], a[200:203], a[136:139], v[168:171]
    ds_read_b64_tr_b16 a[222:223], v154 offset:27648
    v_mfma_f32_16x16x32_bf16 v[172:175], a[200:203], a[140:143], v[172:175]
    ds_read_b64_tr_b16 a[192:193], v155 offset:25600
    v_mfma_f32_16x16x32_bf16 v[176:179], a[204:207], a[136:139], v[176:179]
    ds_read_b64_tr_b16 a[194:195], v155 offset:27648
    buffer_load_dwordx4 a[132:135], v159, s[32:35], s55 offen sc1
    v_mfma_f32_16x16x32_bf16 v[180:183], a[204:207], a[140:143], v[180:183]
    ds_read_b64_tr_b16 a[196:197], v156 offset:27648
    s_waitcnt lgkmcnt(7)
    v_mfma_f32_16x16x32_bf16 v[184:187], a[208:211], a[136:139], v[184:187]
    ds_read_b64_tr_b16 a[198:199], v156 offset:27904
    v_mfma_f32_16x16x32_bf16 v[188:191], a[208:211], a[140:143], v[188:191]
    v_mfma_f32_16x16x32_bf16 v[192:195], a[212:215], a[136:139], v[192:195]
    s_barrier
    buffer_atomic_add v20, v19, s[32:35], 0 offen sc1
    ds_read_b64_tr_b16 a[200:201], v152 offset:32768
    ds_read_b64_tr_b16 a[202:203], v152 offset:34816
    s_add_u32 m0, s43, 98304
    s_mov_b32 s54, 221184
    buffer_load_dwordx4 v148, s[36:39], s54 offen offset:0 lds
    v_mfma_f32_16x16x32_bf16 v[196:199], a[212:215], a[140:143], v[196:199]
    ds_read_b64_tr_b16 a[204:205], v153 offset:32768
    s_waitcnt lgkmcnt(7)
    v_mfma_f32_16x16x32_bf16 v[200:203], a[216:219], a[136:139], v[200:203]
    ds_read_b64_tr_b16 a[206:207], v153 offset:34816
    v_mfma_f32_16x16x32_bf16 v[204:207], a[216:219], a[140:143], v[204:207]
    ds_read_b64_tr_b16 a[208:209], v154 offset:32768
    v_mfma_f32_16x16x32_bf16 v[208:211], a[220:223], a[136:139], v[208:211]
    ds_read_b64_tr_b16 a[210:211], v154 offset:34816
    buffer_load_dwordx4 v149, s[36:39], s54 offen offset:1024 lds
    v_mfma_f32_16x16x32_bf16 v[212:215], a[220:223], a[140:143], v[212:215]
    ds_read_b64_tr_b16 a[212:213], v155 offset:32768
    s_waitcnt lgkmcnt(7)
    v_mfma_f32_16x16x32_bf16 v[216:219], a[192:195], a[136:139], v[216:219]
    ds_read_b64_tr_b16 a[214:215], v155 offset:34816
    v_mfma_f32_16x16x32_bf16 v[220:223], a[192:195], a[140:143], v[220:223]
    ds_read_b64_tr_b16 a[216:217], v152 offset:33792
    v_mfma_f32_16x16x32_bf16 v[224:227], a[196:199], a[136:139], v[224:227]
    ds_read_b64_tr_b16 a[218:219], v152 offset:35840
    v_mfma_f32_16x16x32_bf16 v[228:231], a[196:199], a[140:143], v[228:231]
    ds_read_b64_tr_b16 a[220:221], v153 offset:33792
    s_waitcnt lgkmcnt(7)
    v_mfma_f32_16x16x32_bf16 v[160:163], a[200:203], a[144:147], v[160:163]
    ds_read_b64_tr_b16 a[222:223], v153 offset:35840
    s_mov_b32 s55, 393216
    buffer_load_dwordx4 a[136:139], v158, s[32:35], s55 offen sc1
    v_mfma_f32_16x16x32_bf16 v[164:167], a[200:203], a[148:151], v[164:167]
    ds_read_b64_tr_b16 a[192:193], v154 offset:33792
    s_lshr_b32 s61, s69, 1
    s_and_b32 s62, s69, 1
    v_mfma_f32_16x16x32_bf16 v[168:171], a[204:207], a[144:147], v[168:171]
    ds_read_b64_tr_b16 a[194:195], v154 offset:35840
    s_lshl_b32 s60, s71, 5
    s_lshl_b32 s63, s61, 4
    v_mfma_f32_16x16x32_bf16 v[172:175], a[204:207], a[148:151], v[172:175]
    ds_read_b64_tr_b16 a[196:197], v155 offset:33792
    s_add_u32 s4, s60, s63
    s_lshl_b32 s60, s70, 7
    s_waitcnt lgkmcnt(7)
    v_mfma_f32_16x16x32_bf16 v[176:179], a[208:211], a[144:147], v[176:179]
    ds_read_b64_tr_b16 a[198:199], v155 offset:35840
    buffer_load_dwordx4 a[140:143], v159, s[32:35], s55 offen sc1
    v_mfma_f32_16x16x32_bf16 v[180:183], a[208:211], a[148:151], v[180:183]
    ds_read_b64_tr_b16 a[200:201], v156 offset:30720
    s_lshl_b32 s63, s62, 6
    s_add_u32 s5, s60, s63
    v_mfma_f32_16x16x32_bf16 v[184:187], a[212:215], a[144:147], v[184:187]
    ds_read_b64_tr_b16 a[202:203], v156 offset:30976
    s_lshl_b32 s6, s70, 4
    s_add_u32 s6, s6, 512
    v_mfma_f32_16x16x32_bf16 v[188:191], a[212:215], a[148:151], v[188:191]
    ds_read_b64_tr_b16 a[204:205], v152 offset:40960
    v_and_b32 v27, 15, v26
    s_waitcnt lgkmcnt(7)
    v_mfma_f32_16x16x32_bf16 v[192:195], a[216:219], a[144:147], v[192:195]
    ds_read_b64_tr_b16 a[206:207], v152 offset:43008
    s_add_u32 m0, s43, 98304
    s_mov_b32 s54, 221184
    buffer_load_dwordx4 v150, s[36:39], s54 offen offset:2048 lds
    v_mfma_f32_16x16x32_bf16 v[196:199], a[216:219], a[148:151], v[196:199]
    ds_read_b64_tr_b16 a[208:209], v153 offset:40960
    s_lshl_b32 s60, s4, 2
    s_add_u32 s60, s60, 24641536
    v_mfma_f32_16x16x32_bf16 v[200:203], a[220:223], a[144:147], v[200:203]
    ds_read_b64_tr_b16 a[210:211], v153 offset:43008
    v_lshl_add_u32 v10, v27, 2, s60
    v_mfma_f32_16x16x32_bf16 v[204:207], a[220:223], a[148:151], v[204:207]
    ds_read_b64_tr_b16 a[212:213], v154 offset:40960
    v_xor_b32 v11, 64, v10
    s_waitcnt lgkmcnt(7)
    v_mfma_f32_16x16x32_bf16 v[208:211], a[192:195], a[144:147], v[208:211]
    ds_read_b64_tr_b16 a[214:215], v154 offset:43008
    buffer_load_dwordx4 v151, s[36:39], s54 offen offset:3072 lds
    v_mfma_f32_16x16x32_bf16 v[212:215], a[192:195], a[148:151], v[212:215]
    ds_read_b64_tr_b16 a[216:217], v155 offset:40960
    v_lshrrev_b32 v30, 1, v26
    v_mfma_f32_16x16x32_bf16 v[216:219], a[196:199], a[144:147], v[216:219]
    ds_read_b64_tr_b16 a[218:219], v155 offset:43008
    v_lshlrev_b32 v12, 12, v30
    v_mfma_f32_16x16x32_bf16 v[220:223], a[196:199], a[148:151], v[220:223]
    ds_read_b64_tr_b16 a[220:221], v152 offset:41984
    v_and_b32 v30, 1, v26
    s_waitcnt lgkmcnt(7)
    v_mfma_f32_16x16x32_bf16 v[224:227], a[200:203], a[144:147], v[224:227]
    ds_read_b64_tr_b16 a[222:223], v152 offset:44032
    v_lshl_add_u32 v12, v30, 4, v12
    v_mfma_f32_16x16x32_bf16 v[228:231], a[200:203], a[148:151], v[228:231]
    ds_read_b64_tr_b16 a[192:193], v153 offset:41984
    s_lshl_b32 s60, s5, 12
    s_lshl_b32 s63, s4, 1
    v_mfma_f32_16x16x32_bf16 v[160:163], a[204:207], a[152:155], v[160:163]
    ds_read_b64_tr_b16 a[194:195], v153 offset:44032
    s_mov_b32 s55, 786432
    buffer_load_dwordx4 a[144:147], v158, s[32:35], s55 offen sc1
    v_mfma_f32_16x16x32_bf16 v[164:167], a[204:207], a[156:159], v[164:167]
    ds_read_b64_tr_b16 a[196:197], v154 offset:41984
    s_add_u32 s60, s60, s63
    s_add_u32 s60, s60, 34603008
    s_waitcnt lgkmcnt(7)
    v_mfma_f32_16x16x32_bf16 v[168:171], a[208:211], a[152:155], v[168:171]
    ds_read_b64_tr_b16 a[198:199], v154 offset:44032
    v_add_u32 v12, s60, v12
    v_mfma_f32_16x16x32_bf16 v[172:175], a[208:211], a[156:159], v[172:175]
    ds_read_b64_tr_b16 a[200:201], v155 offset:41984
    v_lshrrev_b32 v30, 2, v26
    v_mfma_f32_16x16x32_bf16 v[176:179], a[212:215], a[152:155], v[176:179]
    ds_read_b64_tr_b16 a[202:203], v155 offset:44032
    buffer_load_dwordx4 a[148:151], v159, s[32:35], s55 offen sc1
    v_mfma_f32_16x16x32_bf16 v[180:183], a[212:215], a[156:159], v[180:183]
    ds_read_b64_tr_b16 a[204:205], v156 offset:31744
    v_lshlrev_b32 v13, 12, v30
    s_waitcnt lgkmcnt(7)
    v_mfma_f32_16x16x32_bf16 v[184:187], a[216:219], a[152:155], v[184:187]
    ds_read_b64_tr_b16 a[206:207], v156 offset:32000
    s_lshl_b32 s63, s61, 1
    v_mfma_f32_16x16x32_bf16 v[188:191], a[216:219], a[156:159], v[188:191]
    ds_read_b64_tr_b16 a[208:209], v152 offset:49152
    v_xor_b32 v28, s63, v28
    v_mfma_f32_16x16x32_bf16 v[192:195], a[220:223], a[152:155], v[192:195]
    ds_read_b64_tr_b16 a[210:211], v152 offset:51200
    s_add_u32 m0, s43, 0
    s_mov_b32 s54, 368640
    buffer_load_dwordx4 v148, s[36:39], s54 offen offset:0 lds
    v_mfma_f32_16x16x32_bf16 v[196:199], a[220:223], a[156:159], v[196:199]
    ds_read_b64_tr_b16 a[212:213], v153 offset:49152
    v_lshl_add_u32 v13, v28, 4, v13
    s_waitcnt lgkmcnt(7)
    v_mfma_f32_16x16x32_bf16 v[200:203], a[192:195], a[152:155], v[200:203]
    ds_read_b64_tr_b16 a[214:215], v153 offset:51200
    s_lshl_b32 s60, s6, 12
    s_lshl_b32 s63, s71, 6
    v_mfma_f32_16x16x32_bf16 v[204:207], a[192:195], a[156:159], v[204:207]
    ds_read_b64_tr_b16 a[216:217], v154 offset:49152
    s_add_u32 s60, s60, s63
    s_add_u32 s60, s60, 34600960
    v_mfma_f32_16x16x32_bf16 v[208:211], a[196:199], a[152:155], v[208:211]
    ds_read_b64_tr_b16 a[218:219], v154 offset:51200
    buffer_load_dwordx4 v149, s[36:39], s54 offen offset:1024 lds
    v_mfma_f32_16x16x32_bf16 v[212:215], a[196:199], a[156:159], v[212:215]
    ds_read_b64_tr_b16 a[220:221], v155 offset:49152
    v_add_u32 v13, s60, v13
    s_waitcnt lgkmcnt(7)
    v_mfma_f32_16x16x32_bf16 v[216:219], a[200:203], a[152:155], v[216:219]
    ds_read_b64_tr_b16 a[222:223], v155 offset:51200
    s_mul_i32 s7, s40, 3072
    s_add_u32 s7, s7, 114688
    v_mfma_f32_16x16x32_bf16 v[220:223], a[200:203], a[156:159], v[220:223]
    ds_read_b64_tr_b16 a[192:193], v152 offset:50176
    s_mov_b32 s46, 130048
    s_lshl_b32 s60, s61, 8
    v_mfma_f32_16x16x32_bf16 v[224:227], a[204:207], a[152:155], v[224:227]
    ds_read_b64_tr_b16 a[194:195], v152 offset:52224
    v_xor_b32 v17, s60, v232
    v_mfma_f32_16x16x32_bf16 v[228:231], a[204:207], a[156:159], v[228:231]
    ds_read_b64_tr_b16 a[196:197], v153 offset:50176
    s_xor_b32 s12, s69, s40
    s_lshl_b32 s60, s12, 1
    s_waitcnt lgkmcnt(7)
    v_mfma_f32_16x16x32_bf16 v[160:163], a[208:211], a[160:163], v[160:163]
    ds_read_b64_tr_b16 a[198:199], v153 offset:52224
    s_mov_b32 s55, 917504
    buffer_load_dwordx4 a[152:155], v158, s[32:35], s55 offen sc1
    v_mfma_f32_16x16x32_bf16 v[164:167], a[208:211], a[164:167], v[164:167]
    ds_read_b64_tr_b16 a[200:201], v154 offset:50176
    s_xor_b32 s60, s60, s2
    s_mul_i32 s60, s60, 28672
    v_mfma_f32_16x16x32_bf16 v[168:171], a[212:215], a[160:163], v[168:171]
    ds_read_b64_tr_b16 a[202:203], v154 offset:52224
    s_lshl_b32 s63, s12, 10
    s_add_u32 s60, s60, s63
    v_mfma_f32_16x16x32_bf16 v[172:175], a[212:215], a[164:167], v[172:175]
    ds_read_b64_tr_b16 a[204:205], v155 offset:50176
    s_add_u32 s60, s60, 25451520
    s_cmp_eq_u32 s12, 0
    s_cselect_b32 s60, 2130706432, s60
    s_waitcnt lgkmcnt(7)
    v_mfma_f32_16x16x32_bf16 v[176:179], a[216:219], a[160:163], v[176:179]
    ds_read_b64_tr_b16 a[206:207], v155 offset:52224
    buffer_load_dwordx4 a[156:159], v159, s[32:35], s55 offen sc1
    v_mfma_f32_16x16x32_bf16 v[180:183], a[216:219], a[164:167], v[180:183]
    ds_read_b64_tr_b16 a[208:209], v156 offset:34816
    v_add_u32 v16, s60, v17
    v_mfma_f32_16x16x32_bf16 v[184:187], a[220:223], a[160:163], v[184:187]
    ds_read_b64_tr_b16 a[210:211], v156 offset:35072
    v_mfma_f32_16x16x32_bf16 v[188:191], a[220:223], a[164:167], v[188:191]
    ds_read_b64_tr_b16 a[212:213], v152 offset:57344
    s_waitcnt lgkmcnt(7)
    v_mfma_f32_16x16x32_bf16 v[192:195], a[192:195], a[160:163], v[192:195]
    ds_read_b64_tr_b16 a[214:215], v152 offset:59392
    s_add_u32 m0, s43, 0
    s_mov_b32 s54, 368640
    buffer_load_dwordx4 v150, s[36:39], s54 offen offset:2048 lds
    v_mfma_f32_16x16x32_bf16 v[196:199], a[192:195], a[164:167], v[196:199]
    ds_read_b64_tr_b16 a[216:217], v153 offset:57344
    v_mfma_f32_16x16x32_bf16 v[200:203], a[196:199], a[160:163], v[200:203]
    ds_read_b64_tr_b16 a[218:219], v153 offset:59392
    v_mfma_f32_16x16x32_bf16 v[204:207], a[196:199], a[164:167], v[204:207]
    ds_read_b64_tr_b16 a[220:221], v154 offset:57344
    s_waitcnt lgkmcnt(7)
    v_mfma_f32_16x16x32_bf16 v[208:211], a[200:203], a[160:163], v[208:211]
    ds_read_b64_tr_b16 a[222:223], v154 offset:59392
    buffer_load_dwordx4 v151, s[36:39], s54 offen offset:3072 lds
    v_mfma_f32_16x16x32_bf16 v[212:215], a[200:203], a[164:167], v[212:215]
    ds_read_b64_tr_b16 a[192:193], v155 offset:57344
    v_mfma_f32_16x16x32_bf16 v[216:219], a[204:207], a[160:163], v[216:219]
    ds_read_b64_tr_b16 a[194:195], v155 offset:59392
    v_mfma_f32_16x16x32_bf16 v[220:223], a[204:207], a[164:167], v[220:223]
    ds_read_b64_tr_b16 a[196:197], v152 offset:58368
    s_waitcnt lgkmcnt(7)
    v_mfma_f32_16x16x32_bf16 v[224:227], a[208:211], a[160:163], v[224:227]
    ds_read_b64_tr_b16 a[198:199], v152 offset:60416
    v_mfma_f32_16x16x32_bf16 v[228:231], a[208:211], a[164:167], v[228:231]
    ds_read_b64_tr_b16 a[200:201], v153 offset:58368
    s_waitcnt vmcnt(25)
    v_mfma_f32_16x16x32_bf16 v[160:163], a[212:215], a[168:171], v[160:163]
    ds_read_b64_tr_b16 a[202:203], v153 offset:60416
    s_mov_b32 s55, 1310720
    buffer_load_dwordx4 a[160:163], v158, s[32:35], s55 offen sc1
    v_mfma_f32_16x16x32_bf16 v[164:167], a[212:215], a[172:175], v[164:167]
    ds_read_b64_tr_b16 a[204:205], v154 offset:58368
    s_waitcnt lgkmcnt(7)
    v_mfma_f32_16x16x32_bf16 v[168:171], a[216:219], a[168:171], v[168:171]
    ds_read_b64_tr_b16 a[206:207], v154 offset:60416
    v_mfma_f32_16x16x32_bf16 v[172:175], a[216:219], a[172:175], v[172:175]
    ds_read_b64_tr_b16 a[208:209], v155 offset:58368
    v_mfma_f32_16x16x32_bf16 v[176:179], a[220:223], a[168:171], v[176:179]
    ds_read_b64_tr_b16 a[210:211], v155 offset:60416
    buffer_load_dwordx4 a[164:167], v159, s[32:35], s55 offen sc1
    v_mfma_f32_16x16x32_bf16 v[180:183], a[220:223], a[172:175], v[180:183]
    ds_read_b64_tr_b16 a[212:213], v156 offset:35840
    s_waitcnt lgkmcnt(7)
    v_mfma_f32_16x16x32_bf16 v[184:187], a[192:195], a[168:171], v[184:187]
    ds_read_b64_tr_b16 a[214:215], v156 offset:36096
    v_mfma_f32_16x16x32_bf16 v[188:191], a[192:195], a[172:175], v[188:191]
    v_mfma_f32_16x16x32_bf16 v[192:195], a[196:199], a[168:171], v[192:195]
    s_waitcnt vmcnt(23)
    s_barrier
    ds_read_b64_tr_b16 a[216:217], v236 offset:0
    ds_read_b64_tr_b16 a[218:219], v236 offset:2048
    s_add_u32 m0, s43, 16384
    s_mov_b32 s54, 516096
    buffer_load_dwordx4 v148, s[36:39], s54 offen offset:0 lds
    v_mfma_f32_16x16x32_bf16 v[196:199], a[196:199], a[172:175], v[196:199]
    ds_read_b64_tr_b16 a[220:221], v237 offset:0
    s_waitcnt lgkmcnt(7)
    v_mfma_f32_16x16x32_bf16 v[200:203], a[200:203], a[168:171], v[200:203]
    ds_read_b64_tr_b16 a[222:223], v237 offset:2048
    v_mfma_f32_16x16x32_bf16 v[204:207], a[200:203], a[172:175], v[204:207]
    ds_read_b64_tr_b16 a[192:193], v238 offset:0
    v_mfma_f32_16x16x32_bf16 v[208:211], a[204:207], a[168:171], v[208:211]
    ds_read_b64_tr_b16 a[194:195], v238 offset:2048
    buffer_load_dwordx4 v149, s[36:39], s54 offen offset:1024 lds
    v_mfma_f32_16x16x32_bf16 v[212:215], a[204:207], a[172:175], v[212:215]
    ds_read_b64_tr_b16 a[196:197], v239 offset:0
    s_waitcnt lgkmcnt(7)
    v_mfma_f32_16x16x32_bf16 v[216:219], a[208:211], a[168:171], v[216:219]
    ds_read_b64_tr_b16 a[198:199], v239 offset:2048
    v_mfma_f32_16x16x32_bf16 v[220:223], a[208:211], a[172:175], v[220:223]
    ds_read_b64_tr_b16 a[200:201], v236 offset:1024
    v_mfma_f32_16x16x32_bf16 v[224:227], a[212:215], a[168:171], v[224:227]
    ds_read_b64_tr_b16 a[202:203], v236 offset:3072
    v_mfma_f32_16x16x32_bf16 v[228:231], a[212:215], a[172:175], v[228:231]
    ds_read_b64_tr_b16 a[204:205], v237 offset:1024
    s_waitcnt vmcnt(23) lgkmcnt(7)
    v_mfma_f32_16x16x32_bf16 v[160:163], a[216:219], a[176:179], v[160:163]
    ds_read_b64_tr_b16 a[206:207], v237 offset:3072
    s_mov_b32 s55, 1441792
    buffer_load_dwordx4 a[168:171], v158, s[32:35], s55 offen sc1
    v_mfma_f32_16x16x32_bf16 v[164:167], a[216:219], a[180:183], v[164:167]
    ds_read_b64_tr_b16 a[208:209], v238 offset:1024
    v_mfma_f32_16x16x32_bf16 v[168:171], a[220:223], a[176:179], v[168:171]
    ds_read_b64_tr_b16 a[210:211], v238 offset:3072
    v_mfma_f32_16x16x32_bf16 v[172:175], a[220:223], a[180:183], v[172:175]
    ds_read_b64_tr_b16 a[212:213], v239 offset:1024
    s_waitcnt lgkmcnt(7)
    v_mfma_f32_16x16x32_bf16 v[176:179], a[192:195], a[176:179], v[176:179]
    ds_read_b64_tr_b16 a[214:215], v239 offset:3072
    buffer_load_dwordx4 a[172:175], v159, s[32:35], s55 offen sc1
    v_mfma_f32_16x16x32_bf16 v[180:183], a[192:195], a[180:183], v[180:183]
    ds_read_b64_tr_b16 a[216:217], v156 offset:2048
    v_mfma_f32_16x16x32_bf16 v[184:187], a[196:199], a[176:179], v[184:187]
    ds_read_b64_tr_b16 a[218:219], v156 offset:2304
    v_mfma_f32_16x16x32_bf16 v[188:191], a[196:199], a[180:183], v[188:191]
    ds_read_b64_tr_b16 a[220:221], v236 offset:8192
    s_waitcnt lgkmcnt(7)
    v_mfma_f32_16x16x32_bf16 v[192:195], a[200:203], a[176:179], v[192:195]
    ds_read_b64_tr_b16 a[222:223], v236 offset:10240
    s_add_u32 m0, s43, 16384
    s_mov_b32 s54, 516096
    buffer_load_dwordx4 v150, s[36:39], s54 offen offset:2048 lds
    v_mfma_f32_16x16x32_bf16 v[196:199], a[200:203], a[180:183], v[196:199]
    ds_read_b64_tr_b16 a[192:193], v237 offset:8192
    v_mfma_f32_16x16x32_bf16 v[200:203], a[204:207], a[176:179], v[200:203]
    ds_read_b64_tr_b16 a[194:195], v237 offset:10240
    v_mfma_f32_16x16x32_bf16 v[204:207], a[204:207], a[180:183], v[204:207]
    ds_read_b64_tr_b16 a[196:197], v238 offset:8192
    s_waitcnt lgkmcnt(7)
    v_mfma_f32_16x16x32_bf16 v[208:211], a[208:211], a[176:179], v[208:211]
    ds_read_b64_tr_b16 a[198:199], v238 offset:10240
    buffer_load_dwordx4 v151, s[36:39], s54 offen offset:3072 lds
    v_mfma_f32_16x16x32_bf16 v[212:215], a[208:211], a[180:183], v[212:215]
    ds_read_b64_tr_b16 a[200:201], v239 offset:8192
    v_mfma_f32_16x16x32_bf16 v[216:219], a[212:215], a[176:179], v[216:219]
    ds_read_b64_tr_b16 a[202:203], v239 offset:10240
    v_mfma_f32_16x16x32_bf16 v[220:223], a[212:215], a[180:183], v[220:223]
    ds_read_b64_tr_b16 a[204:205], v236 offset:9216
    s_waitcnt lgkmcnt(7)
    v_mfma_f32_16x16x32_bf16 v[224:227], a[216:219], a[176:179], v[224:227]
    ds_read_b64_tr_b16 a[206:207], v236 offset:11264
    v_mfma_f32_16x16x32_bf16 v[228:231], a[216:219], a[180:183], v[228:231]
    ds_read_b64_tr_b16 a[208:209], v237 offset:9216
    s_waitcnt vmcnt(25)
    v_mfma_f32_16x16x32_bf16 v[160:163], a[220:223], a[184:187], v[160:163]
    ds_read_b64_tr_b16 a[210:211], v237 offset:11264
    s_mov_b32 s55, 1835008
    buffer_load_dwordx4 a[224:227], v158, s[32:35], s55 offen sc1
    v_mfma_f32_16x16x32_bf16 v[164:167], a[220:223], a[188:191], v[164:167]
    ds_read_b64_tr_b16 a[212:213], v238 offset:9216
    s_waitcnt lgkmcnt(7)
    v_mfma_f32_16x16x32_bf16 v[168:171], a[192:195], a[184:187], v[168:171]
    ds_read_b64_tr_b16 a[214:215], v238 offset:11264
    v_mfma_f32_16x16x32_bf16 v[172:175], a[192:195], a[188:191], v[172:175]
    ds_read_b64_tr_b16 a[216:217], v239 offset:9216
    v_mfma_f32_16x16x32_bf16 v[176:179], a[196:199], a[184:187], v[176:179]
    ds_read_b64_tr_b16 a[218:219], v239 offset:11264
    buffer_load_dwordx4 a[180:183], v159, s[32:35], s55 offen sc1
    v_mfma_f32_16x16x32_bf16 v[180:183], a[196:199], a[188:191], v[180:183]
    ds_read_b64_tr_b16 a[220:221], v156 offset:3072
    s_waitcnt lgkmcnt(7)
    v_mfma_f32_16x16x32_bf16 v[184:187], a[200:203], a[184:187], v[184:187]
    ds_read_b64_tr_b16 a[222:223], v156 offset:3328
    v_mfma_f32_16x16x32_bf16 v[188:191], a[200:203], a[188:191], v[188:191]
    ds_read_b64_tr_b16 a[192:193], v236 offset:16384
    v_mfma_f32_16x16x32_bf16 v[192:195], a[204:207], a[184:187], v[192:195]
    ds_read_b64_tr_b16 a[194:195], v236 offset:18432
    s_add_u32 m0, s43, 32768
    s_mov_b32 s54, 737280
    buffer_load_dwordx4 v148, s[36:39], s54 offen offset:0 lds
    v_mfma_f32_16x16x32_bf16 v[196:199], a[204:207], a[188:191], v[196:199]
    ds_read_b64_tr_b16 a[196:197], v237 offset:16384
    s_waitcnt lgkmcnt(7)
    v_mfma_f32_16x16x32_bf16 v[200:203], a[208:211], a[184:187], v[200:203]
    ds_read_b64_tr_b16 a[198:199], v237 offset:18432
    v_mfma_f32_16x16x32_bf16 v[204:207], a[208:211], a[188:191], v[204:207]
    ds_read_b64_tr_b16 a[200:201], v238 offset:16384
    v_mfma_f32_16x16x32_bf16 v[208:211], a[212:215], a[184:187], v[208:211]
    ds_read_b64_tr_b16 a[202:203], v238 offset:18432
    buffer_load_dwordx4 v149, s[36:39], s54 offen offset:1024 lds
    v_mfma_f32_16x16x32_bf16 v[212:215], a[212:215], a[188:191], v[212:215]
    ds_read_b64_tr_b16 a[204:205], v239 offset:16384
    s_waitcnt lgkmcnt(7)
    v_mfma_f32_16x16x32_bf16 v[216:219], a[216:219], a[184:187], v[216:219]
    ds_read_b64_tr_b16 a[206:207], v239 offset:18432
    v_mfma_f32_16x16x32_bf16 v[220:223], a[216:219], a[188:191], v[220:223]
    ds_read_b64_tr_b16 a[208:209], v236 offset:17408
    v_mfma_f32_16x16x32_bf16 v[224:227], a[220:223], a[184:187], v[224:227]
    ds_read_b64_tr_b16 a[210:211], v236 offset:19456
    v_mfma_f32_16x16x32_bf16 v[228:231], a[220:223], a[188:191], v[228:231]
    ds_read_b64_tr_b16 a[212:213], v237 offset:17408
    s_waitcnt vmcnt(27) lgkmcnt(7)
    v_mfma_f32_16x16x32_bf16 v[160:163], a[192:195], a[128:131], v[160:163]
    ds_read_b64_tr_b16 a[214:215], v237 offset:19456
    s_mov_b32 s55, 1966080
    buffer_load_dwordx4 a[228:231], v158, s[32:35], s55 offen sc1
    v_mfma_f32_16x16x32_bf16 v[164:167], a[192:195], a[132:135], v[164:167]
    ds_read_b64_tr_b16 a[216:217], v238 offset:17408
    v_mfma_f32_16x16x32_bf16 v[168:171], a[196:199], a[128:131], v[168:171]
    ds_read_b64_tr_b16 a[218:219], v238 offset:19456
    v_mfma_f32_16x16x32_bf16 v[172:175], a[196:199], a[132:135], v[172:175]
    ds_read_b64_tr_b16 a[220:221], v239 offset:17408
    s_waitcnt lgkmcnt(7)
    v_mfma_f32_16x16x32_bf16 v[176:179], a[200:203], a[128:131], v[176:179]
    ds_read_b64_tr_b16 a[222:223], v239 offset:19456
    buffer_load_dwordx4 a[188:191], v159, s[32:35], s55 offen sc1
    v_mfma_f32_16x16x32_bf16 v[180:183], a[200:203], a[132:135], v[180:183]
    ds_read_b64_tr_b16 a[192:193], v156 offset:10240
    v_mfma_f32_16x16x32_bf16 v[184:187], a[204:207], a[128:131], v[184:187]
    ds_read_b64_tr_b16 a[194:195], v156 offset:10496
    v_mfma_f32_16x16x32_bf16 v[188:191], a[204:207], a[132:135], v[188:191]
    ds_read_b64_tr_b16 a[196:197], v236 offset:24576
    s_waitcnt lgkmcnt(7)
    v_mfma_f32_16x16x32_bf16 v[192:195], a[208:211], a[128:131], v[192:195]
    ds_read_b64_tr_b16 a[198:199], v236 offset:26624
    s_add_u32 m0, s43, 32768
    s_mov_b32 s54, 737280
    buffer_load_dwordx4 v150, s[36:39], s54 offen offset:2048 lds
    v_mfma_f32_16x16x32_bf16 v[196:199], a[208:211], a[132:135], v[196:199]
    ds_read_b64_tr_b16 a[200:201], v237 offset:24576
    v_mfma_f32_16x16x32_bf16 v[200:203], a[212:215], a[128:131], v[200:203]
    ds_read_b64_tr_b16 a[202:203], v237 offset:26624
    v_mfma_f32_16x16x32_bf16 v[204:207], a[212:215], a[132:135], v[204:207]
    ds_read_b64_tr_b16 a[204:205], v238 offset:24576
    s_waitcnt lgkmcnt(7)
    v_mfma_f32_16x16x32_bf16 v[208:211], a[216:219], a[128:131], v[208:211]
    ds_read_b64_tr_b16 a[206:207], v238 offset:26624
    buffer_load_dwordx4 v151, s[36:39], s54 offen offset:3072 lds
    v_mfma_f32_16x16x32_bf16 v[212:215], a[216:219], a[132:135], v[212:215]
    ds_read_b64_tr_b16 a[208:209], v239 offset:24576
    v_mfma_f32_16x16x32_bf16 v[216:219], a[220:223], a[128:131], v[216:219]
    ds_read_b64_tr_b16 a[210:211], v239 offset:26624
    v_mfma_f32_16x16x32_bf16 v[220:223], a[220:223], a[132:135], v[220:223]
    ds_read_b64_tr_b16 a[212:213], v236 offset:25600
    s_waitcnt lgkmcnt(7)
    v_mfma_f32_16x16x32_bf16 v[224:227], a[192:195], a[128:131], v[224:227]
    ds_read_b64_tr_b16 a[214:215], v236 offset:27648
    v_mfma_f32_16x16x32_bf16 v[228:231], a[192:195], a[132:135], v[228:231]
    ds_read_b64_tr_b16 a[216:217], v237 offset:25600
    s_waitcnt vmcnt(26)
    v_mfma_f32_16x16x32_bf16 v[160:163], a[196:199], a[136:139], v[160:163]
    ds_read_b64_tr_b16 a[218:219], v237 offset:27648
    s_mov_b32 s55, 2621440
    buffer_load_dwordx4 a[232:235], v158, s[32:35], s55 offen sc1
    v_mfma_f32_16x16x32_bf16 v[164:167], a[196:199], a[140:143], v[164:167]
    ds_read_b64_tr_b16 a[220:221], v238 offset:25600
    s_waitcnt lgkmcnt(7)
    v_mfma_f32_16x16x32_bf16 v[168:171], a[200:203], a[136:139], v[168:171]
    ds_read_b64_tr_b16 a[222:223], v238 offset:27648
    v_mfma_f32_16x16x32_bf16 v[172:175], a[200:203], a[140:143], v[172:175]
    ds_read_b64_tr_b16 a[192:193], v239 offset:25600
    v_mfma_f32_16x16x32_bf16 v[176:179], a[204:207], a[136:139], v[176:179]
    ds_read_b64_tr_b16 a[194:195], v239 offset:27648
    buffer_load_dwordx4 a[132:135], v159, s[32:35], s55 offen sc1
    v_mfma_f32_16x16x32_bf16 v[180:183], a[204:207], a[140:143], v[180:183]
    ds_read_b64_tr_b16 a[196:197], v156 offset:11264
    s_waitcnt lgkmcnt(7)
    v_mfma_f32_16x16x32_bf16 v[184:187], a[208:211], a[136:139], v[184:187]
    ds_read_b64_tr_b16 a[198:199], v156 offset:11520
    v_mfma_f32_16x16x32_bf16 v[188:191], a[208:211], a[140:143], v[188:191]
    v_mfma_f32_16x16x32_bf16 v[192:195], a[212:215], a[136:139], v[192:195]
    s_waitcnt vmcnt(18)
    s_barrier
    ds_read_b64_tr_b16 a[200:201], v236 offset:32768
    ds_read_b64_tr_b16 a[202:203], v236 offset:34816
    s_add_u32 m0, s43, 49152
    s_mov_b32 s54, 884736
    buffer_load_dwordx4 v148, s[36:39], s54 offen offset:0 lds
    v_mfma_f32_16x16x32_bf16 v[196:199], a[212:215], a[140:143], v[196:199]
    ds_read_b64_tr_b16 a[204:205], v237 offset:32768
    s_waitcnt lgkmcnt(7)
    v_mfma_f32_16x16x32_bf16 v[200:203], a[216:219], a[136:139], v[200:203]
    ds_read_b64_tr_b16 a[206:207], v237 offset:34816
    v_mfma_f32_16x16x32_bf16 v[204:207], a[216:219], a[140:143], v[204:207]
    ds_read_b64_tr_b16 a[208:209], v238 offset:32768
    v_mfma_f32_16x16x32_bf16 v[208:211], a[220:223], a[136:139], v[208:211]
    ds_read_b64_tr_b16 a[210:211], v238 offset:34816
    buffer_load_dwordx4 v149, s[36:39], s54 offen offset:1024 lds
    v_mfma_f32_16x16x32_bf16 v[212:215], a[220:223], a[140:143], v[212:215]
    ds_read_b64_tr_b16 a[212:213], v239 offset:32768
    s_waitcnt lgkmcnt(7)
    v_mfma_f32_16x16x32_bf16 v[216:219], a[192:195], a[136:139], v[216:219]
    ds_read_b64_tr_b16 a[214:215], v239 offset:34816
    v_mfma_f32_16x16x32_bf16 v[220:223], a[192:195], a[140:143], v[220:223]
    ds_read_b64_tr_b16 a[216:217], v236 offset:33792
    v_mfma_f32_16x16x32_bf16 v[224:227], a[196:199], a[136:139], v[224:227]
    ds_read_b64_tr_b16 a[218:219], v236 offset:35840
    buffer_load_dword v147, v157, s[32:35], 0 offen sc1
    v_mfma_f32_16x16x32_bf16 v[228:231], a[196:199], a[140:143], v[228:231]
    ds_read_b64_tr_b16 a[220:221], v237 offset:33792
    s_waitcnt lgkmcnt(7)
    v_mfma_f32_16x16x32_bf16 v[160:163], a[200:203], a[144:147], v[160:163]
    ds_read_b64_tr_b16 a[222:223], v237 offset:35840
    s_mov_b32 s55, 2752512
    buffer_load_dwordx4 a[236:239], v158, s[32:35], s55 offen sc1
    v_mfma_f32_16x16x32_bf16 v[164:167], a[200:203], a[148:151], v[164:167]
    ds_read_b64_tr_b16 a[192:193], v238 offset:33792
    v_mfma_f32_16x16x32_bf16 v[168:171], a[204:207], a[144:147], v[168:171]
    ds_read_b64_tr_b16 a[194:195], v238 offset:35840
    v_mfma_f32_16x16x32_bf16 v[172:175], a[204:207], a[148:151], v[172:175]
    ds_read_b64_tr_b16 a[196:197], v239 offset:33792
    s_waitcnt lgkmcnt(7)
    v_mfma_f32_16x16x32_bf16 v[176:179], a[208:211], a[144:147], v[176:179]
    ds_read_b64_tr_b16 a[198:199], v239 offset:35840
    buffer_load_dwordx4 a[140:143], v159, s[32:35], s55 offen sc1
    v_mfma_f32_16x16x32_bf16 v[180:183], a[208:211], a[148:151], v[180:183]
    ds_read_b64_tr_b16 a[200:201], v156 offset:14336
    v_mfma_f32_16x16x32_bf16 v[184:187], a[212:215], a[144:147], v[184:187]
    ds_read_b64_tr_b16 a[202:203], v156 offset:14592
    v_mfma_f32_16x16x32_bf16 v[188:191], a[212:215], a[148:151], v[188:191]
    ds_read_b64_tr_b16 a[204:205], v236 offset:40960
    s_waitcnt lgkmcnt(7)
    v_mfma_f32_16x16x32_bf16 v[192:195], a[216:219], a[144:147], v[192:195]
    ds_read_b64_tr_b16 a[206:207], v236 offset:43008
    s_add_u32 m0, s43, 49152
    s_mov_b32 s54, 884736
    buffer_load_dwordx4 v150, s[36:39], s54 offen offset:2048 lds
    v_mfma_f32_16x16x32_bf16 v[196:199], a[216:219], a[148:151], v[196:199]
    ds_read_b64_tr_b16 a[208:209], v237 offset:40960
    v_mfma_f32_16x16x32_bf16 v[200:203], a[220:223], a[144:147], v[200:203]
    ds_read_b64_tr_b16 a[210:211], v237 offset:43008
    v_mfma_f32_16x16x32_bf16 v[204:207], a[220:223], a[148:151], v[204:207]
    ds_read_b64_tr_b16 a[212:213], v238 offset:40960
    s_waitcnt lgkmcnt(7)
    v_mfma_f32_16x16x32_bf16 v[208:211], a[192:195], a[144:147], v[208:211]
    ds_read_b64_tr_b16 a[214:215], v238 offset:43008
    buffer_load_dwordx4 v151, s[36:39], s54 offen offset:3072 lds
    v_mfma_f32_16x16x32_bf16 v[212:215], a[192:195], a[148:151], v[212:215]
    ds_read_b64_tr_b16 a[216:217], v239 offset:40960
    v_mfma_f32_16x16x32_bf16 v[216:219], a[196:199], a[144:147], v[216:219]
    ds_read_b64_tr_b16 a[218:219], v239 offset:43008
    v_mfma_f32_16x16x32_bf16 v[220:223], a[196:199], a[148:151], v[220:223]
    ds_read_b64_tr_b16 a[220:221], v236 offset:41984
    s_waitcnt lgkmcnt(7)
    v_mfma_f32_16x16x32_bf16 v[224:227], a[200:203], a[144:147], v[224:227]
    ds_read_b64_tr_b16 a[222:223], v236 offset:44032
    v_mfma_f32_16x16x32_bf16 v[228:231], a[200:203], a[148:151], v[228:231]
    ds_read_b64_tr_b16 a[192:193], v237 offset:41984
    v_mfma_f32_16x16x32_bf16 v[160:163], a[204:207], a[152:155], v[160:163]
    ds_read_b64_tr_b16 a[194:195], v237 offset:44032
    s_mov_b32 s55, 3145728
    buffer_load_dwordx4 a[240:243], v158, s[32:35], s55 offen sc1
    v_mfma_f32_16x16x32_bf16 v[164:167], a[204:207], a[156:159], v[164:167]
    ds_read_b64_tr_b16 a[196:197], v238 offset:41984
    s_waitcnt lgkmcnt(7)
    v_mfma_f32_16x16x32_bf16 v[168:171], a[208:211], a[152:155], v[168:171]
    ds_read_b64_tr_b16 a[198:199], v238 offset:44032
    v_mfma_f32_16x16x32_bf16 v[172:175], a[208:211], a[156:159], v[172:175]
    ds_read_b64_tr_b16 a[200:201], v239 offset:41984
    v_mfma_f32_16x16x32_bf16 v[176:179], a[212:215], a[152:155], v[176:179]
    ds_read_b64_tr_b16 a[202:203], v239 offset:44032
    buffer_load_dwordx4 a[148:151], v159, s[32:35], s55 offen sc1
    v_mfma_f32_16x16x32_bf16 v[180:183], a[212:215], a[156:159], v[180:183]
    ds_read_b64_tr_b16 a[204:205], v156 offset:15360
    s_waitcnt lgkmcnt(7)
    v_mfma_f32_16x16x32_bf16 v[184:187], a[216:219], a[152:155], v[184:187]
    ds_read_b64_tr_b16 a[206:207], v156 offset:15616
    v_mfma_f32_16x16x32_bf16 v[188:191], a[216:219], a[156:159], v[188:191]
    ds_read_b64_tr_b16 a[208:209], v152 offset:0
    v_mfma_f32_16x16x32_bf16 v[192:195], a[220:223], a[152:155], v[192:195]
    ds_read_b64_tr_b16 a[210:211], v152 offset:2048
    s_add_u32 m0, s43, 65536
    s_mov_b32 s54, 1032192
    buffer_load_dwordx4 v148, s[36:39], s54 offen offset:0 lds
    v_mfma_f32_16x16x32_bf16 v[196:199], a[220:223], a[156:159], v[196:199]
    ds_read_b64_tr_b16 a[212:213], v153 offset:0
    s_waitcnt lgkmcnt(7)
    v_mfma_f32_16x16x32_bf16 v[200:203], a[192:195], a[152:155], v[200:203]
    ds_read_b64_tr_b16 a[214:215], v153 offset:2048
    v_mfma_f32_16x16x32_bf16 v[204:207], a[192:195], a[156:159], v[204:207]
    ds_read_b64_tr_b16 a[216:217], v154 offset:0
    v_mfma_f32_16x16x32_bf16 v[208:211], a[196:199], a[152:155], v[208:211]
    ds_read_b64_tr_b16 a[218:219], v154 offset:2048
    buffer_load_dwordx4 v149, s[36:39], s54 offen offset:1024 lds
    v_mfma_f32_16x16x32_bf16 v[212:215], a[196:199], a[156:159], v[212:215]
    ds_read_b64_tr_b16 a[220:221], v155 offset:0
    s_waitcnt lgkmcnt(7)
    v_mfma_f32_16x16x32_bf16 v[216:219], a[200:203], a[152:155], v[216:219]
    ds_read_b64_tr_b16 a[222:223], v155 offset:2048
    v_mfma_f32_16x16x32_bf16 v[220:223], a[200:203], a[156:159], v[220:223]
    ds_read_b64_tr_b16 a[192:193], v152 offset:1024
    v_mfma_f32_16x16x32_bf16 v[224:227], a[204:207], a[152:155], v[224:227]
    ds_read_b64_tr_b16 a[194:195], v152 offset:3072
    v_mfma_f32_16x16x32_bf16 v[228:231], a[204:207], a[156:159], v[228:231]
    s_waitcnt vmcnt(8)
    v_cmp_ne_u32 vcc, 3, v147
    s_nop 0
    s_cbranch_vccnz mk_SL_H3
mk_BK_H3:
    ds_read_b64_tr_b16 a[196:197], v153 offset:1024
    s_waitcnt lgkmcnt(7)
    v_mfma_f32_16x16x32_bf16 v[160:163], a[208:211], a[160:163], v[160:163]
    ds_read_b64_tr_b16 a[198:199], v153 offset:3072
    s_mov_b32 s55, 3276800
    buffer_load_dwordx4 a[244:247], v158, s[32:35], s55 offen sc1
    v_mfma_f32_16x16x32_bf16 v[164:167], a[208:211], a[164:167], v[164:167]
    ds_read_b64_tr_b16 a[200:201], v154 offset:1024
    v_mfma_f32_16x16x32_bf16 v[168:171], a[212:215], a[160:163], v[168:171]
    ds_read_b64_tr_b16 a[202:203], v154 offset:3072
    v_mfma_f32_16x16x32_bf16 v[172:175], a[212:215], a[164:167], v[172:175]
    ds_read_b64_tr_b16 a[204:205], v155 offset:1024
    s_waitcnt lgkmcnt(7)
    v_mfma_f32_16x16x32_bf16 v[176:179], a[216:219], a[160:163], v[176:179]
    ds_read_b64_tr_b16 a[206:207], v155 offset:3072
    buffer_load_dwordx4 a[156:159], v159, s[32:35], s55 offen sc1
    v_mfma_f32_16x16x32_bf16 v[180:183], a[216:219], a[164:167], v[180:183]
    ds_read_b64_tr_b16 a[208:209], v156 offset:18432
    v_mfma_f32_16x16x32_bf16 v[184:187], a[220:223], a[160:163], v[184:187]
    ds_read_b64_tr_b16 a[210:211], v156 offset:18688
    v_mfma_f32_16x16x32_bf16 v[188:191], a[220:223], a[164:167], v[188:191]
    ds_read_b64_tr_b16 a[212:213], v152 offset:8192
    s_waitcnt lgkmcnt(7)
    v_mfma_f32_16x16x32_bf16 v[192:195], a[192:195], a[160:163], v[192:195]
    ds_read_b64_tr_b16 a[214:215], v152 offset:10240
    s_add_u32 m0, s43, 65536
    s_mov_b32 s54, 1032192
    buffer_load_dwordx4 v150, s[36:39], s54 offen offset:2048 lds
    v_mfma_f32_16x16x32_bf16 v[196:199], a[192:195], a[164:167], v[196:199]
    ds_read_b64_tr_b16 a[216:217], v153 offset:8192
    v_mfma_f32_16x16x32_bf16 v[200:203], a[196:199], a[160:163], v[200:203]
    ds_read_b64_tr_b16 a[218:219], v153 offset:10240
    v_mfma_f32_16x16x32_bf16 v[204:207], a[196:199], a[164:167], v[204:207]
    ds_read_b64_tr_b16 a[220:221], v154 offset:8192
    s_waitcnt lgkmcnt(7)
    v_mfma_f32_16x16x32_bf16 v[208:211], a[200:203], a[160:163], v[208:211]
    ds_read_b64_tr_b16 a[222:223], v154 offset:10240
    buffer_load_dwordx4 v151, s[36:39], s54 offen offset:3072 lds
    v_mfma_f32_16x16x32_bf16 v[212:215], a[200:203], a[164:167], v[212:215]
    ds_read_b64_tr_b16 a[192:193], v155 offset:8192
    v_mfma_f32_16x16x32_bf16 v[216:219], a[204:207], a[160:163], v[216:219]
    ds_read_b64_tr_b16 a[194:195], v155 offset:10240
    v_mfma_f32_16x16x32_bf16 v[220:223], a[204:207], a[164:167], v[220:223]
    ds_read_b64_tr_b16 a[196:197], v152 offset:9216
    s_waitcnt lgkmcnt(7)
    v_mfma_f32_16x16x32_bf16 v[224:227], a[208:211], a[160:163], v[224:227]
    ds_read_b64_tr_b16 a[198:199], v152 offset:11264
    v_mfma_f32_16x16x32_bf16 v[228:231], a[208:211], a[164:167], v[228:231]
    ds_read_b64_tr_b16 a[200:201], v153 offset:9216
    v_mfma_f32_16x16x32_bf16 v[160:163], a[212:215], a[168:171], v[160:163]
    ds_read_b64_tr_b16 a[202:203], v153 offset:11264
    s_mov_b32 s55, 3670016
    buffer_load_dwordx4 a[160:163], v158, s[32:35], s55 offen sc1
    v_mfma_f32_16x16x32_bf16 v[164:167], a[212:215], a[172:175], v[164:167]
    ds_read_b64_tr_b16 a[204:205], v154 offset:9216
    s_waitcnt lgkmcnt(7)
    v_mfma_f32_16x16x32_bf16 v[168:171], a[216:219], a[168:171], v[168:171]
    ds_read_b64_tr_b16 a[206:207], v154 offset:11264
    v_mfma_f32_16x16x32_bf16 v[172:175], a[216:219], a[172:175], v[172:175]
    ds_read_b64_tr_b16 a[208:209], v155 offset:9216
    v_mfma_f32_16x16x32_bf16 v[176:179], a[220:223], a[168:171], v[176:179]
    ds_read_b64_tr_b16 a[210:211], v155 offset:11264
    buffer_load_dwordx4 a[164:167], v159, s[32:35], s55 offen sc1
    v_mfma_f32_16x16x32_bf16 v[180:183], a[220:223], a[172:175], v[180:183]
    ds_read_b64_tr_b16 a[212:213], v156 offset:19456
    s_waitcnt lgkmcnt(7)
    v_mfma_f32_16x16x32_bf16 v[184:187], a[192:195], a[168:171], v[184:187]
    ds_read_b64_tr_b16 a[214:215], v156 offset:19712
    v_mfma_f32_16x16x32_bf16 v[188:191], a[192:195], a[172:175], v[188:191]
    v_mfma_f32_16x16x32_bf16 v[192:195], a[196:199], a[168:171], v[192:195]
    s_barrier
    ds_read_b64_tr_b16 a[216:217], v152 offset:16384
    ds_read_b64_tr_b16 a[218:219], v152 offset:18432
    s_add_u32 m0, s43, 81920
    s_mov_b32 s54, 1179648
    buffer_load_dwordx4 v148, s[36:39], s54 offen offset:0 lds
    v_mfma_f32_16x16x32_bf16 v[196:199], a[196:199], a[172:175], v[196:199]
    ds_read_b64_tr_b16 a[220:221], v153 offset:16384
    s_waitcnt lgkmcnt(7)
    v_mfma_f32_16x16x32_bf16 v[200:203], a[200:203], a[168:171], v[200:203]
    ds_read_b64_tr_b16 a[222:223], v153 offset:18432
    v_mfma_f32_16x16x32_bf16 v[204:207], a[200:203], a[172:175], v[204:207]
    ds_read_b64_tr_b16 a[192:193], v154 offset:16384
    v_mfma_f32_16x16x32_bf16 v[208:211], a[204:207], a[168:171], v[208:211]
    ds_read_b64_tr_b16 a[194:195], v154 offset:18432
    buffer_load_dwordx4 v149, s[36:39], s54 offen offset:1024 lds
    v_mfma_f32_16x16x32_bf16 v[212:215], a[204:207], a[172:175], v[212:215]
    ds_read_b64_tr_b16 a[196:197], v155 offset:16384
    s_waitcnt lgkmcnt(7)
    v_mfma_f32_16x16x32_bf16 v[216:219], a[208:211], a[168:171], v[216:219]
    ds_read_b64_tr_b16 a[198:199], v155 offset:18432
    v_mfma_f32_16x16x32_bf16 v[220:223], a[208:211], a[172:175], v[220:223]
    ds_read_b64_tr_b16 a[200:201], v152 offset:17408
    v_mfma_f32_16x16x32_bf16 v[224:227], a[212:215], a[168:171], v[224:227]
    ds_read_b64_tr_b16 a[202:203], v152 offset:19456
    v_mfma_f32_16x16x32_bf16 v[228:231], a[212:215], a[172:175], v[228:231]
    ds_read_b64_tr_b16 a[204:205], v153 offset:17408
    s_waitcnt lgkmcnt(7)
    v_mfma_f32_16x16x32_bf16 v[164:167], a[216:219], a[180:183], v[164:167]
    ds_read_b64_tr_b16 a[206:207], v153 offset:19456
    s_mov_b32 s55, 3801088
    buffer_load_dwordx4 a[168:171], v158, s[32:35], s55 offen sc1
    v_mfma_f32_16x16x32_bf16 v[172:175], a[220:223], a[180:183], v[172:175]
    ds_read_b64_tr_b16 a[208:209], v154 offset:17408
    ds_read_b64_tr_b16 a[210:211], v154 offset:19456
    s_waitcnt lgkmcnt(6)
    v_mfma_f32_16x16x32_bf16 v[180:183], a[192:195], a[180:183], v[180:183]
    ds_read_b64_tr_b16 a[212:213], v155 offset:17408
    ds_read_b64_tr_b16 a[214:215], v155 offset:19456
    v_mfma_f32_16x16x32_bf16 v[188:191], a[196:199], a[180:183], v[188:191]
    ds_read_b64_tr_b16 a[216:217], v156 offset:22528
    ds_read_b64_tr_b16 a[218:219], v156 offset:22784
    s_waitcnt lgkmcnt(6)
    v_mfma_f32_16x16x32_bf16 v[192:195], a[200:203], a[224:227], v[192:195]
    ds_read_b64_tr_b16 a[220:221], v152 offset:24576
    ds_read_b64_tr_b16 a[222:223], v152 offset:26624
    buffer_load_dwordx4 a[172:175], v159, s[32:35], s55 offen sc1
    v_mfma_f32_16x16x32_bf16 v[196:199], a[200:203], a[180:183], v[196:199]
    ds_read_b64_tr_b16 a[192:193], v153 offset:24576
    v_mfma_f32_16x16x32_bf16 v[200:203], a[204:207], a[224:227], v[200:203]
    ds_read_b64_tr_b16 a[194:195], v153 offset:26624
    v_mfma_f32_16x16x32_bf16 v[204:207], a[204:207], a[180:183], v[204:207]
    ds_read_b64_tr_b16 a[196:197], v154 offset:24576
    s_waitcnt lgkmcnt(7)
    v_mfma_f32_16x16x32_bf16 v[208:211], a[208:211], a[224:227], v[208:211]
    ds_read_b64_tr_b16 a[198:199], v154 offset:26624
    s_add_u32 m0, s43, 81920
    s_mov_b32 s54, 1179648
    buffer_load_dwordx4 v150, s[36:39], s54 offen offset:2048 lds
    v_mfma_f32_16x16x32_bf16 v[212:215], a[208:211], a[180:183], v[212:215]
    ds_read_b64_tr_b16 a[200:201], v155 offset:24576
    v_mfma_f32_16x16x32_bf16 v[216:219], a[212:215], a[224:227], v[216:219]
    ds_read_b64_tr_b16 a[202:203], v155 offset:26624
    v_mfma_f32_16x16x32_bf16 v[220:223], a[212:215], a[180:183], v[220:223]
    ds_read_b64_tr_b16 a[204:205], v152 offset:25600
    s_waitcnt lgkmcnt(7)
    v_mfma_f32_16x16x32_bf16 v[224:227], a[216:219], a[224:227], v[224:227]
    ds_read_b64_tr_b16 a[206:207], v152 offset:27648
    buffer_load_dwordx4 v151, s[36:39], s54 offen offset:3072 lds
    v_mfma_f32_16x16x32_bf16 v[228:231], a[216:219], a[180:183], v[228:231]
    ds_read_b64_tr_b16 a[208:209], v153 offset:25600
    v_mfma_f32_16x16x32_bf16 v[164:167], a[220:223], a[188:191], v[164:167]
    ds_read_b64_tr_b16 a[210:211], v153 offset:27648
    s_waitcnt lgkmcnt(6)
    v_mfma_f32_16x16x32_bf16 v[172:175], a[192:195], a[188:191], v[172:175]
    ds_read_b64_tr_b16 a[212:213], v154 offset:25600
    ds_read_b64_tr_b16 a[214:215], v154 offset:27648
    v_mfma_f32_16x16x32_bf16 v[180:183], a[196:199], a[188:191], v[180:183]
    ds_read_b64_tr_b16 a[216:217], v155 offset:25600
    ds_read_b64_tr_b16 a[218:219], v155 offset:27648
    buffer_load_dword v21, v18, s[32:35], 0 offen sc1
    s_waitcnt lgkmcnt(6)
    v_mfma_f32_16x16x32_bf16 v[188:191], a[200:203], a[188:191], v[188:191]
    ds_read_b64_tr_b16 a[220:221], v156 offset:23552
    ds_read_b64_tr_b16 a[222:223], v156 offset:23808
    s_mov_b32 s55, 4194304
    buffer_load_dwordx4 a[176:179], v158, s[32:35], s55 offen sc1
    v_mfma_f32_16x16x32_bf16 v[192:195], a[204:207], a[228:231], v[192:195]
    ds_read_b64_tr_b16 a[192:193], v152 offset:32768
    ds_read_b64_tr_b16 a[194:195], v152 offset:34816
    v_mfma_f32_16x16x32_bf16 v[196:199], a[204:207], a[188:191], v[196:199]
    ds_read_b64_tr_b16 a[196:197], v153 offset:32768
    s_waitcnt lgkmcnt(7)
    v_mfma_f32_16x16x32_bf16 v[200:203], a[208:211], a[228:231], v[200:203]
    ds_read_b64_tr_b16 a[198:199], v153 offset:34816
    v_mfma_f32_16x16x32_bf16 v[204:207], a[208:211], a[188:191], v[204:207]
    ds_read_b64_tr_b16 a[200:201], v154 offset:32768
    buffer_load_dwordx4 a[180:183], v159, s[32:35], s55 offen sc1
    v_mfma_f32_16x16x32_bf16 v[208:211], a[212:215], a[228:231], v[208:211]
    ds_read_b64_tr_b16 a[202:203], v154 offset:34816
    v_mfma_f32_16x16x32_bf16 v[212:215], a[212:215], a[188:191], v[212:215]
    ds_read_b64_tr_b16 a[204:205], v155 offset:32768
    s_waitcnt lgkmcnt(7)
    v_mfma_f32_16x16x32_bf16 v[216:219], a[216:219], a[228:231], v[216:219]
    ds_read_b64_tr_b16 a[206:207], v155 offset:34816
    v_mfma_f32_16x16x32_bf16 v[220:223], a[216:219], a[188:191], v[220:223]
    ds_read_b64_tr_b16 a[208:209], v152 offset:33792
    s_add_u32 m0, s43, 98304
    s_mov_b32 s54, 589824
    buffer_load_dwordx4 v148, s[36:39], s54 offen offset:0 lds
    v_mfma_f32_16x16x32_bf16 v[224:227], a[220:223], a[228:231], v[224:227]
    ds_read_b64_tr_b16 a[210:211], v152 offset:35840
    v_mfma_f32_16x16x32_bf16 v[228:231], a[220:223], a[188:191], v[228:231]
    ds_read_b64_tr_b16 a[212:213], v153 offset:33792
    s_waitcnt lgkmcnt(7)
    v_mfma_f32_16x16x32_bf16 v[164:167], a[192:195], a[132:135], v[164:167]
    ds_read_b64_tr_b16 a[214:215], v153 offset:35840
    v_mfma_f32_16x16x32_bf16 v[172:175], a[196:199], a[132:135], v[172:175]
    ds_read_b64_tr_b16 a[216:217], v154 offset:33792
    ds_read_b64_tr_b16 a[218:219], v154 offset:35840
    buffer_load_dwordx4 v149, s[36:39], s54 offen offset:1024 lds
    s_waitcnt lgkmcnt(6)
    v_mfma_f32_16x16x32_bf16 v[180:183], a[200:203], a[132:135], v[180:183]
    ds_read_b64_tr_b16 a[220:221], v155 offset:33792
    ds_read_b64_tr_b16 a[222:223], v155 offset:35840
    v_mfma_f32_16x16x32_bf16 v[188:191], a[204:207], a[132:135], v[188:191]
    ds_read_b64_tr_b16 a[192:193], v156 offset:28672
    ds_read_b64_tr_b16 a[194:195], v156 offset:28928
    s_waitcnt lgkmcnt(6)
    v_mfma_f32_16x16x32_bf16 v[192:195], a[208:211], a[232:235], v[192:195]
    ds_read_b64_tr_b16 a[196:197], v152 offset:40960
    ds_read_b64_tr_b16 a[198:199], v152 offset:43008
    v_mfma_f32_16x16x32_bf16 v[196:199], a[208:211], a[132:135], v[196:199]
    ds_read_b64_tr_b16 a[200:201], v153 offset:40960
    s_mov_b32 s55, 4325376
    buffer_load_dwordx4 a[184:187], v158, s[32:35], s55 offen sc1
    v_mfma_f32_16x16x32_bf16 v[200:203], a[212:215], a[232:235], v[200:203]
    ds_read_b64_tr_b16 a[202:203], v153 offset:43008
    v_mfma_f32_16x16x32_bf16 v[204:207], a[212:215], a[132:135], v[204:207]
    ds_read_b64_tr_b16 a[204:205], v154 offset:40960
    s_waitcnt lgkmcnt(7)
    v_mfma_f32_16x16x32_bf16 v[208:211], a[216:219], a[232:235], v[208:211]
    ds_read_b64_tr_b16 a[206:207], v154 offset:43008
    v_mfma_f32_16x16x32_bf16 v[212:215], a[216:219], a[132:135], v[212:215]
    ds_read_b64_tr_b16 a[208:209], v155 offset:40960
    buffer_load_dwordx4 a[188:191], v159, s[32:35], s55 offen sc1
    v_mfma_f32_16x16x32_bf16 v[216:219], a[220:223], a[232:235], v[216:219]
    ds_read_b64_tr_b16 a[210:211], v155 offset:43008
    v_mfma_f32_16x16x32_bf16 v[220:223], a[220:223], a[132:135], v[220:223]
    ds_read_b64_tr_b16 a[212:213], v152 offset:41984
    s_waitcnt lgkmcnt(7)
    v_mfma_f32_16x16x32_bf16 v[224:227], a[192:195], a[232:235], v[224:227]
    ds_read_b64_tr_b16 a[214:215], v152 offset:44032
    v_mfma_f32_16x16x32_bf16 v[228:231], a[192:195], a[132:135], v[228:231]
    ds_read_b64_tr_b16 a[216:217], v153 offset:41984
    s_add_u32 m0, s43, 98304
    s_mov_b32 s54, 589824
    buffer_load_dwordx4 v150, s[36:39], s54 offen offset:2048 lds
    s_waitcnt vmcnt(26)
    v_mfma_f32_16x16x32_bf16 v[164:167], a[196:199], a[140:143], v[164:167]
    ds_read_b64_tr_b16 a[218:219], v153 offset:44032
    s_waitcnt lgkmcnt(6)
    v_mfma_f32_16x16x32_bf16 v[172:175], a[200:203], a[140:143], v[172:175]
    ds_read_b64_tr_b16 a[220:221], v154 offset:41984
    ds_read_b64_tr_b16 a[222:223], v154 offset:44032
    v_mfma_f32_16x16x32_bf16 v[180:183], a[204:207], a[140:143], v[180:183]
    ds_read_b64_tr_b16 a[192:193], v155 offset:41984
    ds_read_b64_tr_b16 a[194:195], v155 offset:44032
    s_waitcnt lgkmcnt(6)
    v_mfma_f32_16x16x32_bf16 v[188:191], a[208:211], a[140:143], v[188:191]
    ds_read_b64_tr_b16 a[196:197], v156 offset:29696
    ds_read_b64_tr_b16 a[198:199], v156 offset:29952
    buffer_load_dwordx4 v151, s[36:39], s54 offen offset:3072 lds
    v_mfma_f32_16x16x32_bf16 v[192:195], a[212:215], a[236:239], v[192:195]
    s_waitcnt vmcnt(17)
    s_barrier
    ds_read_b64_tr_b16 a[200:201], v152 offset:49152
    ds_read_b64_tr_b16 a[202:203], v152 offset:51200
    v_mfma_f32_16x16x32_bf16 v[196:199], a[212:215], a[140:143], v[196:199]
    ds_read_b64_tr_b16 a[204:205], v153 offset:49152
    s_waitcnt lgkmcnt(7)
    v_mfma_f32_16x16x32_bf16 v[200:203], a[216:219], a[236:239], v[200:203]
    ds_read_b64_tr_b16 a[206:207], v153 offset:51200
    v_mfma_f32_16x16x32_bf16 v[204:207], a[216:219], a[140:143], v[204:207]
    ds_read_b64_tr_b16 a[208:209], v154 offset:49152
    s_mov_b32 s55, 2097152
    buffer_load_dwordx4 a[128:131], v158, s[32:35], s55 offen sc1
    v_mfma_f32_16x16x32_bf16 v[208:211], a[220:223], a[236:239], v[208:211]
    ds_read_b64_tr_b16 a[210:211], v154 offset:51200
    v_mfma_f32_16x16x32_bf16 v[212:215], a[220:223], a[140:143], v[212:215]
    ds_read_b64_tr_b16 a[212:213], v155 offset:49152
    s_waitcnt lgkmcnt(7)
    v_mfma_f32_16x16x32_bf16 v[216:219], a[192:195], a[236:239], v[216:219]
    ds_read_b64_tr_b16 a[214:215], v155 offset:51200
    v_mfma_f32_16x16x32_bf16 v[220:223], a[192:195], a[140:143], v[220:223]
    ds_read_b64_tr_b16 a[216:217], v152 offset:50176
    buffer_load_dwordx4 a[132:135], v159, s[32:35], s55 offen sc1
    v_mfma_f32_16x16x32_bf16 v[224:227], a[196:199], a[236:239], v[224:227]
    ds_read_b64_tr_b16 a[218:219], v152 offset:52224
    v_mfma_f32_16x16x32_bf16 v[228:231], a[196:199], a[140:143], v[228:231]
    ds_read_b64_tr_b16 a[220:221], v153 offset:50176
    s_waitcnt lgkmcnt(7)
    v_mfma_f32_16x16x32_bf16 v[164:167], a[200:203], a[148:151], v[164:167]
    ds_read_b64_tr_b16 a[222:223], v153 offset:52224
    v_mfma_f32_16x16x32_bf16 v[172:175], a[204:207], a[148:151], v[172:175]
    ds_read_b64_tr_b16 a[192:193], v154 offset:50176
    ds_read_b64_tr_b16 a[194:195], v154 offset:52224
    s_add_u32 m0, s43, 0
    s_mov_b32 s54, 1253376
    buffer_load_dwordx4 v148, s[36:39], s54 offen offset:0 lds
    s_waitcnt lgkmcnt(6)
    v_mfma_f32_16x16x32_bf16 v[180:183], a[208:211], a[148:151], v[180:183]
    ds_read_b64_tr_b16 a[196:197], v155 offset:50176
    ds_read_b64_tr_b16 a[198:199], v155 offset:52224
    v_mfma_f32_16x16x32_bf16 v[188:191], a[212:215], a[148:151], v[188:191]
    ds_read_b64_tr_b16 a[200:201], v156 offset:32768
    ds_read_b64_tr_b16 a[202:203], v156 offset:33024
    s_waitcnt lgkmcnt(6)
    v_mfma_f32_16x16x32_bf16 v[192:195], a[216:219], a[240:243], v[192:195]
    ds_read_b64_tr_b16 a[204:205], v152 offset:57344
    ds_read_b64_tr_b16 a[206:207], v152 offset:59392
    v_mfma_f32_16x16x32_bf16 v[196:199], a[216:219], a[148:151], v[196:199]
    ds_read_b64_tr_b16 a[208:209], v153 offset:57344
    buffer_load_dwordx4 v149, s[36:39], s54 offen offset:1024 lds
    v_mfma_f32_16x16x32_bf16 v[200:203], a[220:223], a[240:243], v[200:203]
    ds_read_b64_tr_b16 a[210:211], v153 offset:59392
    v_mfma_f32_16x16x32_bf16 v[204:207], a[220:223], a[148:151], v[204:207]
    ds_read_b64_tr_b16 a[212:213], v154 offset:57344
    s_waitcnt lgkmcnt(7)
    v_mfma_f32_16x16x32_bf16 v[208:211], a[192:195], a[240:243], v[208:211]
    ds_read_b64_tr_b16 a[214:215], v154 offset:59392
    v_mfma_f32_16x16x32_bf16 v[212:215], a[192:195], a[148:151], v[212:215]
    ds_read_b64_tr_b16 a[216:217], v155 offset:57344
    s_mov_b32 s55, 2228224
    buffer_load_dwordx4 a[136:139], v158, s[32:35], s55 offen sc1
    v_mfma_f32_16x16x32_bf16 v[216:219], a[196:199], a[240:243], v[216:219]
    ds_read_b64_tr_b16 a[218:219], v155 offset:59392
    v_mfma_f32_16x16x32_bf16 v[220:223], a[196:199], a[148:151], v[220:223]
    ds_read_b64_tr_b16 a[220:221], v152 offset:58368
    s_waitcnt lgkmcnt(7)
    v_mfma_f32_16x16x32_bf16 v[224:227], a[200:203], a[240:243], v[224:227]
    ds_read_b64_tr_b16 a[222:223], v152 offset:60416
    v_mfma_f32_16x16x32_bf16 v[228:231], a[200:203], a[148:151], v[228:231]
    ds_read_b64_tr_b16 a[192:193], v153 offset:58368
    buffer_load_dwordx4 a[140:143], v159, s[32:35], s55 offen sc1
    v_mfma_f32_16x16x32_bf16 v[164:167], a[204:207], a[156:159], v[164:167]
    ds_read_b64_tr_b16 a[194:195], v153 offset:60416
    s_waitcnt lgkmcnt(6)
    v_mfma_f32_16x16x32_bf16 v[172:175], a[208:211], a[156:159], v[172:175]
    ds_read_b64_tr_b16 a[196:197], v154 offset:58368
    ds_read_b64_tr_b16 a[198:199], v154 offset:60416
    v_mfma_f32_16x16x32_bf16 v[180:183], a[212:215], a[156:159], v[180:183]
    ds_read_b64_tr_b16 a[200:201], v155 offset:58368
    ds_read_b64_tr_b16 a[202:203], v155 offset:60416
    s_waitcnt lgkmcnt(6)
    v_mfma_f32_16x16x32_bf16 v[188:191], a[216:219], a[156:159], v[188:191]
    ds_read_b64_tr_b16 a[204:205], v156 offset:33792
    ds_read_b64_tr_b16 a[206:207], v156 offset:34048
    s_add_u32 m0, s43, 0
    s_mov_b32 s54, 1253376
    buffer_load_dwordx4 v150, s[36:39], s54 offen offset:2048 lds
    v_mfma_f32_16x16x32_bf16 v[192:195], a[220:223], a[244:247], v[192:195]
    ds_read_b64_tr_b16 a[208:209], v236 offset:0
    ds_read_b64_tr_b16 a[210:211], v236 offset:2048
    v_mfma_f32_16x16x32_bf16 v[196:199], a[220:223], a[156:159], v[196:199]
    ds_read_b64_tr_b16 a[212:213], v237 offset:0
    s_waitcnt lgkmcnt(7)
    v_mfma_f32_16x16x32_bf16 v[200:203], a[192:195], a[244:247], v[200:203]
    ds_read_b64_tr_b16 a[214:215], v237 offset:2048
    v_mfma_f32_16x16x32_bf16 v[204:207], a[192:195], a[156:159], v[204:207]
    ds_read_b64_tr_b16 a[216:217], v238 offset:0
    buffer_load_dwordx4 v151, s[36:39], s54 offen offset:3072 lds
    v_mfma_f32_16x16x32_bf16 v[208:211], a[196:199], a[244:247], v[208:211]
    ds_read_b64_tr_b16 a[218:219], v238 offset:2048
    v_mfma_f32_16x16x32_bf16 v[212:215], a[196:199], a[156:159], v[212:215]
    ds_read_b64_tr_b16 a[220:221], v239 offset:0
    s_waitcnt lgkmcnt(7)
    v_mfma_f32_16x16x32_bf16 v[216:219], a[200:203], a[244:247], v[216:219]
    ds_read_b64_tr_b16 a[222:223], v239 offset:2048
    v_mfma_f32_16x16x32_bf16 v[220:223], a[200:203], a[156:159], v[220:223]
    ds_read_b64_tr_b16 a[192:193], v236 offset:1024
    s_mov_b32 s55, 4456448
    buffer_load_dwordx4 a[144:147], v158, s[32:35], s55 offen sc1
    v_mfma_f32_16x16x32_bf16 v[224:227], a[204:207], a[244:247], v[224:227]
    ds_read_b64_tr_b16 a[194:195], v236 offset:3072
    v_mfma_f32_16x16x32_bf16 v[228:231], a[204:207], a[156:159], v[228:231]
    ds_read_b64_tr_b16 a[196:197], v237 offset:1024
    s_waitcnt vmcnt(24) lgkmcnt(7)
    v_mfma_f32_16x16x32_bf16 v[164:167], a[208:211], a[164:167], v[164:167]
    ds_read_b64_tr_b16 a[198:199], v237 offset:3072
    v_mfma_f32_16x16x32_bf16 v[172:175], a[212:215], a[164:167], v[172:175]
    ds_read_b64_tr_b16 a[200:201], v238 offset:1024
    ds_read_b64_tr_b16 a[202:203], v238 offset:3072
    buffer_load_dwordx4 a[148:151], v159, s[32:35], s55 offen sc1
    s_waitcnt lgkmcnt(6)
    v_mfma_f32_16x16x32_bf16 v[180:183], a[216:219], a[164:167], v[180:183]
    ds_read_b64_tr_b16 a[204:205], v239 offset:1024
    ds_read_b64_tr_b16 a[206:207], v239 offset:3072
    v_mfma_f32_16x16x32_bf16 v[188:191], a[220:223], a[164:167], v[188:191]
    ds_read_b64_tr_b16 a[208:209], v156 offset:0
    ds_read_b64_tr_b16 a[210:211], v156 offset:256
    s_waitcnt lgkmcnt(6)
    v_mfma_f32_16x16x32_bf16 v[192:195], a[192:195], a[160:163], v[192:195]
    ds_read_b64_tr_b16 a[0:1], v236 offset:8192
    ds_read_b64_tr_b16 a[2:3], v236 offset:10240
    v_mfma_f32_16x16x32_bf16 v[196:199], a[192:195], a[164:167], v[196:199]
    ds_read_b64_tr_b16 a[4:5], v237 offset:8192
    s_mov_b32 s55, 4587520
    buffer_load_dwordx4 a[152:155], v158, s[32:35], s55 offen sc1
    v_mfma_f32_16x16x32_bf16 v[200:203], a[196:199], a[160:163], v[200:203]
    ds_read_b64_tr_b16 a[6:7], v237 offset:10240
    v_mfma_f32_16x16x32_bf16 v[204:207], a[196:199], a[164:167], v[204:207]
    ds_read_b64_tr_b16 a[8:9], v238 offset:8192
    s_waitcnt lgkmcnt(7)
    v_mfma_f32_16x16x32_bf16 v[208:211], a[200:203], a[160:163], v[208:211]
    ds_read_b64_tr_b16 a[10:11], v238 offset:10240
    v_mfma_f32_16x16x32_bf16 v[212:215], a[200:203], a[164:167], v[212:215]
    ds_read_b64_tr_b16 a[12:13], v239 offset:8192
    buffer_load_dwordx4 a[156:159], v159, s[32:35], s55 offen sc1
    v_mfma_f32_16x16x32_bf16 v[216:219], a[204:207], a[160:163], v[216:219]
    ds_read_b64_tr_b16 a[14:15], v239 offset:10240
    v_mfma_f32_16x16x32_bf16 v[220:223], a[204:207], a[164:167], v[220:223]
    ds_read_b64_tr_b16 a[196:197], v236 offset:9216
    s_waitcnt lgkmcnt(7)
    v_mfma_f32_16x16x32_bf16 v[224:227], a[208:211], a[160:163], v[224:227]
    ds_read_b64_tr_b16 a[198:199], v236 offset:11264
    v_mfma_f32_16x16x32_bf16 v[228:231], a[208:211], a[164:167], v[228:231]
    s_waitcnt vmcnt(20)
    v_cmp_ne_u32 vcc, 16, v21
    s_nop 0
    s_cbranch_vccnz mk_SL_AC
mk_BK_AC:
    ds_read_b64_tr_b16 a[200:201], v237 offset:9216
    s_mov_b32 m0, s7
    s_nop 0
    buffer_load_dwordx4 v12, s[32:35], 0 offen sc1 lds
    v_mfma_f32_16x16x32_bf16 v[164:167], a[0:3], a[172:175], v[164:167]
    ds_read_b64_tr_b16 a[202:203], v237 offset:11264
    s_waitcnt lgkmcnt(6)
    v_mfma_f32_16x16x32_bf16 v[172:175], a[4:7], a[172:175], v[172:175]
    ds_read_b64_tr_b16 a[204:205], v238 offset:9216
    ds_read_b64_tr_b16 a[206:207], v238 offset:11264
    v_mfma_f32_16x16x32_bf16 v[180:183], a[8:11], a[172:175], v[180:183]
    ds_read_b64_tr_b16 a[208:209], v239 offset:9216
    ds_read_b64_tr_b16 a[210:211], v239 offset:11264
    buffer_load_dwordx4 v12, s[32:35], s46 offen offset:1024 sc1 lds
    s_waitcnt lgkmcnt(6)
    v_mfma_f32_16x16x32_bf16 v[188:191], a[12:15], a[172:175], v[188:191]
    ds_read_b64_tr_b16 a[212:213], v156 offset:1024
    ds_read_b64_tr_b16 a[214:215], v156 offset:1280
    v_mfma_f32_16x16x32_bf16 v[192:195], a[196:199], a[168:171], v[192:195]
    s_waitcnt vmcnt(14)
    s_barrier
    ds_read_b64_tr_b16 a[16:17], v236 offset:16384
    ds_read_b64_tr_b16 a[18:19], v236 offset:18432
    v_mfma_f32_16x16x32_bf16 v[196:199], a[196:199], a[172:175], v[196:199]
    ds_read_b64_tr_b16 a[20:21], v237 offset:16384
    buffer_load_dwordx4 v13, s[32:35], 0 offen offset:2048 sc1 lds
    s_waitcnt lgkmcnt(7)
    v_mfma_f32_16x16x32_bf16 v[200:203], a[200:203], a[168:171], v[200:203]
    ds_read_b64_tr_b16 a[22:23], v237 offset:18432
    v_mfma_f32_16x16x32_bf16 v[204:207], a[200:203], a[172:175], v[204:207]
    ds_read_b64_tr_b16 a[24:25], v238 offset:16384
    v_mfma_f32_16x16x32_bf16 v[208:211], a[204:207], a[168:171], v[208:211]
    ds_read_b64_tr_b16 a[26:27], v238 offset:18432
    buffer_load_dword v22, v10, s[32:35], 0 offen sc1
    v_mfma_f32_16x16x32_bf16 v[212:215], a[204:207], a[172:175], v[212:215]
    ds_read_b64_tr_b16 a[28:29], v239 offset:16384
    buffer_load_dword v23, v11, s[32:35], 0 offen sc1
    s_waitcnt lgkmcnt(7)
    v_mfma_f32_16x16x32_bf16 v[216:219], a[208:211], a[168:171], v[216:219]
    ds_read_b64_tr_b16 a[30:31], v239 offset:18432
    v_mfma_f32_16x16x32_bf16 v[220:223], a[208:211], a[172:175], v[220:223]
    ds_read_b64_tr_b16 a[200:201], v236 offset:17408
    v_mfma_f32_16x16x32_bf16 v[224:227], a[212:215], a[168:171], v[224:227]
    ds_read_b64_tr_b16 a[202:203], v236 offset:19456
    v_mfma_f32_16x16x32_bf16 v[228:231], a[212:215], a[172:175], v[228:231]
    ds_read_b64_tr_b16 a[204:205], v237 offset:17408
    s_waitcnt lgkmcnt(7)
    v_mfma_f32_16x16x32_bf16 v[164:167], a[16:19], a[180:183], v[164:167]
    ds_read_b64_tr_b16 a[206:207], v237 offset:19456
    v_mfma_f32_16x16x32_bf16 v[172:175], a[20:23], a[180:183], v[172:175]
    ds_read_b64_tr_b16 a[208:209], v238 offset:17408
    ds_read_b64_tr_b16 a[210:211], v238 offset:19456
    s_waitcnt lgkmcnt(6)
    v_mfma_f32_16x16x32_bf16 v[180:183], a[24:27], a[180:183], v[180:183]
    ds_read_b64_tr_b16 a[212:213], v239 offset:17408
    ds_read_b64_tr_b16 a[214:215], v239 offset:19456
    v_mfma_f32_16x16x32_bf16 v[188:191], a[28:31], a[180:183], v[188:191]
    ds_read_b64_tr_b16 a[216:217], v156 offset:4096
    ds_read_b64_tr_b16 a[218:219], v156 offset:4352
    s_waitcnt lgkmcnt(6)
    v_mfma_f32_16x16x32_bf16 v[192:195], a[200:203], a[176:179], v[192:195]
    ds_read_b64_tr_b16 a[32:33], v236 offset:24576
    ds_read_b64_tr_b16 a[34:35], v236 offset:26624
    v_mfma_f32_16x16x32_bf16 v[196:199], a[200:203], a[180:183], v[196:199]
    ds_read_b64_tr_b16 a[36:37], v237 offset:24576
    v_mfma_f32_16x16x32_bf16 v[200:203], a[204:207], a[176:179], v[200:203]
    ds_read_b64_tr_b16 a[38:39], v237 offset:26624
    v_mfma_f32_16x16x32_bf16 v[204:207], a[204:207], a[180:183], v[204:207]
    ds_read_b64_tr_b16 a[40:41], v238 offset:24576
    s_waitcnt lgkmcnt(7)
    v_mfma_f32_16x16x32_bf16 v[208:211], a[208:211], a[176:179], v[208:211]
    ds_read_b64_tr_b16 a[42:43], v238 offset:26624
    v_mfma_f32_16x16x32_bf16 v[212:215], a[208:211], a[180:183], v[212:215]
    ds_read_b64_tr_b16 a[44:45], v239 offset:24576
    v_mfma_f32_16x16x32_bf16 v[216:219], a[212:215], a[176:179], v[216:219]
    ds_read_b64_tr_b16 a[46:47], v239 offset:26624
    v_mfma_f32_16x16x32_bf16 v[220:223], a[212:215], a[180:183], v[220:223]
    ds_read_b64_tr_b16 a[204:205], v236 offset:25600
    s_waitcnt lgkmcnt(7)
    v_mfma_f32_16x16x32_bf16 v[224:227], a[216:219], a[176:179], v[224:227]
    ds_read_b64_tr_b16 a[206:207], v236 offset:27648
    v_mfma_f32_16x16x32_bf16 v[228:231], a[216:219], a[180:183], v[228:231]
    ds_read_b64_tr_b16 a[208:209], v237 offset:25600
    v_mfma_f32_16x16x32_bf16 v[164:167], a[32:35], a[188:191], v[164:167]
    ds_read_b64_tr_b16 a[210:211], v237 offset:27648
    s_waitcnt lgkmcnt(6)
    v_mfma_f32_16x16x32_bf16 v[172:175], a[36:39], a[188:191], v[172:175]
    ds_read_b64_tr_b16 a[212:213], v238 offset:25600
    ds_read_b64_tr_b16 a[214:215], v238 offset:27648
    v_mfma_f32_16x16x32_bf16 v[180:183], a[40:43], a[188:191], v[180:183]
    ds_read_b64_tr_b16 a[216:217], v239 offset:25600
    ds_read_b64_tr_b16 a[218:219], v239 offset:27648
    s_waitcnt lgkmcnt(6)
    v_mfma_f32_16x16x32_bf16 v[188:191], a[44:47], a[188:191], v[188:191]
    ds_read_b64_tr_b16 a[220:221], v156 offset:5120
    ds_read_b64_tr_b16 a[222:223], v156 offset:5376
    v_mfma_f32_16x16x32_bf16 v[192:195], a[204:207], a[184:187], v[192:195]
    ds_read_b64_tr_b16 a[48:49], v236 offset:32768
    ds_read_b64_tr_b16 a[50:51], v236 offset:34816
    v_mfma_f32_16x16x32_bf16 v[196:199], a[204:207], a[188:191], v[196:199]
    ds_read_b64_tr_b16 a[52:53], v237 offset:32768
    s_waitcnt lgkmcnt(7)
    v_mfma_f32_16x16x32_bf16 v[200:203], a[208:211], a[184:187], v[200:203]
    ds_read_b64_tr_b16 a[54:55], v237 offset:34816
    v_mfma_f32_16x16x32_bf16 v[204:207], a[208:211], a[188:191], v[204:207]
    ds_read_b64_tr_b16 a[56:57], v238 offset:32768
    v_mfma_f32_16x16x32_bf16 v[208:211], a[212:215], a[184:187], v[208:211]
    ds_read_b64_tr_b16 a[58:59], v238 offset:34816
    v_mfma_f32_16x16x32_bf16 v[212:215], a[212:215], a[188:191], v[212:215]
    ds_read_b64_tr_b16 a[60:61], v239 offset:32768
    s_waitcnt lgkmcnt(7)
    v_mfma_f32_16x16x32_bf16 v[216:219], a[216:219], a[184:187], v[216:219]
    ds_read_b64_tr_b16 a[62:63], v239 offset:34816
    v_mfma_f32_16x16x32_bf16 v[220:223], a[216:219], a[188:191], v[220:223]
    ds_read_b64_tr_b16 a[208:209], v236 offset:33792
    v_mfma_f32_16x16x32_bf16 v[224:227], a[220:223], a[184:187], v[224:227]
    ds_read_b64_tr_b16 a[210:211], v236 offset:35840
    v_mfma_f32_16x16x32_bf16 v[228:231], a[220:223], a[188:191], v[228:231]
    ds_read_b64_tr_b16 a[212:213], v237 offset:33792
    s_waitcnt vmcnt(15) lgkmcnt(7)
    v_mfma_f32_16x16x32_bf16 v[164:167], a[48:51], a[132:135], v[164:167]
    ds_read_b64_tr_b16 a[214:215], v237 offset:35840
    v_mfma_f32_16x16x32_bf16 v[172:175], a[52:55], a[132:135], v[172:175]
    ds_read_b64_tr_b16 a[216:217], v238 offset:33792
    ds_read_b64_tr_b16 a[218:219], v238 offset:35840
    s_waitcnt lgkmcnt(6)
    v_mfma_f32_16x16x32_bf16 v[180:183], a[56:59], a[132:135], v[180:183]
    ds_read_b64_tr_b16 a[220:221], v239 offset:33792
    ds_read_b64_tr_b16 a[222:223], v239 offset:35840
    v_mfma_f32_16x16x32_bf16 v[188:191], a[60:63], a[132:135], v[188:191]
    ds_read_b64_tr_b16 a[192:193], v156 offset:24576
    ds_read_b64_tr_b16 a[194:195], v156 offset:24832
    s_waitcnt lgkmcnt(6)
    v_mfma_f32_16x16x32_bf16 v[192:195], a[208:211], a[128:131], v[192:195]
    ds_read_b64_tr_b16 a[64:65], v236 offset:40960
    ds_read_b64_tr_b16 a[66:67], v236 offset:43008
    v_mfma_f32_16x16x32_bf16 v[196:199], a[208:211], a[132:135], v[196:199]
    ds_read_b64_tr_b16 a[68:69], v237 offset:40960
    v_mfma_f32_16x16x32_bf16 v[200:203], a[212:215], a[128:131], v[200:203]
    ds_read_b64_tr_b16 a[70:71], v237 offset:43008
    v_mfma_f32_16x16x32_bf16 v[204:207], a[212:215], a[132:135], v[204:207]
    ds_read_b64_tr_b16 a[72:73], v238 offset:40960
    s_waitcnt lgkmcnt(7)
    v_mfma_f32_16x16x32_bf16 v[208:211], a[216:219], a[128:131], v[208:211]
    ds_read_b64_tr_b16 a[74:75], v238 offset:43008
    v_mfma_f32_16x16x32_bf16 v[212:215], a[216:219], a[132:135], v[212:215]
    ds_read_b64_tr_b16 a[76:77], v239 offset:40960
    v_mfma_f32_16x16x32_bf16 v[216:219], a[220:223], a[128:131], v[216:219]
    ds_read_b64_tr_b16 a[78:79], v239 offset:43008
    v_mfma_f32_16x16x32_bf16 v[220:223], a[220:223], a[132:135], v[220:223]
    ds_read_b64_tr_b16 a[212:213], v236 offset:41984
    s_waitcnt lgkmcnt(7)
    v_mfma_f32_16x16x32_bf16 v[224:227], a[192:195], a[128:131], v[224:227]
    ds_read_b64_tr_b16 a[214:215], v236 offset:44032
    v_mfma_f32_16x16x32_bf16 v[228:231], a[192:195], a[132:135], v[228:231]
    ds_read_b64_tr_b16 a[216:217], v237 offset:41984
    s_waitcnt vmcnt(11)
    v_mfma_f32_16x16x32_bf16 v[164:167], a[64:67], a[140:143], v[164:167]
    ds_read_b64_tr_b16 a[218:219], v237 offset:44032
    s_waitcnt lgkmcnt(6)
    v_mfma_f32_16x16x32_bf16 v[172:175], a[68:71], a[140:143], v[172:175]
    ds_read_b64_tr_b16 a[220:221], v238 offset:41984
    ds_read_b64_tr_b16 a[222:223], v238 offset:44032
    v_mfma_f32_16x16x32_bf16 v[180:183], a[72:75], a[140:143], v[180:183]
    ds_read_b64_tr_b16 a[192:193], v239 offset:41984
    ds_read_b64_tr_b16 a[194:195], v239 offset:44032
    s_waitcnt lgkmcnt(6)
    v_mfma_f32_16x16x32_bf16 v[188:191], a[76:79], a[140:143], v[188:191]
    ds_read_b64_tr_b16 a[196:197], v156 offset:25600
    ds_read_b64_tr_b16 a[198:199], v156 offset:25856
    v_mfma_f32_16x16x32_bf16 v[192:195], a[212:215], a[136:139], v[192:195]
    s_waitcnt vmcnt(9)
    s_barrier
    ds_read_b64_tr_b16 a[80:81], v152 offset:0
    ds_read_b64_tr_b16 a[82:83], v152 offset:2048
    v_mfma_f32_16x16x32_bf16 v[196:199], a[212:215], a[140:143], v[196:199]
    ds_read_b64_tr_b16 a[84:85], v153 offset:0
    s_waitcnt lgkmcnt(7)
    v_mfma_f32_16x16x32_bf16 v[200:203], a[216:219], a[136:139], v[200:203]
    ds_read_b64_tr_b16 a[86:87], v153 offset:2048
    v_mfma_f32_16x16x32_bf16 v[204:207], a[216:219], a[140:143], v[204:207]
    ds_read_b64_tr_b16 a[88:89], v154 offset:0
    v_mfma_f32_16x16x32_bf16 v[208:211], a[220:223], a[136:139], v[208:211]
    ds_read_b64_tr_b16 a[90:91], v154 offset:2048
    v_mfma_f32_16x16x32_bf16 v[212:215], a[220:223], a[140:143], v[212:215]
    ds_read_b64_tr_b16 a[92:93], v155 offset:0
    s_waitcnt lgkmcnt(7)
    v_mfma_f32_16x16x32_bf16 v[216:219], a[192:195], a[136:139], v[216:219]
    ds_read_b64_tr_b16 a[94:95], v155 offset:2048
    v_mfma_f32_16x16x32_bf16 v[220:223], a[192:195], a[140:143], v[220:223]
    ds_read_b64_tr_b16 a[216:217], v152 offset:1024
    v_mfma_f32_16x16x32_bf16 v[224:227], a[196:199], a[136:139], v[224:227]
    ds_read_b64_tr_b16 a[218:219], v152 offset:3072
    v_mfma_f32_16x16x32_bf16 v[228:231], a[196:199], a[140:143], v[228:231]
    ds_read_b64_tr_b16 a[220:221], v153 offset:1024
    s_waitcnt vmcnt(7) lgkmcnt(7)
    v_mfma_f32_16x16x32_bf16 v[164:167], a[80:83], a[148:151], v[164:167]
    ds_read_b64_tr_b16 a[222:223], v153 offset:3072
    v_mfma_f32_16x16x32_bf16 v[172:175], a[84:87], a[148:151], v[172:175]
    ds_read_b64_tr_b16 a[192:193], v154 offset:1024
    ds_read_b64_tr_b16 a[194:195], v154 offset:3072
    s_waitcnt lgkmcnt(6)
    v_mfma_f32_16x16x32_bf16 v[180:183], a[88:91], a[148:151], v[180:183]
    ds_read_b64_tr_b16 a[196:197], v155 offset:1024
    ds_read_b64_tr_b16 a[198:199], v155 offset:3072
    v_mfma_f32_16x16x32_bf16 v[188:191], a[92:95], a[148:151], v[188:191]
    ds_read_b64_tr_b16 a[200:201], v156 offset:6144
    ds_read_b64_tr_b16 a[202:203], v156 offset:6400
    s_waitcnt lgkmcnt(6)
    v_mfma_f32_16x16x32_bf16 v[192:195], a[216:219], a[144:147], v[192:195]
    ds_read_b64_tr_b16 a[96:97], v152 offset:8192
    ds_read_b64_tr_b16 a[98:99], v152 offset:10240
    v_mfma_f32_16x16x32_bf16 v[196:199], a[216:219], a[148:151], v[196:199]
    ds_read_b64_tr_b16 a[100:101], v153 offset:8192
    v_mfma_f32_16x16x32_bf16 v[200:203], a[220:223], a[144:147], v[200:203]
    ds_read_b64_tr_b16 a[102:103], v153 offset:10240
    v_mfma_f32_16x16x32_bf16 v[204:207], a[220:223], a[148:151], v[204:207]
    ds_read_b64_tr_b16 a[104:105], v154 offset:8192
    s_waitcnt lgkmcnt(7)
    v_mfma_f32_16x16x32_bf16 v[208:211], a[192:195], a[144:147], v[208:211]
    ds_read_b64_tr_b16 a[106:107], v154 offset:10240
    v_mfma_f32_16x16x32_bf16 v[212:215], a[192:195], a[148:151], v[212:215]
    ds_read_b64_tr_b16 a[108:109], v155 offset:8192
    v_mfma_f32_16x16x32_bf16 v[216:219], a[196:199], a[144:147], v[216:219]
    ds_read_b64_tr_b16 a[110:111], v155 offset:10240
    v_mfma_f32_16x16x32_bf16 v[220:223], a[196:199], a[148:151], v[220:223]
    ds_read_b64_tr_b16 a[220:221], v152 offset:9216
    s_waitcnt lgkmcnt(7)
    v_mfma_f32_16x16x32_bf16 v[224:227], a[200:203], a[144:147], v[224:227]
    ds_read_b64_tr_b16 a[222:223], v152 offset:11264
    v_mfma_f32_16x16x32_bf16 v[228:231], a[200:203], a[148:151], v[228:231]
    ds_read_b64_tr_b16 a[192:193], v153 offset:9216
    s_waitcnt vmcnt(5)
    v_mfma_f32_16x16x32_bf16 v[164:167], a[96:99], a[156:159], v[164:167]
    ds_read_b64_tr_b16 a[194:195], v153 offset:11264
    s_waitcnt lgkmcnt(6)
    v_mfma_f32_16x16x32_bf16 v[172:175], a[100:103], a[156:159], v[172:175]
    ds_read_b64_tr_b16 a[196:197], v154 offset:9216
    ds_read_b64_tr_b16 a[198:199], v154 offset:11264
    v_mfma_f32_16x16x32_bf16 v[180:183], a[104:107], a[156:159], v[180:183]
    ds_read_b64_tr_b16 a[200:201], v155 offset:9216
    ds_read_b64_tr_b16 a[202:203], v155 offset:11264
    s_waitcnt lgkmcnt(6)
    v_mfma_f32_16x16x32_bf16 v[188:191], a[108:111], a[156:159], v[188:191]
    ds_read_b64_tr_b16 a[204:205], v156 offset:7168
    ds_read_b64_tr_b16 a[206:207], v156 offset:7424
    v_mfma_f32_16x16x32_bf16 v[192:195], a[220:223], a[152:155], v[192:195]
    v_mfma_f32_16x16x32_bf16 v[196:199], a[220:223], a[156:159], v[196:199]
    v_cvt_pk_bf16_f32 v64, v164, v165
    v_cvt_pk_bf16_f32 v66, v172, v173
    v_cvt_pk_bf16_f32 v65, v166, v167
    s_waitcnt lgkmcnt(4)
    v_mfma_f32_16x16x32_bf16 v[200:203], a[192:195], a[152:155], v[200:203]
    v_cvt_pk_bf16_f32 v67, v174, v175
    v_cvt_pk_bf16_f32 v68, v180, v181
    v_cvt_pk_bf16_f32 v70, v188, v189
    v_mfma_f32_16x16x32_bf16 v[204:207], a[192:195], a[156:159], v[204:207]
    v_cvt_pk_bf16_f32 v69, v182, v183
    v_cvt_pk_bf16_f32 v71, v190, v191
    v_permlane16_swap_b32 v64, v66
    v_mfma_f32_16x16x32_bf16 v[208:211], a[196:199], a[152:155], v[208:211]
    v_permlane16_swap_b32 v65, v67
    v_min_u32 v64, -2, v64
    v_min_u32 v65, -2, v65
    v_mfma_f32_16x16x32_bf16 v[212:215], a[196:199], a[156:159], v[212:215]
    v_min_u32 v66, -2, v66
    v_min_u32 v67, -2, v67
    buffer_store_dwordx4 v[64:67], v232, s[32:35], s17 offen offset:0 sc1
    s_waitcnt lgkmcnt(0)
    v_mfma_f32_16x16x32_bf16 v[216:219], a[200:203], a[152:155], v[216:219]
    v_cvt_pk_bf16_f32 v72, v192, v193
    v_cvt_pk_bf16_f32 v74, v200, v201
    v_cvt_pk_bf16_f32 v73, v194, v195
    v_mfma_f32_16x16x32_bf16 v[220:223], a[200:203], a[156:159], v[220:223]
    v_cvt_pk_bf16_f32 v75, v202, v203
    v_permlane16_swap_b32 v68, v70
    v_permlane16_swap_b32 v69, v71
    v_mfma_f32_16x16x32_bf16 v[224:227], a[204:207], a[152:155], v[224:227]
    v_min_u32 v68, -2, v68
    v_min_u32 v69, -2, v69
    v_min_u32 v70, -2, v70
    v_mfma_f32_16x16x32_bf16 v[228:231], a[204:207], a[156:159], v[228:231]
    v_min_u32 v71, -2, v71
    buffer_store_dwordx4 v[68:71], v232, s[32:35], s17 offen offset:1024 sc1
    v_cvt_pk_bf16_f32 v76, v196, v197
    v_mfma_f32_16x16x32_bf16 v[160:163], a[0:3], a[168:171], v[160:163]
    v_cvt_pk_bf16_f32 v78, v204, v205
    v_cvt_pk_bf16_f32 v77, v198, v199
    v_cvt_pk_bf16_f32 v79, v206, v207
    v_mfma_f32_16x16x32_bf16 v[168:171], a[4:7], a[168:171], v[168:171]
    v_permlane16_swap_b32 v72, v74
    v_permlane16_swap_b32 v73, v75
    v_min_u32 v72, -2, v72
    v_mfma_f32_16x16x32_bf16 v[176:179], a[8:11], a[168:171], v[176:179]
    v_min_u32 v73, -2, v73
    v_min_u32 v74, -2, v74
    v_min_u32 v75, -2, v75
    v_mfma_f32_16x16x32_bf16 v[184:187], a[12:15], a[168:171], v[184:187]
    buffer_store_dwordx4 v[72:75], v232, s[32:35], s16 offen offset:0 sc1
    v_cvt_pk_bf16_f32 v80, v208, v209
    v_cvt_pk_bf16_f32 v82, v216, v217
    v_mfma_f32_16x16x32_bf16 v[160:163], a[16:19], a[176:179], v[160:163]
    v_cvt_pk_bf16_f32 v81, v210, v211
    v_cvt_pk_bf16_f32 v83, v218, v219
    v_permlane16_swap_b32 v76, v78
    v_mfma_f32_16x16x32_bf16 v[168:171], a[20:23], a[176:179], v[168:171]
    v_permlane16_swap_b32 v77, v79
    v_min_u32 v76, -2, v76
    v_min_u32 v77, -2, v77
    v_mfma_f32_16x16x32_bf16 v[176:179], a[24:27], a[176:179], v[176:179]
    v_min_u32 v78, -2, v78
    v_min_u32 v79, -2, v79
    buffer_store_dwordx4 v[76:79], v232, s[32:35], s18 offen offset:0 sc1
    v_mfma_f32_16x16x32_bf16 v[184:187], a[28:31], a[176:179], v[184:187]
    v_cvt_pk_bf16_f32 v84, v212, v213
    v_cvt_pk_bf16_f32 v86, v220, v221
    v_cvt_pk_bf16_f32 v85, v214, v215
    v_mfma_f32_16x16x32_bf16 v[160:163], a[32:35], a[184:187], v[160:163]
    v_cvt_pk_bf16_f32 v87, v222, v223
    v_permlane16_swap_b32 v80, v82
    v_permlane16_swap_b32 v81, v83
    v_mfma_f32_16x16x32_bf16 v[168:171], a[36:39], a[184:187], v[168:171]
    v_min_u32 v80, -2, v80
    v_min_u32 v81, -2, v81
    v_min_u32 v82, -2, v82
    v_mfma_f32_16x16x32_bf16 v[176:179], a[40:43], a[184:187], v[176:179]
    v_min_u32 v83, -2, v83
    buffer_store_dwordx4 v[80:83], v232, s[32:35], s16 offen offset:1024 sc1
    v_cvt_pk_bf16_f32 v88, v224, v225
    v_mfma_f32_16x16x32_bf16 v[184:187], a[44:47], a[184:187], v[184:187]
    v_cvt_pk_bf16_f32 v90, v228, v229
    v_cvt_pk_bf16_f32 v89, v226, v227
    v_cvt_pk_bf16_f32 v91, v230, v231
    v_mfma_f32_16x16x32_bf16 v[160:163], a[48:51], a[128:131], v[160:163]
    v_permlane16_swap_b32 v84, v86
    v_permlane16_swap_b32 v85, v87
    v_min_u32 v84, -2, v84
    v_mfma_f32_16x16x32_bf16 v[168:171], a[52:55], a[128:131], v[168:171]
    v_min_u32 v85, -2, v85
    v_min_u32 v86, -2, v86
    v_min_u32 v87, -2, v87
    v_mfma_f32_16x16x32_bf16 v[176:179], a[56:59], a[128:131], v[176:179]
    buffer_store_dwordx4 v[84:87], v232, s[32:35], s18 offen offset:1024 sc1
    v_permlane16_swap_b32 v88, v90
    v_permlane16_swap_b32 v89, v91
    v_mfma_f32_16x16x32_bf16 v[184:187], a[60:63], a[128:131], v[184:187]
    v_min_u32 v88, -2, v88
    v_min_u32 v89, -2, v89
    v_min_u32 v90, -2, v90
    v_mfma_f32_16x16x32_bf16 v[160:163], a[64:67], a[136:139], v[160:163]
    v_min_u32 v91, -2, v91
    buffer_store_dwordx4 v[88:91], v16, s[32:35], 0 offen offset:0 sc1
    v_mfma_f32_16x16x32_bf16 v[168:171], a[68:71], a[136:139], v[168:171]
    v_mfma_f32_16x16x32_bf16 v[176:179], a[72:75], a[136:139], v[176:179]
    v_mfma_f32_16x16x32_bf16 v[184:187], a[76:79], a[136:139], v[184:187]
    v_mfma_f32_16x16x32_bf16 v[160:163], a[80:83], a[144:147], v[160:163]
    v_mfma_f32_16x16x32_bf16 v[168:171], a[84:87], a[144:147], v[168:171]
    v_mfma_f32_16x16x32_bf16 v[176:179], a[88:91], a[144:147], v[176:179]
    v_mfma_f32_16x16x32_bf16 v[184:187], a[92:95], a[144:147], v[184:187]
    v_mfma_f32_16x16x32_bf16 v[160:163], a[96:99], a[152:155], v[160:163]
    v_mfma_f32_16x16x32_bf16 v[168:171], a[100:103], a[152:155], v[168:171]
    v_mfma_f32_16x16x32_bf16 v[176:179], a[104:107], a[152:155], v[176:179]
    v_mfma_f32_16x16x32_bf16 v[184:187], a[108:111], a[152:155], v[184:187]
    ds_read_b64_tr_b16 a[0:1], v152 offset:16384
    ds_read_b64_tr_b16 a[2:3], v152 offset:18432
    ds_read_b64_tr_b16 a[4:5], v153 offset:16384
    ds_read_b64_tr_b16 a[6:7], v153 offset:18432
    ds_read_b64_tr_b16 a[8:9], v154 offset:16384
    ds_read_b64_tr_b16 a[10:11], v154 offset:18432
    ds_read_b64_tr_b16 a[12:13], v155 offset:16384
    ds_read_b64_tr_b16 a[14:15], v155 offset:18432
    s_waitcnt lgkmcnt(6)
    v_mfma_f32_16x16x32_bf16 v[160:163], a[0:3], a[224:227], v[160:163]
    ds_read_b64_tr_b16 a[16:17], v152 offset:24576
    ds_read_b64_tr_b16 a[18:19], v152 offset:26624
    v_lshrrev_b32 v128, 4, v232
    s_mul_i32 s63, s2, 28672
    s_waitcnt lgkmcnt(6)
    v_mfma_f32_16x16x32_bf16 v[168:171], a[4:7], a[224:227], v[168:171]
    ds_read_b64_tr_b16 a[20:21], v153 offset:24576
    ds_read_b64_tr_b16 a[22:23], v153 offset:26624
    s_add_u32 s63, s63, 25452544
    s_cmp_eq_u32 s12, 0
    s_waitcnt lgkmcnt(6)
    v_mfma_f32_16x16x32_bf16 v[176:179], a[8:11], a[224:227], v[176:179]
    ds_read_b64_tr_b16 a[24:25], v154 offset:24576
    ds_read_b64_tr_b16 a[26:27], v154 offset:26624
    s_cselect_b32 s63, s63, 2130706432
    s_cselect_b32 s13, 0, 2130706432
    s_waitcnt lgkmcnt(6)
    v_mfma_f32_16x16x32_bf16 v[184:187], a[12:15], a[224:227], v[184:187]
    ds_read_b64_tr_b16 a[28:29], v155 offset:24576
    ds_read_b64_tr_b16 a[30:31], v155 offset:26624
    v_add_u32 v17, s63, v17
    v_lshl_add_u32 v14, v128, 3, s7
    s_waitcnt lgkmcnt(6)
    v_mfma_f32_16x16x32_bf16 v[160:163], a[16:19], a[228:231], v[160:163]
    ds_read_b64_tr_b16 a[32:33], v152 offset:32768
    ds_read_b64_tr_b16 a[34:35], v152 offset:34816
    v_lshrrev_b32 v132, 2, v128
    v_and_b32 v130, 3, v128
    s_waitcnt lgkmcnt(6)
    v_mfma_f32_16x16x32_bf16 v[168:171], a[20:23], a[228:231], v[168:171]
    ds_read_b64_tr_b16 a[36:37], v153 offset:32768
    ds_read_b64_tr_b16 a[38:39], v153 offset:34816
    v_lshlrev_b32 v130, 3, v130
    v_lshl_add_u32 v130, v132, 6, v130
    s_waitcnt lgkmcnt(6)
    v_mfma_f32_16x16x32_bf16 v[176:179], a[24:27], a[228:231], v[176:179]
    ds_read_b64_tr_b16 a[40:41], v154 offset:32768
    ds_read_b64_tr_b16 a[42:43], v154 offset:34816
    s_add_u32 s60, s7, 2048
    v_add_u32 v15, s60, v130
    s_waitcnt lgkmcnt(6)
    v_mfma_f32_16x16x32_bf16 v[184:187], a[28:31], a[228:231], v[184:187]
    ds_read_b64_tr_b16 a[44:45], v155 offset:32768
    ds_read_b64_tr_b16 a[46:47], v155 offset:34816
    s_waitcnt vmcnt(7)
    ds_read_b64_tr_b16 v[26:27], v14 offset:0
    s_waitcnt lgkmcnt(7)
    v_mfma_f32_16x16x32_bf16 v[160:163], a[32:35], a[232:235], v[160:163]
    ds_read_b64_tr_b16 a[48:49], v152 offset:40960
    ds_read_b64_tr_b16 a[50:51], v152 offset:43008
    ds_read_b64_tr_b16 v[28:29], v14 offset:512
    ds_read_b64_tr_b16 v[30:31], v14 offset:1024
    s_waitcnt lgkmcnt(9)
    v_mfma_f32_16x16x32_bf16 v[168:171], a[36:39], a[232:235], v[168:171]
    ds_read_b64_tr_b16 a[52:53], v153 offset:40960
    ds_read_b64_tr_b16 a[54:55], v153 offset:43008
    ds_read_b64_tr_b16 v[32:33], v14 offset:1536
    ds_read_b64_tr_b16 v[34:35], v15 offset:0
    s_waitcnt lgkmcnt(11)
    v_mfma_f32_16x16x32_bf16 v[176:179], a[40:43], a[232:235], v[176:179]
    ds_read_b64_tr_b16 a[56:57], v154 offset:40960
    ds_read_b64_tr_b16 a[58:59], v154 offset:43008
    ds_read_b64_tr_b16 v[36:37], v15 offset:32
    v_sub_f32 v24, 1.0, v22
    s_waitcnt lgkmcnt(12)
    v_mfma_f32_16x16x32_bf16 v[184:187], a[44:47], a[232:235], v[184:187]
    ds_read_b64_tr_b16 a[60:61], v155 offset:40960
    ds_read_b64_tr_b16 a[62:63], v155 offset:43008
    v_sub_f32 v25, 1.0, v23
    v_and_b32 v129, 15, v128
    s_waitcnt lgkmcnt(11)
    v_mfma_f32_16x16x32_bf16 v[160:163], a[48:51], a[236:239], v[160:163]
    ds_read_b64_tr_b16 a[64:65], v152 offset:49152
    ds_read_b64_tr_b16 a[66:67], v152 offset:51200
    v_lshrrev_b32 v131, 4, v128
    v_and_b32 v130, 1, v131
    s_waitcnt lgkmcnt(9)
    v_mfma_f32_16x16x32_bf16 v[168:171], a[52:55], a[236:239], v[168:171]
    ds_read_b64_tr_b16 a[68:69], v153 offset:49152
    ds_read_b64_tr_b16 a[70:71], v153 offset:51200
    v_lshrrev_b32 v131, 1, v131
    v_mul_u32_u24 v132, 1152, v129
    s_waitcnt lgkmcnt(7)
    v_mfma_f32_16x16x32_bf16 v[176:179], a[56:59], a[236:239], v[176:179]
    ds_read_b64_tr_b16 a[72:73], v154 offset:49152
    ds_read_b64_tr_b16 a[74:75], v154 offset:51200
    v_lshl_add_u32 v132, v131, 4, v132
    s_mul_i32 s60, s4, 1152
    s_waitcnt lgkmcnt(6)
    v_mfma_f32_16x16x32_bf16 v[184:187], a[60:63], a[236:239], v[184:187]
    ds_read_b64_tr_b16 a[76:77], v155 offset:49152
    ds_read_b64_tr_b16 a[78:79], v155 offset:51200
    s_lshl_b32 s63, s5, 1
    s_add_u32 s60, s60, s63
    s_waitcnt lgkmcnt(6)
    v_mfma_f32_16x16x32_bf16 v[160:163], a[64:67], a[240:243], v[160:163]
    ds_read_b64_tr_b16 a[80:81], v152 offset:57344
    ds_read_b64_tr_b16 a[82:83], v152 offset:59392
    v_lshl_add_u32 v8, v130, 5, v132
    v_add_u32 v8, s60, v8
    s_waitcnt lgkmcnt(6)
    v_mfma_f32_16x16x32_bf16 v[168:171], a[68:71], a[240:243], v[168:171]
    ds_read_b64_tr_b16 a[84:85], v153 offset:57344
    ds_read_b64_tr_b16 a[86:87], v153 offset:59392
    v_xor_b32 v9, s61, v130
    v_mul_u32_u24 v9, 18432, v9
    s_waitcnt lgkmcnt(6)
    v_mfma_f32_16x16x32_bf16 v[176:179], a[72:75], a[240:243], v[176:179]
    ds_read_b64_tr_b16 a[88:89], v154 offset:57344
    ds_read_b64_tr_b16 a[90:91], v154 offset:59392
    s_mul_i32 s60, s71, 36864
    s_lshl_b32 s63, s6, 1
    s_waitcnt lgkmcnt(6)
    v_mfma_f32_16x16x32_bf16 v[184:187], a[76:79], a[240:243], v[184:187]
    ds_read_b64_tr_b16 a[92:93], v155 offset:57344
    ds_read_b64_tr_b16 a[94:95], v155 offset:59392
    s_add_u32 s60, s60, s63
    s_add_u32 s60, s60, s13
    s_waitcnt lgkmcnt(6)
    v_mfma_f32_16x16x32_bf16 v[160:163], a[80:83], a[244:247], v[160:163]
    ds_read_b64_tr_b16 a[96:97], v236 offset:0
    ds_read_b64_tr_b16 a[98:99], v236 offset:2048
    v_add3_u32 v9, v9, v132, s60
    s_mov_b32 s8, s92
    s_waitcnt lgkmcnt(6)
    v_mfma_f32_16x16x32_bf16 v[168:171], a[84:87], a[244:247], v[168:171]
    ds_read_b64_tr_b16 a[100:101], v237 offset:0
    ds_read_b64_tr_b16 a[102:103], v237 offset:2048
    s_mov_b32 s9, s93
    s_mov_b32 s10, 2359296
    s_waitcnt lgkmcnt(6)
    v_mfma_f32_16x16x32_bf16 v[176:179], a[88:91], a[244:247], v[176:179]
    ds_read_b64_tr_b16 a[104:105], v238 offset:0
    ds_read_b64_tr_b16 a[106:107], v238 offset:2048
    s_mov_b32 s11, 0x00020000
    v_lshlrev_b32 v131, 3, v131
    s_waitcnt lgkmcnt(6)
    v_mfma_f32_16x16x32_bf16 v[184:187], a[92:95], a[244:247], v[184:187]
    ds_read_b64_tr_b16 a[108:109], v239 offset:0
    ds_read_b64_tr_b16 a[110:111], v239 offset:2048
    v_sub_u32 v131, v129, v131
    v_and_b32 v132, 1, v131
    s_waitcnt lgkmcnt(6)
    v_mfma_f32_16x16x32_bf16 v[160:163], a[96:99], a[160:163], v[160:163]
    v_lshlrev_b32 v132, 4, v132
    s_movk_i32 s60, 0x3f80
    s_waitcnt lgkmcnt(4)
    v_mfma_f32_16x16x32_bf16 v[168:171], a[100:103], a[160:163], v[168:171]
    v_lshlrev_b32 v132, v132, s60
    v_lshrrev_b32 v131, 1, v131
    s_waitcnt lgkmcnt(2)
    v_mfma_f32_16x16x32_bf16 v[176:179], a[104:107], a[160:163], v[176:179]
    v_lshl_add_u32 v131, v130, 2, v131
    v_lshrrev_b32 v129, 3, v129
    s_waitcnt lgkmcnt(0)
    v_mfma_f32_16x16x32_bf16 v[184:187], a[108:111], a[160:163], v[184:187]
    v_lshrrev_b32 v130, 5, v128
    v_cmp_eq_u32 vcc, v129, v130
    s_nop 1
    v_cndmask_b32 v132, 0, v132, vcc
    v_cmp_eq_u32 vcc, 0, v131
    s_nop 1
    v_cndmask_b32 v0, 0, v132, vcc
    v_cmp_eq_u32 vcc, 1, v131
    s_nop 1
    v_cndmask_b32 v1, 0, v132, vcc
    v_cmp_eq_u32 vcc, 2, v131
    s_nop 1
    v_cndmask_b32 v2, 0, v132, vcc
    v_cmp_eq_u32 vcc, 3, v131
    s_nop 1
    v_cndmask_b32 v3, 0, v132, vcc
    v_cmp_eq_u32 vcc, 4, v131
    s_nop 1
    v_cndmask_b32 v4, 0, v132, vcc
    v_cmp_eq_u32 vcc, 5, v131
    s_nop 1
    v_cndmask_b32 v5, 0, v132, vcc
    v_cmp_eq_u32 vcc, 6, v131
    s_nop 1
    v_cndmask_b32 v6, 0, v132, vcc
    v_cmp_eq_u32 vcc, 7, v131
    s_nop 1
    v_cndmask_b32 v7, 0, v132, vcc
    v_lshlrev_b32 v40, 16, v26
    v_and_b32 v41, 0xffff0000, v26
    v_lshlrev_b32 v42, 16, v27
    v_and_b32 v43, 0xffff0000, v27
    v_lshlrev_b32 v44, 16, v28
    v_and_b32 v45, 0xffff0000, v28
    v_lshlrev_b32 v46, 16, v29
    v_and_b32 v47, 0xffff0000, v29
    v_lshlrev_b32 v48, 16, v30
    v_and_b32 v49, 0xffff0000, v30
    v_lshlrev_b32 v50, 16, v31
    v_and_b32 v51, 0xffff0000, v31
    v_lshlrev_b32 v52, 16, v32
    v_and_b32 v53, 0xffff0000, v32
    v_lshlrev_b32 v54, 16, v33
    v_and_b32 v55, 0xffff0000, v33
    v_lshlrev_b32 v56, 16, v34
    v_and_b32 v57, 0xffff0000, v34
    v_lshlrev_b32 v58, 16, v35
    v_and_b32 v59, 0xffff0000, v35
    v_lshlrev_b32 v60, 16, v36
    v_and_b32 v61, 0xffff0000, v36
    v_lshlrev_b32 v62, 16, v37
    v_and_b32 v63, 0xffff0000, v37
    v_mul_f32 v40, v22, v40
    v_mul_f32 v41, v22, v41
    v_mul_f32 v42, v22, v42
    v_mul_f32 v43, v22, v43
    v_mul_f32 v44, v22, v44
    v_mul_f32 v45, v22, v45
    v_mul_f32 v46, v22, v46
    v_mul_f32 v47, v22, v47
    v_mul_f32 v48, v22, v48
    v_mul_f32 v49, v22, v49
    v_mul_f32 v50, v22, v50
    v_mul_f32 v51, v22, v51
    v_mul_f32 v52, v22, v52
    v_mul_f32 v53, v22, v53
    v_mul_f32 v54, v22, v54
    v_mul_f32 v55, v22, v55
    v_mul_f32 v56, v22, v56
    v_mul_f32 v57, v22, v57
    v_mul_f32 v58, v22, v58
    v_mul_f32 v59, v22, v59
    v_mul_f32 v60, v23, v60
    v_mul_f32 v61, v23, v61
    v_mul_f32 v62, v23, v62
    v_mul_f32 v63, v23, v63
    s_mov_b32 s3, 65536
    s_waitcnt vmcnt(0)
    buffer_load_dwordx4 v[92:95], v232, s[32:35], s80 offen offset:0 sc1
    buffer_load_dwordx4 v[96:99], v232, s[32:35], s80 offen offset:1024 sc1
    buffer_load_dwordx4 v[116:119], v17, s[32:35], 0 offen offset:0 sc1
    buffer_load_dwordx4 v[100:103], v232, s[32:35], s80 offen offset:2048 sc1
    buffer_load_dwordx4 v[104:107], v232, s[32:35], s80 offen offset:3072 sc1
    buffer_load_dwordx4 v[120:123], v17, s[32:35], 0 offen offset:1024 sc1
    buffer_load_dwordx4 v[108:111], v232, s[32:35], s81 offen offset:0 sc1
    buffer_load_dwordx4 v[112:115], v232, s[32:35], s81 offen offset:1024 sc1
    buffer_load_dwordx4 v[124:127], v17, s[32:35], 0 offen offset:2048 sc1
    s_waitcnt vmcnt(6)
    v_max3_u32 v133, v92, v93, v94
    v_max3_u32 v134, v95, v96, v97
    v_max3_u32 v133, v98, v99, v133
    v_max3_u32 v134, v116, v117, v134
    v_max3_u32 v133, v118, v119, v133
    v_max_u32 v133, v133, v134
    v_cmp_eq_u32 s[20:21], -1, v133
    s_nop 0
    s_cmp_eq_u64 s[20:21], 0
    s_cbranch_scc0 mk_F0
    v_mfma_f32_16x16x32_bf16 v[160:163], v[0:3], v[92:95], v[160:163]
    v_mfma_f32_16x16x32_bf16 v[168:171], v[4:7], v[92:95], v[168:171]
    v_mfma_f32_16x16x32_bf16 v[176:179], v[0:3], v[96:99], v[176:179]
    v_mfma_f32_16x16x32_bf16 v[184:187], v[4:7], v[96:99], v[184:187]
    v_mfma_f32_16x16x32_bf16 v[224:227], v[0:3], v[116:119], v[224:227]
    v_mfma_f32_16x16x32_bf16 v[228:231], v[4:7], v[116:119], v[228:231]
mk_F0:
    s_waitcnt vmcnt(3)
    v_max3_u32 v135, v100, v101, v102
    v_max3_u32 v136, v103, v104, v105
    v_max3_u32 v135, v106, v107, v135
    v_max3_u32 v136, v120, v121, v136
    v_max3_u32 v135, v122, v123, v135
    v_max_u32 v135, v135, v136
    v_cmp_eq_u32 s[22:23], -1, v135
    s_nop 0
    s_cmp_eq_u64 s[22:23], 0
    s_cbranch_scc0 mk_F1
    v_mfma_f32_16x16x32_bf16 v[160:163], v[0:3], v[100:103], v[160:163]
    v_mfma_f32_16x16x32_bf16 v[168:171], v[4:7], v[100:103], v[168:171]
    v_mfma_f32_16x16x32_bf16 v[176:179], v[0:3], v[104:107], v[176:179]
    v_mfma_f32_16x16x32_bf16 v[184:187], v[4:7], v[104:107], v[184:187]
    v_mfma_f32_16x16x32_bf16 v[224:227], v[0:3], v[120:123], v[224:227]
    v_mfma_f32_16x16x32_bf16 v[228:231], v[4:7], v[120:123], v[228:231]
mk_F1:
    s_waitcnt vmcnt(0)
    v_max3_u32 v137, v108, v109, v110
    v_max3_u32 v138, v111, v112, v113
    v_max3_u32 v137, v114, v115, v137
    v_max3_u32 v138, v124, v125, v138
    v_max3_u32 v137, v126, v127, v137
    v_max_u32 v137, v137, v138
    v_cmp_eq_u32 s[24:25], -1, v137
    s_nop 0
    s_cmp_eq_u64 s[24:25], 0
    s_cbranch_scc0 mk_F2
    v_mfma_f32_16x16x32_bf16 v[160:163], v[0:3], v[108:111], v[160:163]
    v_mfma_f32_16x16x32_bf16 v[168:171], v[4:7], v[108:111], v[168:171]
    v_mfma_f32_16x16x32_bf16 v[176:179], v[0:3], v[112:115], v[176:179]
    v_mfma_f32_16x16x32_bf16 v[184:187], v[4:7], v[112:115], v[184:187]
    v_mfma_f32_16x16x32_bf16 v[224:227], v[0:3], v[124:127], v[224:227]
    v_mfma_f32_16x16x32_bf16 v[228:231], v[4:7], v[124:127], v[228:231]
mk_F2:
mk_PL:
    s_or_b64 s[26:27], s[20:21], s[22:23]
    s_or_b64 s[26:27], s[26:27], s[24:25]
    s_cbranch_scc0 mk_PD
    s_sub_u32 s3, s3, 1
    s_cmp_eq_u32 s3, 0
    s_cbranch_scc1 mk_PD
    s_cmp_eq_u64 s[20:21], 0
    s_cbranch_scc1 mk_Q0
    buffer_load_dwordx4 v[92:95], v232, s[32:35], s80 offen offset:0 sc1
    buffer_load_dwordx4 v[96:99], v232, s[32:35], s80 offen offset:1024 sc1
    buffer_load_dwordx4 v[116:119], v17, s[32:35], 0 offen offset:0 sc1
mk_Q0:
    s_cmp_eq_u64 s[22:23], 0
    s_cbranch_scc1 mk_Q1
    buffer_load_dwordx4 v[100:103], v232, s[32:35], s80 offen offset:2048 sc1
    buffer_load_dwordx4 v[104:107], v232, s[32:35], s80 offen offset:3072 sc1
    buffer_load_dwordx4 v[120:123], v17, s[32:35], 0 offen offset:1024 sc1
mk_Q1:
    s_cmp_eq_u64 s[24:25], 0
    s_cbranch_scc1 mk_Q2
    buffer_load_dwordx4 v[108:111], v232, s[32:35], s81 offen offset:0 sc1
    buffer_load_dwordx4 v[112:115], v232, s[32:35], s81 offen offset:1024 sc1
    buffer_load_dwordx4 v[124:127], v17, s[32:35], 0 offen offset:2048 sc1
mk_Q2:
    s_waitcnt vmcnt(0)
    s_cmp_eq_u64 s[20:21], 0
    s_cbranch_scc1 mk_C0
    v_max3_u32 v133, v92, v93, v94
    v_max3_u32 v134, v95, v96, v97
    v_max3_u32 v133, v98, v99, v133
    v_max3_u32 v134, v116, v117, v134
    v_max3_u32 v133, v118, v119, v133
    v_max_u32 v133, v133, v134
    v_cmp_eq_u32 s[20:21], -1, v133
    s_nop 0
    s_cmp_eq_u64 s[20:21], 0
    s_cbranch_scc0 mk_C0
    v_mfma_f32_16x16x32_bf16 v[160:163], v[0:3], v[92:95], v[160:163]
    v_mfma_f32_16x16x32_bf16 v[168:171], v[4:7], v[92:95], v[168:171]
    v_mfma_f32_16x16x32_bf16 v[176:179], v[0:3], v[96:99], v[176:179]
    v_mfma_f32_16x16x32_bf16 v[184:187], v[4:7], v[96:99], v[184:187]
    v_mfma_f32_16x16x32_bf16 v[224:227], v[0:3], v[116:119], v[224:227]
    v_mfma_f32_16x16x32_bf16 v[228:231], v[4:7], v[116:119], v[228:231]
mk_C0:
    s_cmp_eq_u64 s[22:23], 0
    s_cbranch_scc1 mk_C1
    v_max3_u32 v135, v100, v101, v102
    v_max3_u32 v136, v103, v104, v105
    v_max3_u32 v135, v106, v107, v135
    v_max3_u32 v136, v120, v121, v136
    v_max3_u32 v135, v122, v123, v135
    v_max_u32 v135, v135, v136
    v_cmp_eq_u32 s[22:23], -1, v135
    s_nop 0
    s_cmp_eq_u64 s[22:23], 0
    s_cbranch_scc0 mk_C1
    v_mfma_f32_16x16x32_bf16 v[160:163], v[0:3], v[100:103], v[160:163]
    v_mfma_f32_16x16x32_bf16 v[168:171], v[4:7], v[100:103], v[168:171]
    v_mfma_f32_16x16x32_bf16 v[176:179], v[0:3], v[104:107], v[176:179]
    v_mfma_f32_16x16x32_bf16 v[184:187], v[4:7], v[104:107], v[184:187]
    v_mfma_f32_16x16x32_bf16 v[224:227], v[0:3], v[120:123], v[224:227]
    v_mfma_f32_16x16x32_bf16 v[228:231], v[4:7], v[120:123], v[228:231]
mk_C1:
    s_cmp_eq_u64 s[24:25], 0
    s_cbranch_scc1 mk_C2
    v_max3_u32 v137, v108, v109, v110
    v_max3_u32 v138, v111, v112, v113
    v_max3_u32 v137, v114, v115, v137
    v_max3_u32 v138, v124, v125, v138
    v_max3_u32 v137, v126, v127, v137
    v_max_u32 v137, v137, v138
    v_cmp_eq_u32 s[24:25], -1, v137
    s_nop 0
    s_cmp_eq_u64 s[24:25], 0
    s_cbranch_scc0 mk_C2
    v_mfma_f32_16x16x32_bf16 v[160:163], v[0:3], v[108:111], v[160:163]
    v_mfma_f32_16x16x32_bf16 v[168:171], v[4:7], v[108:111], v[168:171]
    v_mfma_f32_16x16x32_bf16 v[176:179], v[0:3], v[112:115], v[176:179]
    v_mfma_f32_16x16x32_bf16 v[184:187], v[4:7], v[112:115], v[184:187]
    v_mfma_f32_16x16x32_bf16 v[224:227], v[0:3], v[124:127], v[224:227]
    v_mfma_f32_16x16x32_bf16 v[228:231], v[4:7], v[124:127], v[228:231]
mk_C2:
    s_branch mk_PL
mk_PD:
    s_nop 1
    v_pk_fma_f32 v[160:161], v[160:161], v[24:25], v[40:41] op_sel:[0,0,0] op_sel_hi:[1,0,1]
    v_pk_fma_f32 v[162:163], v[162:163], v[24:25], v[42:43] op_sel:[0,0,0] op_sel_hi:[1,0,1]
    v_pk_fma_f32 v[168:169], v[168:169], v[24:25], v[44:45] op_sel:[0,0,0] op_sel_hi:[1,0,1]
    v_pk_fma_f32 v[170:171], v[170:171], v[24:25], v[46:47] op_sel:[0,0,0] op_sel_hi:[1,0,1]
    v_cvt_pk_bf16_f32 v72, v160, v161
    v_cvt_pk_bf16_f32 v74, v168, v169
    v_cvt_pk_bf16_f32 v73, v162, v163
    v_cvt_pk_bf16_f32 v75, v170, v171
    v_permlane16_swap_b32 v72, v74
    s_nop 0
    v_permlane16_swap_b32 v73, v75
    buffer_store_dwordx4 v[72:75], v8, s[8:11], 0 offen offset:0
    v_pk_fma_f32 v[176:177], v[176:177], v[24:25], v[48:49] op_sel:[0,0,0] op_sel_hi:[1,0,1]
    v_pk_fma_f32 v[178:179], v[178:179], v[24:25], v[50:51] op_sel:[0,0,0] op_sel_hi:[1,0,1]
    v_pk_fma_f32 v[184:185], v[184:185], v[24:25], v[52:53] op_sel:[0,0,0] op_sel_hi:[1,0,1]
    v_pk_fma_f32 v[186:187], v[186:187], v[24:25], v[54:55] op_sel:[0,0,0] op_sel_hi:[1,0,1]
    v_cvt_pk_bf16_f32 v76, v176, v177
    v_cvt_pk_bf16_f32 v78, v184, v185
    v_cvt_pk_bf16_f32 v77, v178, v179
    v_cvt_pk_bf16_f32 v79, v186, v187
    v_permlane16_swap_b32 v76, v78
    s_nop 0
    v_permlane16_swap_b32 v77, v79
    buffer_store_dwordx4 v[76:79], v8, s[8:11], 0 offen offset:64
    v_pk_fma_f32 v[224:225], v[224:225], v[24:25], v[56:57] op_sel:[0,0,0] op_sel_hi:[1,0,1]
    v_pk_fma_f32 v[226:227], v[226:227], v[24:25], v[58:59] op_sel:[0,0,0] op_sel_hi:[1,0,1]
    v_pk_fma_f32 v[228:229], v[228:229], v[24:25], v[60:61] op_sel:[0,1,0] op_sel_hi:[1,1,1]
    v_pk_fma_f32 v[230:231], v[230:231], v[24:25], v[62:63] op_sel:[0,1,0] op_sel_hi:[1,1,1]
    v_cvt_pk_bf16_f32 v80, v224, v225
    v_cvt_pk_bf16_f32 v82, v228, v229
    v_cvt_pk_bf16_f32 v81, v226, v227
    v_cvt_pk_bf16_f32 v83, v230, v231
    v_permlane16_swap_b32 v80, v82
    s_nop 0
    v_permlane16_swap_b32 v81, v83
    buffer_store_dwordx4 v[80:83], v9, s[8:11], 0 offen offset:0
mk_END:
    s_endpgm
mk_SL_U:
    s_mov_b32 s3, 65536
mk_LP_U:
    buffer_load_dword v229, v218, s[72:75], 0 offen sc1
    s_waitcnt vmcnt(0)
    v_cmp_ne_u32 vcc, s82, v229
    s_nop 0
    s_cbranch_vccz mk_BK_U
    s_sub_u32 s3, s3, 1
    s_cmp_lg_u32 s3, 0
    s_cbranch_scc1 mk_LP_U
    s_branch mk_BK_U
mk_SL_H1:
    s_mov_b32 s3, 65536
mk_LP_H1:
    buffer_load_dword v147, v157, s[32:35], 0 offen sc1
    s_waitcnt vmcnt(0)
    v_cmp_eq_u32 vcc, 0, v147
    s_nop 0
    s_cbranch_vccz mk_BK_H1
    s_sub_u32 s3, s3, 1
    s_cmp_lg_u32 s3, 0
    s_cbranch_scc1 mk_LP_H1
    s_branch mk_BK_H1
mk_SL_H2:
    s_mov_b32 s3, 65536
mk_LP_H2:
    buffer_load_dword v147, v157, s[32:35], 0 offen sc1
    s_waitcnt vmcnt(0)
    v_cmp_gt_u32 vcc, 2, v147
    s_nop 0
    s_cbranch_vccz mk_BK_H2
    s_sub_u32 s3, s3, 1
    s_cmp_lg_u32 s3, 0
    s_cbranch_scc1 mk_LP_H2
    s_branch mk_BK_H2
mk_SL_H3:
    s_mov_b32 s3, 65536
mk_LP_H3:
    buffer_load_dword v147, v157, s[32:35], 0 offen sc1
    s_waitcnt vmcnt(0)
    v_cmp_ne_u32 vcc, 3, v147
    s_nop 0
    s_cbranch_vccz mk_BK_H3
    s_sub_u32 s3, s3, 1
    s_cmp_lg_u32 s3, 0
    s_cbranch_scc1 mk_LP_H3
    s_branch mk_BK_H3
mk_SL_AC:
    s_mov_b32 s3, 65536
mk_LP_AC:
    buffer_load_dword v21, v18, s[32:35], 0 offen sc1
    s_waitcnt vmcnt(0)
    v_cmp_ne_u32 vcc, 16, v21
    s_nop 0
    s_cbranch_vccz mk_BK_AC
    s_sub_u32 s3, s3, 1
    s_cmp_lg_u32 s3, 0
    s_cbranch_scc1 mk_LP_AC
    s_branch mk_BK_AC
    s_endpgm
mk_CE:
.section .rodata,"a"
.p2align 6
.amdhsa_kernel mk_kernel
  .amdhsa_next_free_vgpr 512
  .amdhsa_next_free_sgpr 102
  .amdhsa_accum_offset 256
  .amdhsa_group_segment_fixed_size 0
  .amdhsa_kernarg_size 136
  .amdhsa_user_sgpr_count 2
  .amdhsa_user_sgpr_kernarg_segment_ptr 1
  .amdhsa_system_sgpr_workgroup_id_x 1
  .amdhsa_float_denorm_mode_32 3
  .amdhsa_float_denorm_mode_16_64 3
.end_amdhsa_kernel
```
